```python
import torch

def _softmax(x, axis=-1):
    return torch.softmax(x, dim=axis)
def _gelu(x):
    return torch.nn.functional.gelu(x, approximate="tanh")
def _silu(x):
    return torch.nn.functional.silu(x)
def _sigmoid(x):
    return torch.sigmoid(x)
def _layernorm(x, axis=-1, eps=1e-5):
    m = x.mean(dim=axis, keepdim=True)
    v = x.var(dim=axis, keepdim=True, unbiased=False)
    return (x - m) / torch.sqrt(v + eps)
def _scatter_add(tgt, idx, src, axis=0):
    return tgt.clone().index_add_(axis, idx, src)
def _segment_sum(src, seg, n):
    out = torch.zeros((n,) + src.shape[1:], dtype=src.dtype)
    return out.index_add_(0, seg, src)
def _pad(x, pw):
    flat = tuple(v for pair in reversed(pw) for v in pair)
    return torch.nn.functional.pad(x, flat)

kernel_name = 'concat_heads__mha_block_cached__gqa_block_cached__near_ridge'

def setup_inputs():

    _w = (lambda a: (lambda t: t.to(torch.bfloat16) if t.is_floating_point() else t)(torch.as_tensor(a)))
    def _A_setup():
        B, Sq, D = 16, 112, 576
        H, Sk, Dh = 32, 512, 128
        return {
            "x": _w((lambda *s: torch.randn(*s, dtype=torch.bfloat16) * 0.8)(B, Sq, D)),
            "k_cache": _w((lambda *s: torch.randn(*s, dtype=torch.bfloat16) * 0.8)(B, H, Sk, Dh)),
            "v_cache": _w((lambda *s: torch.randn(*s, dtype=torch.bfloat16) * 0.05)(B, H, Sk, Dh)),
            "wq": _w((lambda *s: torch.randn(*s, dtype=torch.bfloat16) * 0.8)(D, H * Dh) * (D ** -0.5)),
            "wo": _w((lambda *s: torch.randn(*s, dtype=torch.bfloat16) * 0.05)(H * Dh, D) * ((H * Dh) ** -0.5)),
        }
    _A_in = _A_setup()

    def _B_setup():
        B, Sq, D = 16, 112, 576
        Hq, Hkv, Sk, Dh = 32, 32, 512, 128
        assert Hq % Hkv == 0, (Hq, Hkv)
        return {
            "x": _w((lambda *s: torch.randn(*s, dtype=torch.bfloat16) * 0.8)(B, Sq, D)),
            "k_cache": _w((lambda *s: torch.randn(*s, dtype=torch.bfloat16) * 0.8)(B, Hkv, Sk, Dh)),
            "v_cache": _w((lambda *s: torch.randn(*s, dtype=torch.bfloat16) * 0.05)(B, Hkv, Sk, Dh)),
            "wq": _w((lambda *s: torch.randn(*s, dtype=torch.bfloat16) * 0.8)(D, Hq * Dh) * (D ** -0.5)),
            "wo": _w((lambda *s: torch.randn(*s, dtype=torch.bfloat16) * 0.05)(Hq * Dh, D) * ((Hq * Dh) ** -0.5)),
        }
    _B_in = _B_setup()

    return {
        "A_x": _A_in["x"],
        "A_k_cache": _A_in["k_cache"],
        "A_v_cache": _A_in["v_cache"],
        "A_wq": _A_in["wq"],
        "A_wo": _A_in["wo"],
        "B_x": _B_in["x"],
        "B_k_cache": _B_in["k_cache"],
        "B_v_cache": _B_in["v_cache"],
        "B_wq": _B_in["wq"],
        "B_wo": _B_in["wo"],
    }

def reference(A_x, A_k_cache, A_v_cache, A_wq, A_wo, B_x, B_k_cache, B_v_cache, B_wq, B_wo):
    def _A_ref(x, k_cache, v_cache, wq, wo):
        B, Sq, D = x.shape
        H, Dh = 32, 128
        q = (lambda x, *d: x.permute(*d))((x @ wq).reshape(B, Sq, H, Dh), 0, 2, 1, 3)
        scores = torch.einsum("bhqd,bhkd->bhqk", q, k_cache) * (Dh ** -0.5)
        p = _softmax(scores, axis=-1)
        o = torch.einsum("bhqk,bhkd->bhqd", p, v_cache)
        return (lambda x, *d: x.permute(*d))(o, 0, 2, 1, 3).reshape(B, Sq, H * Dh) @ wo

    def _B_ref(x, k_cache, v_cache, wq, wo):
        B, Sq, D = x.shape
        Hq, Dh = 32, 128
        Hkv = k_cache.shape[1]
        rep = Hq // Hkv
        q = (lambda x, *d: x.permute(*d))((x @ wq).reshape(B, Sq, Hq, Dh), 0, 2, 1, 3)
        k = (lambda x, n, axis: torch.repeat_interleave(x, n, dim=axis))(k_cache, rep, axis=1)
        v = (lambda x, n, axis: torch.repeat_interleave(x, n, dim=axis))(v_cache, rep, axis=1)
        scores = torch.einsum("bhqd,bhkd->bhqk", q, k) * (Dh ** -0.5)
        p = _softmax(scores, axis=-1)
        o = torch.einsum("bhqk,bhkd->bhqd", p, v)
        return (lambda x, *d: x.permute(*d))(o, 0, 2, 1, 3).reshape(B, Sq, Hq * Dh) @ wo

    a = _A_ref(A_x, A_k_cache, A_v_cache, A_wq, A_wo)
    b = _B_ref(B_x, B_k_cache, B_v_cache, B_wq, B_wo)
    return torch.concatenate([a, b], axis=-1)
```

```asm
; @launch kernel=fa_main_kernel grid=(256,1,1) block=(256,1,1) lds=151296
; @launch kernel=fa_reduce_kernel grid=(1008,1,1) block=(256,1,1) lds=0
.amdgcn_target "amdgcn-amd-amdhsa--gfx950"
.text
.globl fa_main_kernel
.p2align 8
.type fa_main_kernel,@function
fa_main_kernel:
L_code_start:
s_cmp_ge_u32 s2, 256
s_cbranch_scc1 L_end
s_load_dwordx16 s[4:19], s[0:1], 0
s_load_dwordx4 s[20:23], s[0:1], 64
s_load_dwordx2 s[24:25], s[0:1], 96
v_lshrrev_b32 v1, 6, v0
v_and_b32 v15, 63, v0
v_readfirstlane_b32 s56, v1
s_and_b32 s30, s2, 7
s_lshr_b32 s31, s2, 3
s_lshr_b32 s32, s30, 2
s_and_b32 s33, s30, 3
s_lshl_b32 s33, s33, 1
s_and_b32 s34, s31, 1
s_add_u32 s33, s33, s34
s_lshr_b32 s34, s31, 1
s_mov_b32 s58, 0
s_waitcnt lgkmcnt(0)
s_cmp_eq_u32 s32, 0
s_cselect_b32 s4, s4, s14
s_cselect_b32 s5, s5, s15
s_cselect_b32 s6, s6, s16
s_cselect_b32 s7, s7, s17
s_cselect_b32 s8, s8, s18
s_cselect_b32 s9, s9, s19
s_cselect_b32 s10, s10, s20
s_cselect_b32 s11, s11, s21
s_cselect_b32 s12, s12, s22
s_cselect_b32 s13, s13, s23
s_cmp_ge_u32 s56, 3
s_cbranch_scc1 L_role_W_far
s_branch L_role_C
L_role_W_far:
s_getpc_b64 s[30:31]
L_pcw:
s_add_u32 s30, s30, L_role_W-L_pcw
s_addc_u32 s31, s31, 0
s_setpc_b64 s[30:31]
L_end:
s_endpgm
L_role_C:
v_lshrrev_b32 v17, 3, v15
v_and_b32 v18, 7, v15
s_lshl_b32 s35, s33, 10
s_add_u32 s40, s10, s35
s_addc_u32 s41, s11, 0
s_sub_u32 s40, s40, 4096
s_subb_u32 s41, s41, 0
s_sub_u32 s42, 4722688, s35
s_mov_b32 s43, 0x00020000
s_mul_i32 s35, s34, 129024
s_add_u32 s44, s4, s35
s_addc_u32 s45, s5, 0
s_mov_b32 s46, 129024
s_mov_b32 s47, 0x00020000
v_bfe_u32 v19, v17, 1, 1
v_lshlrev_b32 v16, 2, v19
v_xor_b32 v16, v16, v18
v_lshlrev_b32 v16, 4, v16
v_lshlrev_b32 v19, 1, v19
v_xor_b32 v19, v19, v18
v_lshlrev_b32 v19, 4, v19
v_lshl_add_u32 v54, v17, 13, v16
s_lshl_b32 s35, s56, 16
v_add_u32 v54, s35, v54
s_lshl_b32 s35, s56, 11
v_lshl_add_u32 v8, v17, 8, v16
v_add_u32 v8, s35, v8
v_lshl_add_u32 v7, v17, 8, v19
v_add_u32 v7, s35, v7
s_movk_i32 s35, 1152
v_mul_lo_u32 v16, s35, v17
v_add_u32 v16, v16, v19
s_mul_i32 s35, s56, 36864
s_add_u32 s36, s35, 0
v_add_u32 v55, s36, v16
s_add_u32 s36, s35, 8128
v_add_u32 v56, s36, v16
s_add_u32 s36, s35, 16256
v_add_u32 v57, s36, v16
s_add_u32 s36, s35, 24384
v_add_u32 v58, s36, v16
s_mul_i32 s35, s56, 9216
v_add_u32 v63, s35, v16
s_mul_i32 s76, s56, 2056
s_lshl_b32 s69, s56, 11
s_lshr_b32 s35, s56, 1
s_lshl_b32 s35, s35, 6
s_add_u32 s69, s69, s35
s_mul_i32 s77, s56, 4352
s_mul_i32 s78, s56, 1088
s_movk_i32 s60, 4096
s_movk_i32 s68, 3200
s_mov_b32 s61, 0
s_add_u32 m0, s77, 66048
s_nop 0
buffer_load_dwordx4 v55, s[44:47], s61 offen offset:0 lds
buffer_load_dwordx4 v56, s[44:47], s61 offen offset:1088 lds
buffer_load_dwordx4 v57, s[44:47], s61 offen offset:2176 lds
buffer_load_dwordx4 v58, s[44:47], s61 offen offset:3264 lds
s_add_u32 m0, s76, 0
s_nop 0
buffer_load_dwordx4 v54, s[40:43], s60 offen offset:0 lds
buffer_load_dwordx4 v54, s[40:43], s68 offen offset:1024 lds
s_add_u32 m0, s76, 8256
s_add_u32 s60, s60, 256
s_add_u32 s68, s68, 256
buffer_load_dwordx4 v54, s[40:43], s60 offen offset:0 lds
buffer_load_dwordx4 v54, s[40:43], s68 offen offset:1024 lds
s_add_u32 m0, s76, 16512
s_add_u32 s60, s60, 256
s_add_u32 s68, s68, 256
buffer_load_dwordx4 v54, s[40:43], s60 offen offset:0 lds
buffer_load_dwordx4 v54, s[40:43], s68 offen offset:1024 lds
s_add_u32 m0, s76, 24768
s_add_u32 s60, s60, 256
s_add_u32 s68, s68, 256
buffer_load_dwordx4 v54, s[40:43], s60 offen offset:0 lds
buffer_load_dwordx4 v54, s[40:43], s68 offen offset:1024 lds
s_add_u32 m0, s76, 33024
s_add_u32 s60, s60, 261376
s_add_u32 s68, s68, 261376
buffer_load_dwordx4 v54, s[40:43], s60 offen offset:0 lds
buffer_load_dwordx4 v54, s[40:43], s68 offen offset:1024 lds
s_add_u32 m0, s76, 41280
s_add_u32 s60, s60, 256
s_add_u32 s68, s68, 256
buffer_load_dwordx4 v54, s[40:43], s60 offen offset:0 lds
buffer_load_dwordx4 v54, s[40:43], s68 offen offset:1024 lds
s_add_u32 m0, s76, 49536
s_add_u32 s60, s60, 256
s_add_u32 s68, s68, 256
buffer_load_dwordx4 v54, s[40:43], s60 offen offset:0 lds
buffer_load_dwordx4 v54, s[40:43], s68 offen offset:1024 lds
s_add_u32 m0, s76, 57792
s_add_u32 s60, s60, 256
s_add_u32 s68, s68, 256
buffer_load_dwordx4 v54, s[40:43], s60 offen offset:0 lds
buffer_load_dwordx4 v54, s[40:43], s68 offen offset:1024 lds
s_add_u32 m0, s77, 83456
s_add_u32 s61, s61, 128
buffer_load_dwordx4 v55, s[44:47], s61 offen offset:0 lds
buffer_load_dwordx4 v56, s[44:47], s61 offen offset:1088 lds
buffer_load_dwordx4 v57, s[44:47], s61 offen offset:2176 lds
buffer_load_dwordx4 v58, s[44:47], s61 offen offset:3264 lds
s_mul_i32 s35, s34, 288
s_mul_i32 s36, s56, 72
s_add_u32 s35, s35, s36
v_min_u32 v19, 63, v15
v_add_u32 v19, s35, v19
v_lshrrev_b32 v16, 3, v19
v_lshlrev_b32 v16, 13, v16
v_and_b32 v19, 7, v19
v_lshl_add_u32 v16, v19, 7, v16
v_add_u32 v16, 4096, v16
buffer_load_dword v0, v16, s[40:43], 0 offen offset:0
s_add_u32 s35, s35, 64
v_min_u32 v19, 7, v15
v_add_u32 v19, s35, v19
v_lshrrev_b32 v16, 3, v19
v_lshlrev_b32 v16, 13, v16
v_and_b32 v19, 7, v19
v_lshl_add_u32 v16, v19, 7, v16
v_add_u32 v16, 4096, v16
buffer_load_dword v0, v16, s[40:43], 0 offen offset:0
s_add_u32 s35, s35, 64
s_and_b32 s35, s33, 1
s_lshl_b32 s35, s35, 2
s_add_u32 s35, s35, s56
s_mul_i32 s35, s35, 16128
v_lshlrev_b32 v16, 7, v15
buffer_load_dword v0, v16, s[44:47], s35 offen offset:0
s_add_u32 s35, s35, 7936
buffer_load_dword v0, v16, s[44:47], s35 offen offset:0
s_add_u32 s35, s35, 7936
s_getpc_b64 s[36:37]
L_cpf_C:
s_sub_u32 s36, s36, L_cpf_C-L_code_start
s_subb_u32 s37, s37, 0
s_lshr_b32 s35, s2, 3
s_lshl_b32 s35, s35, 2
s_add_u32 s35, s35, s56
s_and_b32 s35, s35, 15
s_lshl_b32 s35, s35, 13
v_lshlrev_b32 v16, 7, v15
v_add_u32 v16, s35, v16
s_mov_b32 s35, L_code_end-L_code_start-4
v_min_u32 v16, s35, v16
global_load_dword v0, v16, s[36:37]
s_lshl_b32 s35, s34, 5
s_lshl_b32 s36, s33, 2
s_add_u32 s35, s35, s36
s_lshl_b32 s36, s35, 17
s_lshr_b32 s37, s35, 15
s_add_u32 s80, s6, s36
s_addc_u32 s81, s7, s37
s_sub_u32 s80, s80, 4096
s_subb_u32 s81, s81, 0
s_mov_b32 s82, 528384
s_mov_b32 s83, 0x00020000
s_add_u32 s92, s8, s36
s_addc_u32 s93, s9, s37
s_sub_u32 s92, s92, 4096
s_subb_u32 s93, s93, 0
s_mov_b32 s94, 528384
s_mov_b32 s95, 0x00020000
s_movk_i32 s64, 4096
s_movk_i32 s66, 3200
s_movk_i32 s65, 4096
s_movk_i32 s67, 3200
s_mul_i32 s35, s33, 589824
s_add_u32 s48, s12, s35
s_addc_u32 s49, s13, 0
s_mov_b32 s50, 589824
s_mov_b32 s51, 0x00020000
s_mul_i32 s35, s34, 72
s_mul_i32 s36, s56, 18
s_add_u32 s35, s35, s36
v_min_u32 v19, 17, v15
v_add_u32 v19, s35, v19
v_lshlrev_b32 v9, 7, v19
s_mov_b32 s89, 0
s_mov_b32 s62, 4294819840
v_lshlrev_b32 v10, 4, v15
s_mov_b32 s72, 0x3e0293ee
s_mov_b32 s73, 0x45800000
s_mul_i32 s35, s2, 129024
s_add_u32 s52, s24, s35
s_addc_u32 s53, s25, 0
s_mov_b32 s54, 129024
s_mov_b32 s55, 0x00020000
s_mov_b32 s26, 0x3e0293ee
s_mov_b32 s27, 0x3e0293ee
s_lshl_b32 s35, s2, 2
s_add_u32 s35, s35, s56
s_mul_i32 s35, s35, 24576
s_add_u32 s35, s35, 50331648
s_add_u32 s28, s24, s35
s_addc_u32 s29, s25, 0
s_movk_i32 s30, 24576
s_mov_b32 s31, 0x00020000
s_mov_b32 s38, 0
s_movk_i32 s74, 4096
v_lshrrev_b32 v16, 4, v15
v_bfe_u32 v17, v15, 2, 2
v_and_b32 v18, 3, v15
s_movk_i32 s35, 2056
v_mul_lo_u32 v1, s35, v16
v_lshl_add_u32 v1, v17, 7, v1
v_lshrrev_b32 v19, 1, v17
v_lshl_add_u32 v1, v19, 6, v1
v_lshl_add_u32 v1, v18, 4, v1
v_xor_b32 v19, 1, v19
v_mul_lo_u32 v2, s35, v16
v_lshl_add_u32 v2, v17, 7, v2
v_lshl_add_u32 v2, v19, 6, v2
v_lshl_add_u32 v2, v18, 4, v2
s_movk_i32 s35, 1088
v_mul_lo_u32 v5, s35, v16
v_lshl_add_u32 v5, v17, 7, v5
v_lshrrev_b32 v19, 1, v17
v_lshl_add_u32 v5, v19, 5, v5
v_lshl_add_u32 v5, v18, 3, v5
v_add_u32 v5, 66048, v5
v_xor_b32 v6, 32, v5
v_lshlrev_b32 v3, 11, v17
v_lshrrev_b32 v19, 1, v17
v_lshl_add_u32 v3, v19, 6, v3
v_lshl_add_u32 v3, v18, 7, v3
v_and_b32 v19, 2, v18
v_xor_b32 v19, v19, v16
v_lshl_add_u32 v3, v19, 4, v3
v_add_u32 v3, 33024, v3
v_and_b32 v18, 15, v15
v_lshrrev_b32 v17, 3, v18
s_lshl_b32 s36, s56, 2
v_add_u32 v17, s36, v17
v_mul_lo_u32 v4, s35, v17
v_and_b32 v19, 7, v18
v_lshl_add_u32 v4, v19, 7, v4
v_and_b32 v19, 2, v18
v_xor_b32 v19, v19, v16
v_lshl_add_u32 v4, v19, 4, v4
v_add_u32 v4, 66048, v4
v_accvgpr_write_b32 a0, 0
v_accvgpr_write_b32 a1, 0
v_accvgpr_write_b32 a2, 0
v_accvgpr_write_b32 a3, 0
v_accvgpr_write_b32 a4, 0
v_accvgpr_write_b32 a5, 0
v_accvgpr_write_b32 a6, 0
v_accvgpr_write_b32 a7, 0
v_accvgpr_write_b32 a8, 0
v_accvgpr_write_b32 a9, 0
v_accvgpr_write_b32 a10, 0
v_accvgpr_write_b32 a11, 0
v_accvgpr_write_b32 a12, 0
v_accvgpr_write_b32 a13, 0
v_accvgpr_write_b32 a14, 0
v_accvgpr_write_b32 a15, 0
v_accvgpr_write_b32 a16, 0
v_accvgpr_write_b32 a17, 0
v_accvgpr_write_b32 a18, 0
v_accvgpr_write_b32 a19, 0
v_accvgpr_write_b32 a20, 0
v_accvgpr_write_b32 a21, 0
v_accvgpr_write_b32 a22, 0
v_accvgpr_write_b32 a23, 0
v_accvgpr_write_b32 a24, 0
v_accvgpr_write_b32 a25, 0
v_accvgpr_write_b32 a26, 0
v_accvgpr_write_b32 a27, 0
v_accvgpr_write_b32 a28, 0
v_accvgpr_write_b32 a29, 0
v_accvgpr_write_b32 a30, 0
v_accvgpr_write_b32 a31, 0
v_accvgpr_write_b32 a32, 0
v_accvgpr_write_b32 a33, 0
v_accvgpr_write_b32 a34, 0
v_accvgpr_write_b32 a35, 0
v_accvgpr_write_b32 a36, 0
v_accvgpr_write_b32 a37, 0
v_accvgpr_write_b32 a38, 0
v_accvgpr_write_b32 a39, 0
v_accvgpr_write_b32 a40, 0
v_accvgpr_write_b32 a41, 0
v_accvgpr_write_b32 a42, 0
v_accvgpr_write_b32 a43, 0
v_accvgpr_write_b32 a44, 0
v_accvgpr_write_b32 a45, 0
v_accvgpr_write_b32 a46, 0
v_accvgpr_write_b32 a47, 0
v_accvgpr_write_b32 a48, 0
v_accvgpr_write_b32 a49, 0
v_accvgpr_write_b32 a50, 0
v_accvgpr_write_b32 a51, 0
v_accvgpr_write_b32 a52, 0
v_accvgpr_write_b32 a53, 0
v_accvgpr_write_b32 a54, 0
v_accvgpr_write_b32 a55, 0
v_accvgpr_write_b32 a56, 0
v_accvgpr_write_b32 a57, 0
v_accvgpr_write_b32 a58, 0
v_accvgpr_write_b32 a59, 0
v_accvgpr_write_b32 a60, 0
v_accvgpr_write_b32 a61, 0
v_accvgpr_write_b32 a62, 0
v_accvgpr_write_b32 a63, 0
v_accvgpr_write_b32 a64, 0
v_accvgpr_write_b32 a65, 0
v_accvgpr_write_b32 a66, 0
v_accvgpr_write_b32 a67, 0
v_accvgpr_write_b32 a68, 0
v_accvgpr_write_b32 a69, 0
v_accvgpr_write_b32 a70, 0
v_accvgpr_write_b32 a71, 0
v_accvgpr_write_b32 a72, 0
v_accvgpr_write_b32 a73, 0
v_accvgpr_write_b32 a74, 0
v_accvgpr_write_b32 a75, 0
v_accvgpr_write_b32 a76, 0
v_accvgpr_write_b32 a77, 0
v_accvgpr_write_b32 a78, 0
v_accvgpr_write_b32 a79, 0
v_accvgpr_write_b32 a80, 0
v_accvgpr_write_b32 a81, 0
v_accvgpr_write_b32 a82, 0
v_accvgpr_write_b32 a83, 0
v_accvgpr_write_b32 a84, 0
v_accvgpr_write_b32 a85, 0
v_accvgpr_write_b32 a86, 0
v_accvgpr_write_b32 a87, 0
v_accvgpr_write_b32 a88, 0
v_accvgpr_write_b32 a89, 0
v_accvgpr_write_b32 a90, 0
v_accvgpr_write_b32 a91, 0
v_accvgpr_write_b32 a92, 0
v_accvgpr_write_b32 a93, 0
v_accvgpr_write_b32 a94, 0
v_accvgpr_write_b32 a95, 0
v_accvgpr_write_b32 a96, 0
v_accvgpr_write_b32 a97, 0
v_accvgpr_write_b32 a98, 0
v_accvgpr_write_b32 a99, 0
v_accvgpr_write_b32 a100, 0
v_accvgpr_write_b32 a101, 0
v_accvgpr_write_b32 a102, 0
v_accvgpr_write_b32 a103, 0
v_accvgpr_write_b32 a104, 0
v_accvgpr_write_b32 a105, 0
v_accvgpr_write_b32 a106, 0
v_accvgpr_write_b32 a107, 0
v_accvgpr_write_b32 a108, 0
v_accvgpr_write_b32 a109, 0
v_accvgpr_write_b32 a110, 0
v_accvgpr_write_b32 a111, 0
v_accvgpr_write_b32 a112, 0
v_accvgpr_write_b32 a113, 0
v_accvgpr_write_b32 a114, 0
v_accvgpr_write_b32 a115, 0
v_accvgpr_write_b32 a116, 0
v_accvgpr_write_b32 a117, 0
v_accvgpr_write_b32 a118, 0
v_accvgpr_write_b32 a119, 0
v_accvgpr_write_b32 a120, 0
v_accvgpr_write_b32 a121, 0
v_accvgpr_write_b32 a122, 0
v_accvgpr_write_b32 a123, 0
v_accvgpr_write_b32 a124, 0
v_accvgpr_write_b32 a125, 0
v_accvgpr_write_b32 a126, 0
v_accvgpr_write_b32 a127, 0
v_accvgpr_write_b32 a128, 0
v_accvgpr_write_b32 a129, 0
v_accvgpr_write_b32 a130, 0
v_accvgpr_write_b32 a131, 0
v_accvgpr_write_b32 a132, 0
v_accvgpr_write_b32 a133, 0
v_accvgpr_write_b32 a134, 0
v_accvgpr_write_b32 a135, 0
v_accvgpr_write_b32 a136, 0
v_accvgpr_write_b32 a137, 0
v_accvgpr_write_b32 a138, 0
v_accvgpr_write_b32 a139, 0
v_accvgpr_write_b32 a140, 0
v_accvgpr_write_b32 a141, 0
v_accvgpr_write_b32 a142, 0
v_accvgpr_write_b32 a143, 0
v_accvgpr_write_b32 a144, 0
v_accvgpr_write_b32 a145, 0
v_accvgpr_write_b32 a146, 0
v_accvgpr_write_b32 a147, 0
v_accvgpr_write_b32 a148, 0
v_accvgpr_write_b32 a149, 0
v_accvgpr_write_b32 a150, 0
v_accvgpr_write_b32 a151, 0
v_accvgpr_write_b32 a152, 0
v_accvgpr_write_b32 a153, 0
v_accvgpr_write_b32 a154, 0
v_accvgpr_write_b32 a155, 0
v_accvgpr_write_b32 a156, 0
v_accvgpr_write_b32 a157, 0
v_accvgpr_write_b32 a158, 0
v_accvgpr_write_b32 a159, 0
v_accvgpr_write_b32 a160, 0
v_accvgpr_write_b32 a161, 0
v_accvgpr_write_b32 a162, 0
v_accvgpr_write_b32 a163, 0
v_accvgpr_write_b32 a164, 0
v_accvgpr_write_b32 a165, 0
v_accvgpr_write_b32 a166, 0
v_accvgpr_write_b32 a167, 0
v_accvgpr_write_b32 a168, 0
v_accvgpr_write_b32 a169, 0
v_accvgpr_write_b32 a170, 0
v_accvgpr_write_b32 a171, 0
v_accvgpr_write_b32 a172, 0
v_accvgpr_write_b32 a173, 0
v_accvgpr_write_b32 a174, 0
v_accvgpr_write_b32 a175, 0
v_accvgpr_write_b32 a176, 0
v_accvgpr_write_b32 a177, 0
v_accvgpr_write_b32 a178, 0
v_accvgpr_write_b32 a179, 0
v_accvgpr_write_b32 a180, 0
v_accvgpr_write_b32 a181, 0
v_accvgpr_write_b32 a182, 0
v_accvgpr_write_b32 a183, 0
v_accvgpr_write_b32 a184, 0
v_accvgpr_write_b32 a185, 0
v_accvgpr_write_b32 a186, 0
v_accvgpr_write_b32 a187, 0
v_accvgpr_write_b32 a188, 0
v_accvgpr_write_b32 a189, 0
v_accvgpr_write_b32 a190, 0
v_accvgpr_write_b32 a191, 0
v_accvgpr_write_b32 a192, 0
v_accvgpr_write_b32 a193, 0
v_accvgpr_write_b32 a194, 0
v_accvgpr_write_b32 a195, 0
v_accvgpr_write_b32 a196, 0
v_accvgpr_write_b32 a197, 0
v_accvgpr_write_b32 a198, 0
v_accvgpr_write_b32 a199, 0
v_accvgpr_write_b32 a200, 0
v_accvgpr_write_b32 a201, 0
v_accvgpr_write_b32 a202, 0
v_accvgpr_write_b32 a203, 0
v_accvgpr_write_b32 a204, 0
v_accvgpr_write_b32 a205, 0
v_accvgpr_write_b32 a206, 0
v_accvgpr_write_b32 a207, 0
v_accvgpr_write_b32 a208, 0
v_accvgpr_write_b32 a209, 0
v_accvgpr_write_b32 a210, 0
v_accvgpr_write_b32 a211, 0
v_accvgpr_write_b32 a212, 0
v_accvgpr_write_b32 a213, 0
v_accvgpr_write_b32 a214, 0
v_accvgpr_write_b32 a215, 0
v_accvgpr_write_b32 a216, 0
v_accvgpr_write_b32 a217, 0
v_accvgpr_write_b32 a218, 0
v_accvgpr_write_b32 a219, 0
v_accvgpr_write_b32 a220, 0
v_accvgpr_write_b32 a221, 0
v_accvgpr_write_b32 a222, 0
v_accvgpr_write_b32 a223, 0
v_accvgpr_write_b32 a224, 0
v_accvgpr_write_b32 a225, 0
v_accvgpr_write_b32 a226, 0
v_accvgpr_write_b32 a227, 0
v_accvgpr_write_b32 a228, 0
v_accvgpr_write_b32 a229, 0
v_accvgpr_write_b32 a230, 0
v_accvgpr_write_b32 a231, 0
v_accvgpr_write_b32 a232, 0
v_accvgpr_write_b32 a233, 0
v_accvgpr_write_b32 a234, 0
v_accvgpr_write_b32 a235, 0
v_accvgpr_write_b32 a236, 0
v_accvgpr_write_b32 a237, 0
v_accvgpr_write_b32 a238, 0
v_accvgpr_write_b32 a239, 0
v_accvgpr_write_b32 a240, 0
v_accvgpr_write_b32 a241, 0
v_accvgpr_write_b32 a242, 0
v_accvgpr_write_b32 a243, 0
v_accvgpr_write_b32 a244, 0
v_accvgpr_write_b32 a245, 0
v_accvgpr_write_b32 a246, 0
v_accvgpr_write_b32 a247, 0
v_accvgpr_write_b32 a248, 0
v_accvgpr_write_b32 a249, 0
v_accvgpr_write_b32 a250, 0
v_accvgpr_write_b32 a251, 0
v_accvgpr_write_b32 a252, 0
v_accvgpr_write_b32 a253, 0
v_accvgpr_write_b32 a254, 0
v_accvgpr_write_b32 a255, 0
s_waitcnt vmcnt(17) lgkmcnt(0)
s_barrier
ds_read_b128 v[36:39], v4 offset:0
ds_read_b128 v[40:43], v4 offset:2176
ds_read_b64_tr_b16 v[68:69], v1 offset:0
ds_read_b64_tr_b16 v[70:71], v1 offset:512
ds_read_b64_tr_b16 v[72:73], v1 offset:8
ds_read_b64_tr_b16 v[74:75], v1 offset:520
ds_read_b64_tr_b16 v[76:77], v2 offset:0
ds_read_b64_tr_b16 v[78:79], v2 offset:512
ds_read_b64_tr_b16 v[80:81], v2 offset:8
ds_read_b64_tr_b16 v[82:83], v2 offset:520
ds_read_b64_tr_b16 v[84:85], v1 offset:1024
ds_read_b64_tr_b16 v[86:87], v1 offset:1536
ds_read_b64_tr_b16 v[88:89], v1 offset:1032
ds_read_b64_tr_b16 v[90:91], v1 offset:1544
ds_read_b64_tr_b16 v[92:93], v2 offset:1024
ds_read_b64_tr_b16 v[94:95], v2 offset:1536
ds_read_b64_tr_b16 v[96:97], v2 offset:1032
ds_read_b64_tr_b16 v[98:99], v2 offset:1544
s_waitcnt lgkmcnt(14)
v_mfma_f32_16x16x32_bf16 a[0:3], v[68:71], v[36:39], a[0:3]
v_mfma_f32_16x16x32_bf16 a[4:7], v[68:71], v[40:43], a[4:7]
s_waitcnt lgkmcnt(12)
v_mfma_f32_16x16x32_bf16 a[8:11], v[72:75], v[36:39], a[8:11]
ds_read_b64_tr_b16 v[68:69], v1 offset:8256
ds_read_b64_tr_b16 v[70:71], v1 offset:8768
v_mfma_f32_16x16x32_bf16 a[12:15], v[72:75], v[40:43], a[12:15]
s_waitcnt lgkmcnt(12)
v_mfma_f32_16x16x32_bf16 a[16:19], v[76:79], v[36:39], a[16:19]
ds_read_b64_tr_b16 v[72:73], v1 offset:8264
ds_read_b64_tr_b16 v[74:75], v1 offset:8776
v_mfma_f32_16x16x32_bf16 a[20:23], v[76:79], v[40:43], a[20:23]
s_waitcnt lgkmcnt(12)
v_mfma_f32_16x16x32_bf16 a[24:27], v[80:83], v[36:39], a[24:27]
ds_read_b64_tr_b16 v[76:77], v2 offset:8256
ds_read_b64_tr_b16 v[78:79], v2 offset:8768
v_mfma_f32_16x16x32_bf16 a[28:31], v[80:83], v[40:43], a[28:31]
s_waitcnt lgkmcnt(12)
v_mfma_f32_16x16x32_bf16 a[32:35], v[84:87], v[36:39], a[32:35]
ds_read_b64_tr_b16 v[80:81], v2 offset:8264
ds_read_b64_tr_b16 v[82:83], v2 offset:8776
v_mfma_f32_16x16x32_bf16 a[36:39], v[84:87], v[40:43], a[36:39]
s_waitcnt lgkmcnt(12)
v_mfma_f32_16x16x32_bf16 a[40:43], v[88:91], v[36:39], a[40:43]
ds_read_b64_tr_b16 v[84:85], v1 offset:9280
ds_read_b64_tr_b16 v[86:87], v1 offset:9792
v_mfma_f32_16x16x32_bf16 a[44:47], v[88:91], v[40:43], a[44:47]
s_waitcnt lgkmcnt(12)
v_mfma_f32_16x16x32_bf16 a[48:51], v[92:95], v[36:39], a[48:51]
ds_read_b64_tr_b16 v[88:89], v1 offset:9288
ds_read_b64_tr_b16 v[90:91], v1 offset:9800
v_mfma_f32_16x16x32_bf16 a[52:55], v[92:95], v[40:43], a[52:55]
s_waitcnt lgkmcnt(12)
v_mfma_f32_16x16x32_bf16 a[56:59], v[96:99], v[36:39], a[56:59]
ds_read_b64_tr_b16 v[92:93], v2 offset:9280
ds_read_b64_tr_b16 v[94:95], v2 offset:9792
v_mfma_f32_16x16x32_bf16 a[60:63], v[96:99], v[40:43], a[60:63]
s_waitcnt lgkmcnt(12)
v_mfma_f32_16x16x32_bf16 a[64:67], v[68:71], v[36:39], a[64:67]
ds_read_b64_tr_b16 v[96:97], v2 offset:9288
ds_read_b64_tr_b16 v[98:99], v2 offset:9800
v_mfma_f32_16x16x32_bf16 a[68:71], v[68:71], v[40:43], a[68:71]
s_waitcnt lgkmcnt(12)
v_mfma_f32_16x16x32_bf16 a[72:75], v[72:75], v[36:39], a[72:75]
ds_read_b64_tr_b16 v[68:69], v1 offset:16512
ds_read_b64_tr_b16 v[70:71], v1 offset:17024
v_mfma_f32_16x16x32_bf16 a[76:79], v[72:75], v[40:43], a[76:79]
s_waitcnt lgkmcnt(12)
v_mfma_f32_16x16x32_bf16 a[80:83], v[76:79], v[36:39], a[80:83]
ds_read_b64_tr_b16 v[72:73], v1 offset:16520
ds_read_b64_tr_b16 v[74:75], v1 offset:17032
v_mfma_f32_16x16x32_bf16 a[84:87], v[76:79], v[40:43], a[84:87]
s_waitcnt lgkmcnt(12)
v_mfma_f32_16x16x32_bf16 a[88:91], v[80:83], v[36:39], a[88:91]
ds_read_b64_tr_b16 v[76:77], v2 offset:16512
ds_read_b64_tr_b16 v[78:79], v2 offset:17024
v_mfma_f32_16x16x32_bf16 a[92:95], v[80:83], v[40:43], a[92:95]
s_waitcnt lgkmcnt(12)
v_mfma_f32_16x16x32_bf16 a[96:99], v[84:87], v[36:39], a[96:99]
ds_read_b64_tr_b16 v[80:81], v2 offset:16520
ds_read_b64_tr_b16 v[82:83], v2 offset:17032
v_mfma_f32_16x16x32_bf16 a[100:103], v[84:87], v[40:43], a[100:103]
s_waitcnt lgkmcnt(12)
v_mfma_f32_16x16x32_bf16 a[104:107], v[88:91], v[36:39], a[104:107]
ds_read_b64_tr_b16 v[84:85], v1 offset:17536
ds_read_b64_tr_b16 v[86:87], v1 offset:18048
v_mfma_f32_16x16x32_bf16 a[108:111], v[88:91], v[40:43], a[108:111]
s_waitcnt lgkmcnt(12)
v_mfma_f32_16x16x32_bf16 a[112:115], v[92:95], v[36:39], a[112:115]
ds_read_b64_tr_b16 v[88:89], v1 offset:17544
ds_read_b64_tr_b16 v[90:91], v1 offset:18056
v_mfma_f32_16x16x32_bf16 a[116:119], v[92:95], v[40:43], a[116:119]
s_waitcnt lgkmcnt(12)
v_mfma_f32_16x16x32_bf16 a[120:123], v[96:99], v[36:39], a[120:123]
ds_read_b64_tr_b16 v[92:93], v2 offset:17536
ds_read_b64_tr_b16 v[94:95], v2 offset:18048
v_mfma_f32_16x16x32_bf16 a[124:127], v[96:99], v[40:43], a[124:127]
s_mov_b32 s39, 4
L_loop1:
s_waitcnt vmcnt(8)
s_barrier
s_waitcnt lgkmcnt(12)
ds_read_b64_tr_b16 v[96:97], v2 offset:17544
ds_read_b64_tr_b16 v[98:99], v2 offset:18056
v_mfma_f32_16x16x32_bf16 a[128:131], v[68:71], v[36:39], a[128:131]
s_add_u32 m0, s76, 0
s_add_u32 s60, s60, 261376
v_mfma_f32_16x16x32_bf16 a[132:135], v[68:71], v[40:43], a[132:135]
s_waitcnt lgkmcnt(12)
s_add_u32 s68, s68, 261376
v_mfma_f32_16x16x32_bf16 a[136:139], v[72:75], v[36:39], a[136:139]
ds_read_b64_tr_b16 v[68:69], v1 offset:24768
ds_read_b64_tr_b16 v[70:71], v1 offset:25280
v_mfma_f32_16x16x32_bf16 a[140:143], v[72:75], v[40:43], a[140:143]
s_waitcnt lgkmcnt(12)
buffer_load_dwordx4 v54, s[40:43], s60 offen offset:0 lds
v_mfma_f32_16x16x32_bf16 a[144:147], v[76:79], v[36:39], a[144:147]
ds_read_b64_tr_b16 v[72:73], v1 offset:24776
ds_read_b64_tr_b16 v[74:75], v1 offset:25288
v_mfma_f32_16x16x32_bf16 a[148:151], v[76:79], v[40:43], a[148:151]
s_waitcnt lgkmcnt(12)
buffer_load_dwordx4 v54, s[40:43], s68 offen offset:1024 lds
v_mfma_f32_16x16x32_bf16 a[152:155], v[80:83], v[36:39], a[152:155]
ds_read_b64_tr_b16 v[76:77], v2 offset:24768
ds_read_b64_tr_b16 v[78:79], v2 offset:25280
v_mfma_f32_16x16x32_bf16 a[156:159], v[80:83], v[40:43], a[156:159]
s_waitcnt lgkmcnt(12)
s_add_u32 m0, s76, 8256
v_mfma_f32_16x16x32_bf16 a[160:163], v[84:87], v[36:39], a[160:163]
ds_read_b64_tr_b16 v[80:81], v2 offset:24776
ds_read_b64_tr_b16 v[82:83], v2 offset:25288
v_mfma_f32_16x16x32_bf16 a[164:167], v[84:87], v[40:43], a[164:167]
s_waitcnt lgkmcnt(12)
s_add_u32 s60, s60, 256
v_mfma_f32_16x16x32_bf16 a[168:171], v[88:91], v[36:39], a[168:171]
ds_read_b64_tr_b16 v[84:85], v1 offset:25792
ds_read_b64_tr_b16 v[86:87], v1 offset:26304
v_mfma_f32_16x16x32_bf16 a[172:175], v[88:91], v[40:43], a[172:175]
s_waitcnt lgkmcnt(12)
s_add_u32 s68, s68, 256
v_mfma_f32_16x16x32_bf16 a[176:179], v[92:95], v[36:39], a[176:179]
ds_read_b64_tr_b16 v[88:89], v1 offset:25800
ds_read_b64_tr_b16 v[90:91], v1 offset:26312
v_mfma_f32_16x16x32_bf16 a[180:183], v[92:95], v[40:43], a[180:183]
s_waitcnt lgkmcnt(12)
buffer_load_dwordx4 v54, s[40:43], s60 offen offset:0 lds
v_mfma_f32_16x16x32_bf16 a[184:187], v[96:99], v[36:39], a[184:187]
ds_read_b64_tr_b16 v[92:93], v2 offset:25792
ds_read_b64_tr_b16 v[94:95], v2 offset:26304
v_mfma_f32_16x16x32_bf16 a[188:191], v[96:99], v[40:43], a[188:191]
s_waitcnt lgkmcnt(12)
buffer_load_dwordx4 v54, s[40:43], s68 offen offset:1024 lds
v_mfma_f32_16x16x32_bf16 a[192:195], v[68:71], v[36:39], a[192:195]
ds_read_b64_tr_b16 v[96:97], v2 offset:25800
ds_read_b64_tr_b16 v[98:99], v2 offset:26312
v_mfma_f32_16x16x32_bf16 a[196:199], v[68:71], v[40:43], a[196:199]
s_waitcnt lgkmcnt(12)
v_mfma_f32_16x16x32_bf16 a[200:203], v[72:75], v[36:39], a[200:203]
ds_read_b128 v[44:47], v4 offset:64
ds_read_b128 v[48:51], v4 offset:2240
ds_read_b64_tr_b16 v[68:69], v1 offset:33024
ds_read_b64_tr_b16 v[70:71], v1 offset:33536
v_mfma_f32_16x16x32_bf16 a[204:207], v[72:75], v[40:43], a[204:207]
s_waitcnt lgkmcnt(14)
v_mfma_f32_16x16x32_bf16 a[208:211], v[76:79], v[36:39], a[208:211]
ds_read_b64_tr_b16 v[72:73], v1 offset:33032
ds_read_b64_tr_b16 v[74:75], v1 offset:33544
v_mfma_f32_16x16x32_bf16 a[212:215], v[76:79], v[40:43], a[212:215]
s_waitcnt lgkmcnt(14)
v_mfma_f32_16x16x32_bf16 a[216:219], v[80:83], v[36:39], a[216:219]
ds_read_b64_tr_b16 v[76:77], v2 offset:33024
ds_read_b64_tr_b16 v[78:79], v2 offset:33536
v_mfma_f32_16x16x32_bf16 a[220:223], v[80:83], v[40:43], a[220:223]
s_waitcnt lgkmcnt(14)
v_mfma_f32_16x16x32_bf16 a[224:227], v[84:87], v[36:39], a[224:227]
ds_read_b64_tr_b16 v[80:81], v2 offset:33032
ds_read_b64_tr_b16 v[82:83], v2 offset:33544
v_mfma_f32_16x16x32_bf16 a[228:231], v[84:87], v[40:43], a[228:231]
s_waitcnt lgkmcnt(14)
v_mfma_f32_16x16x32_bf16 a[232:235], v[88:91], v[36:39], a[232:235]
ds_read_b64_tr_b16 v[84:85], v1 offset:34048
ds_read_b64_tr_b16 v[86:87], v1 offset:34560
v_mfma_f32_16x16x32_bf16 a[236:239], v[88:91], v[40:43], a[236:239]
s_waitcnt lgkmcnt(14)
v_mfma_f32_16x16x32_bf16 a[240:243], v[92:95], v[36:39], a[240:243]
ds_read_b64_tr_b16 v[88:89], v1 offset:34056
ds_read_b64_tr_b16 v[90:91], v1 offset:34568
v_mfma_f32_16x16x32_bf16 a[244:247], v[92:95], v[40:43], a[244:247]
s_waitcnt lgkmcnt(14)
v_mfma_f32_16x16x32_bf16 a[248:251], v[96:99], v[36:39], a[248:251]
ds_read_b64_tr_b16 v[92:93], v2 offset:34048
ds_read_b64_tr_b16 v[94:95], v2 offset:34560
v_mfma_f32_16x16x32_bf16 a[252:255], v[96:99], v[40:43], a[252:255]
s_waitcnt vmcnt(8)
s_barrier
s_waitcnt lgkmcnt(12)
ds_read_b64_tr_b16 v[96:97], v2 offset:34056
ds_read_b64_tr_b16 v[98:99], v2 offset:34568
v_mfma_f32_16x16x32_bf16 a[0:3], v[68:71], v[44:47], a[0:3]
s_add_u32 m0, s76, 16512
s_add_u32 s60, s60, 256
v_mfma_f32_16x16x32_bf16 a[4:7], v[68:71], v[48:51], a[4:7]
s_waitcnt lgkmcnt(12)
s_add_u32 s68, s68, 256
v_mfma_f32_16x16x32_bf16 a[8:11], v[72:75], v[44:47], a[8:11]
ds_read_b64_tr_b16 v[68:69], v1 offset:41280
ds_read_b64_tr_b16 v[70:71], v1 offset:41792
v_mfma_f32_16x16x32_bf16 a[12:15], v[72:75], v[48:51], a[12:15]
s_waitcnt lgkmcnt(12)
buffer_load_dwordx4 v54, s[40:43], s60 offen offset:0 lds
v_mfma_f32_16x16x32_bf16 a[16:19], v[76:79], v[44:47], a[16:19]
ds_read_b64_tr_b16 v[72:73], v1 offset:41288
ds_read_b64_tr_b16 v[74:75], v1 offset:41800
v_mfma_f32_16x16x32_bf16 a[20:23], v[76:79], v[48:51], a[20:23]
s_waitcnt lgkmcnt(12)
buffer_load_dwordx4 v54, s[40:43], s68 offen offset:1024 lds
v_mfma_f32_16x16x32_bf16 a[24:27], v[80:83], v[44:47], a[24:27]
ds_read_b64_tr_b16 v[76:77], v2 offset:41280
ds_read_b64_tr_b16 v[78:79], v2 offset:41792
v_mfma_f32_16x16x32_bf16 a[28:31], v[80:83], v[48:51], a[28:31]
s_waitcnt lgkmcnt(12)
s_add_u32 m0, s76, 24768
v_mfma_f32_16x16x32_bf16 a[32:35], v[84:87], v[44:47], a[32:35]
ds_read_b64_tr_b16 v[80:81], v2 offset:41288
ds_read_b64_tr_b16 v[82:83], v2 offset:41800
v_mfma_f32_16x16x32_bf16 a[36:39], v[84:87], v[48:51], a[36:39]
s_waitcnt lgkmcnt(12)
s_add_u32 s60, s60, 256
v_mfma_f32_16x16x32_bf16 a[40:43], v[88:91], v[44:47], a[40:43]
ds_read_b64_tr_b16 v[84:85], v1 offset:42304
ds_read_b64_tr_b16 v[86:87], v1 offset:42816
v_mfma_f32_16x16x32_bf16 a[44:47], v[88:91], v[48:51], a[44:47]
s_waitcnt lgkmcnt(12)
s_add_u32 s68, s68, 256
v_mfma_f32_16x16x32_bf16 a[48:51], v[92:95], v[44:47], a[48:51]
ds_read_b64_tr_b16 v[88:89], v1 offset:42312
ds_read_b64_tr_b16 v[90:91], v1 offset:42824
v_mfma_f32_16x16x32_bf16 a[52:55], v[92:95], v[48:51], a[52:55]
s_waitcnt lgkmcnt(12)
buffer_load_dwordx4 v54, s[40:43], s60 offen offset:0 lds
v_mfma_f32_16x16x32_bf16 a[56:59], v[96:99], v[44:47], a[56:59]
ds_read_b64_tr_b16 v[92:93], v2 offset:42304
ds_read_b64_tr_b16 v[94:95], v2 offset:42816
v_mfma_f32_16x16x32_bf16 a[60:63], v[96:99], v[48:51], a[60:63]
s_waitcnt lgkmcnt(12)
buffer_load_dwordx4 v54, s[40:43], s68 offen offset:1024 lds
v_mfma_f32_16x16x32_bf16 a[64:67], v[68:71], v[44:47], a[64:67]
ds_read_b64_tr_b16 v[96:97], v2 offset:42312
ds_read_b64_tr_b16 v[98:99], v2 offset:42824
v_mfma_f32_16x16x32_bf16 a[68:71], v[68:71], v[48:51], a[68:71]
s_waitcnt lgkmcnt(12)
v_mfma_f32_16x16x32_bf16 a[72:75], v[72:75], v[44:47], a[72:75]
ds_read_b64_tr_b16 v[68:69], v1 offset:49536
ds_read_b64_tr_b16 v[70:71], v1 offset:50048
v_mfma_f32_16x16x32_bf16 a[76:79], v[72:75], v[48:51], a[76:79]
s_waitcnt lgkmcnt(12)
v_mfma_f32_16x16x32_bf16 a[80:83], v[76:79], v[44:47], a[80:83]
ds_read_b64_tr_b16 v[72:73], v1 offset:49544
ds_read_b64_tr_b16 v[74:75], v1 offset:50056
v_mfma_f32_16x16x32_bf16 a[84:87], v[76:79], v[48:51], a[84:87]
s_waitcnt lgkmcnt(12)
v_mfma_f32_16x16x32_bf16 a[88:91], v[80:83], v[44:47], a[88:91]
ds_read_b64_tr_b16 v[76:77], v2 offset:49536
ds_read_b64_tr_b16 v[78:79], v2 offset:50048
v_mfma_f32_16x16x32_bf16 a[92:95], v[80:83], v[48:51], a[92:95]
s_waitcnt lgkmcnt(12)
v_mfma_f32_16x16x32_bf16 a[96:99], v[84:87], v[44:47], a[96:99]
ds_read_b64_tr_b16 v[80:81], v2 offset:49544
ds_read_b64_tr_b16 v[82:83], v2 offset:50056
v_mfma_f32_16x16x32_bf16 a[100:103], v[84:87], v[48:51], a[100:103]
s_waitcnt lgkmcnt(12)
v_mfma_f32_16x16x32_bf16 a[104:107], v[88:91], v[44:47], a[104:107]
ds_read_b64_tr_b16 v[84:85], v1 offset:50560
ds_read_b64_tr_b16 v[86:87], v1 offset:51072
v_mfma_f32_16x16x32_bf16 a[108:111], v[88:91], v[48:51], a[108:111]
s_waitcnt lgkmcnt(12)
v_mfma_f32_16x16x32_bf16 a[112:115], v[92:95], v[44:47], a[112:115]
ds_read_b64_tr_b16 v[88:89], v1 offset:50568
ds_read_b64_tr_b16 v[90:91], v1 offset:51080
v_mfma_f32_16x16x32_bf16 a[116:119], v[92:95], v[48:51], a[116:119]
s_waitcnt lgkmcnt(12)
v_mfma_f32_16x16x32_bf16 a[120:123], v[96:99], v[44:47], a[120:123]
ds_read_b64_tr_b16 v[92:93], v2 offset:50560
ds_read_b64_tr_b16 v[94:95], v2 offset:51072
v_mfma_f32_16x16x32_bf16 a[124:127], v[96:99], v[48:51], a[124:127]
s_waitcnt vmcnt(4)
s_barrier
s_waitcnt lgkmcnt(12)
ds_read_b64_tr_b16 v[96:97], v2 offset:50568
ds_read_b64_tr_b16 v[98:99], v2 offset:51080
v_mfma_f32_16x16x32_bf16 a[128:131], v[68:71], v[44:47], a[128:131]
s_add_u32 m0, s76, 33024
s_add_u32 s60, s60, 261376
v_mfma_f32_16x16x32_bf16 a[132:135], v[68:71], v[48:51], a[132:135]
s_waitcnt lgkmcnt(12)
s_add_u32 s68, s68, 261376
v_mfma_f32_16x16x32_bf16 a[136:139], v[72:75], v[44:47], a[136:139]
ds_read_b64_tr_b16 v[68:69], v1 offset:57792
ds_read_b64_tr_b16 v[70:71], v1 offset:58304
v_mfma_f32_16x16x32_bf16 a[140:143], v[72:75], v[48:51], a[140:143]
s_waitcnt lgkmcnt(12)
buffer_load_dwordx4 v54, s[40:43], s60 offen offset:0 lds
v_mfma_f32_16x16x32_bf16 a[144:147], v[76:79], v[44:47], a[144:147]
ds_read_b64_tr_b16 v[72:73], v1 offset:57800
ds_read_b64_tr_b16 v[74:75], v1 offset:58312
v_mfma_f32_16x16x32_bf16 a[148:151], v[76:79], v[48:51], a[148:151]
s_waitcnt lgkmcnt(12)
buffer_load_dwordx4 v54, s[40:43], s68 offen offset:1024 lds
v_mfma_f32_16x16x32_bf16 a[152:155], v[80:83], v[44:47], a[152:155]
ds_read_b64_tr_b16 v[76:77], v2 offset:57792
ds_read_b64_tr_b16 v[78:79], v2 offset:58304
v_mfma_f32_16x16x32_bf16 a[156:159], v[80:83], v[48:51], a[156:159]
s_waitcnt lgkmcnt(12)
s_add_u32 m0, s76, 41280
v_mfma_f32_16x16x32_bf16 a[160:163], v[84:87], v[44:47], a[160:163]
ds_read_b64_tr_b16 v[80:81], v2 offset:57800
ds_read_b64_tr_b16 v[82:83], v2 offset:58312
v_mfma_f32_16x16x32_bf16 a[164:167], v[84:87], v[48:51], a[164:167]
s_waitcnt lgkmcnt(12)
s_add_u32 s60, s60, 256
v_mfma_f32_16x16x32_bf16 a[168:171], v[88:91], v[44:47], a[168:171]
ds_read_b64_tr_b16 v[84:85], v1 offset:58816
ds_read_b64_tr_b16 v[86:87], v1 offset:59328
v_mfma_f32_16x16x32_bf16 a[172:175], v[88:91], v[48:51], a[172:175]
s_waitcnt lgkmcnt(12)
s_add_u32 s68, s68, 256
v_mfma_f32_16x16x32_bf16 a[176:179], v[92:95], v[44:47], a[176:179]
ds_read_b64_tr_b16 v[88:89], v1 offset:58824
ds_read_b64_tr_b16 v[90:91], v1 offset:59336
v_mfma_f32_16x16x32_bf16 a[180:183], v[92:95], v[48:51], a[180:183]
s_waitcnt lgkmcnt(12)
buffer_load_dwordx4 v54, s[40:43], s60 offen offset:0 lds
v_mfma_f32_16x16x32_bf16 a[184:187], v[96:99], v[44:47], a[184:187]
ds_read_b64_tr_b16 v[92:93], v2 offset:58816
ds_read_b64_tr_b16 v[94:95], v2 offset:59328
v_mfma_f32_16x16x32_bf16 a[188:191], v[96:99], v[48:51], a[188:191]
s_waitcnt lgkmcnt(12)
buffer_load_dwordx4 v54, s[40:43], s68 offen offset:1024 lds
v_mfma_f32_16x16x32_bf16 a[192:195], v[68:71], v[44:47], a[192:195]
ds_read_b64_tr_b16 v[96:97], v2 offset:58824
ds_read_b64_tr_b16 v[98:99], v2 offset:59336
v_mfma_f32_16x16x32_bf16 a[196:199], v[68:71], v[48:51], a[196:199]
s_waitcnt lgkmcnt(12)
v_mfma_f32_16x16x32_bf16 a[200:203], v[72:75], v[44:47], a[200:203]
ds_read_b128 v[36:39], v4 offset:17408
ds_read_b128 v[40:43], v4 offset:19584
ds_read_b64_tr_b16 v[68:69], v1 offset:0
ds_read_b64_tr_b16 v[70:71], v1 offset:512
v_mfma_f32_16x16x32_bf16 a[204:207], v[72:75], v[48:51], a[204:207]
s_waitcnt lgkmcnt(14)
v_mfma_f32_16x16x32_bf16 a[208:211], v[76:79], v[44:47], a[208:211]
ds_read_b64_tr_b16 v[72:73], v1 offset:8
ds_read_b64_tr_b16 v[74:75], v1 offset:520
v_mfma_f32_16x16x32_bf16 a[212:215], v[76:79], v[48:51], a[212:215]
s_waitcnt lgkmcnt(14)
v_mfma_f32_16x16x32_bf16 a[216:219], v[80:83], v[44:47], a[216:219]
ds_read_b64_tr_b16 v[76:77], v2 offset:0
ds_read_b64_tr_b16 v[78:79], v2 offset:512
v_mfma_f32_16x16x32_bf16 a[220:223], v[80:83], v[48:51], a[220:223]
s_waitcnt lgkmcnt(14)
v_mfma_f32_16x16x32_bf16 a[224:227], v[84:87], v[44:47], a[224:227]
ds_read_b64_tr_b16 v[80:81], v2 offset:8
ds_read_b64_tr_b16 v[82:83], v2 offset:520
v_mfma_f32_16x16x32_bf16 a[228:231], v[84:87], v[48:51], a[228:231]
s_waitcnt lgkmcnt(14)
v_mfma_f32_16x16x32_bf16 a[232:235], v[88:91], v[44:47], a[232:235]
ds_read_b64_tr_b16 v[84:85], v1 offset:1024
ds_read_b64_tr_b16 v[86:87], v1 offset:1536
v_mfma_f32_16x16x32_bf16 a[236:239], v[88:91], v[48:51], a[236:239]
s_waitcnt lgkmcnt(14)
v_mfma_f32_16x16x32_bf16 a[240:243], v[92:95], v[44:47], a[240:243]
ds_read_b64_tr_b16 v[88:89], v1 offset:1032
ds_read_b64_tr_b16 v[90:91], v1 offset:1544
v_mfma_f32_16x16x32_bf16 a[244:247], v[92:95], v[48:51], a[244:247]
s_waitcnt lgkmcnt(14)
v_mfma_f32_16x16x32_bf16 a[248:251], v[96:99], v[44:47], a[248:251]
ds_read_b64_tr_b16 v[92:93], v2 offset:1024
ds_read_b64_tr_b16 v[94:95], v2 offset:1536
v_mfma_f32_16x16x32_bf16 a[252:255], v[96:99], v[48:51], a[252:255]
s_waitcnt vmcnt(4)
s_barrier
s_waitcnt lgkmcnt(12)
ds_read_b64_tr_b16 v[96:97], v2 offset:1032
ds_read_b64_tr_b16 v[98:99], v2 offset:1544
v_mfma_f32_16x16x32_bf16 a[0:3], v[68:71], v[36:39], a[0:3]
s_add_u32 m0, s76, 49536
s_add_u32 s60, s60, 256
v_mfma_f32_16x16x32_bf16 a[4:7], v[68:71], v[40:43], a[4:7]
s_waitcnt lgkmcnt(12)
s_add_u32 s68, s68, 256
v_mfma_f32_16x16x32_bf16 a[8:11], v[72:75], v[36:39], a[8:11]
ds_read_b64_tr_b16 v[68:69], v1 offset:8256
ds_read_b64_tr_b16 v[70:71], v1 offset:8768
v_mfma_f32_16x16x32_bf16 a[12:15], v[72:75], v[40:43], a[12:15]
s_waitcnt lgkmcnt(12)
buffer_load_dwordx4 v54, s[40:43], s60 offen offset:0 lds
v_mfma_f32_16x16x32_bf16 a[16:19], v[76:79], v[36:39], a[16:19]
ds_read_b64_tr_b16 v[72:73], v1 offset:8264
ds_read_b64_tr_b16 v[74:75], v1 offset:8776
v_mfma_f32_16x16x32_bf16 a[20:23], v[76:79], v[40:43], a[20:23]
s_waitcnt lgkmcnt(12)
buffer_load_dwordx4 v54, s[40:43], s68 offen offset:1024 lds
v_mfma_f32_16x16x32_bf16 a[24:27], v[80:83], v[36:39], a[24:27]
ds_read_b64_tr_b16 v[76:77], v2 offset:8256
ds_read_b64_tr_b16 v[78:79], v2 offset:8768
v_mfma_f32_16x16x32_bf16 a[28:31], v[80:83], v[40:43], a[28:31]
s_waitcnt lgkmcnt(12)
s_add_u32 m0, s76, 57792
v_mfma_f32_16x16x32_bf16 a[32:35], v[84:87], v[36:39], a[32:35]
ds_read_b64_tr_b16 v[80:81], v2 offset:8264
ds_read_b64_tr_b16 v[82:83], v2 offset:8776
v_mfma_f32_16x16x32_bf16 a[36:39], v[84:87], v[40:43], a[36:39]
s_waitcnt lgkmcnt(12)
s_add_u32 s60, s60, 256
v_mfma_f32_16x16x32_bf16 a[40:43], v[88:91], v[36:39], a[40:43]
ds_read_b64_tr_b16 v[84:85], v1 offset:9280
ds_read_b64_tr_b16 v[86:87], v1 offset:9792
v_mfma_f32_16x16x32_bf16 a[44:47], v[88:91], v[40:43], a[44:47]
s_waitcnt lgkmcnt(12)
s_add_u32 s68, s68, 256
v_mfma_f32_16x16x32_bf16 a[48:51], v[92:95], v[36:39], a[48:51]
ds_read_b64_tr_b16 v[88:89], v1 offset:9288
ds_read_b64_tr_b16 v[90:91], v1 offset:9800
v_mfma_f32_16x16x32_bf16 a[52:55], v[92:95], v[40:43], a[52:55]
s_waitcnt lgkmcnt(12)
buffer_load_dwordx4 v54, s[40:43], s60 offen offset:0 lds
v_mfma_f32_16x16x32_bf16 a[56:59], v[96:99], v[36:39], a[56:59]
ds_read_b64_tr_b16 v[92:93], v2 offset:9280
ds_read_b64_tr_b16 v[94:95], v2 offset:9792
v_mfma_f32_16x16x32_bf16 a[60:63], v[96:99], v[40:43], a[60:63]
s_waitcnt lgkmcnt(12)
buffer_load_dwordx4 v54, s[40:43], s68 offen offset:1024 lds
v_mfma_f32_16x16x32_bf16 a[64:67], v[68:71], v[36:39], a[64:67]
ds_read_b64_tr_b16 v[96:97], v2 offset:9288
ds_read_b64_tr_b16 v[98:99], v2 offset:9800
v_mfma_f32_16x16x32_bf16 a[68:71], v[68:71], v[40:43], a[68:71]
s_waitcnt lgkmcnt(12)
s_add_u32 m0, s77, 66048
s_add_u32 s61, s61, 128
v_mfma_f32_16x16x32_bf16 a[72:75], v[72:75], v[36:39], a[72:75]
ds_read_b64_tr_b16 v[68:69], v1 offset:16512
ds_read_b64_tr_b16 v[70:71], v1 offset:17024
v_mfma_f32_16x16x32_bf16 a[76:79], v[72:75], v[40:43], a[76:79]
s_waitcnt lgkmcnt(12)
buffer_load_dwordx4 v55, s[44:47], s61 offen offset:0 lds
buffer_load_dwordx4 v56, s[44:47], s61 offen offset:1088 lds
v_mfma_f32_16x16x32_bf16 a[80:83], v[76:79], v[36:39], a[80:83]
ds_read_b64_tr_b16 v[72:73], v1 offset:16520
ds_read_b64_tr_b16 v[74:75], v1 offset:17032
v_mfma_f32_16x16x32_bf16 a[84:87], v[76:79], v[40:43], a[84:87]
s_waitcnt lgkmcnt(12)
buffer_load_dwordx4 v57, s[44:47], s61 offen offset:2176 lds
buffer_load_dwordx4 v58, s[44:47], s61 offen offset:3264 lds
v_mfma_f32_16x16x32_bf16 a[88:91], v[80:83], v[36:39], a[88:91]
ds_read_b64_tr_b16 v[76:77], v2 offset:16512
ds_read_b64_tr_b16 v[78:79], v2 offset:17024
v_mfma_f32_16x16x32_bf16 a[92:95], v[80:83], v[40:43], a[92:95]
s_waitcnt lgkmcnt(12)
v_mfma_f32_16x16x32_bf16 a[96:99], v[84:87], v[36:39], a[96:99]
ds_read_b64_tr_b16 v[80:81], v2 offset:16520
ds_read_b64_tr_b16 v[82:83], v2 offset:17032
v_mfma_f32_16x16x32_bf16 a[100:103], v[84:87], v[40:43], a[100:103]
s_waitcnt lgkmcnt(12)
v_mfma_f32_16x16x32_bf16 a[104:107], v[88:91], v[36:39], a[104:107]
ds_read_b64_tr_b16 v[84:85], v1 offset:17536
ds_read_b64_tr_b16 v[86:87], v1 offset:18048
v_mfma_f32_16x16x32_bf16 a[108:111], v[88:91], v[40:43], a[108:111]
s_waitcnt lgkmcnt(12)
v_mfma_f32_16x16x32_bf16 a[112:115], v[92:95], v[36:39], a[112:115]
ds_read_b64_tr_b16 v[88:89], v1 offset:17544
ds_read_b64_tr_b16 v[90:91], v1 offset:18056
v_mfma_f32_16x16x32_bf16 a[116:119], v[92:95], v[40:43], a[116:119]
s_waitcnt lgkmcnt(12)
v_mfma_f32_16x16x32_bf16 a[120:123], v[96:99], v[36:39], a[120:123]
ds_read_b64_tr_b16 v[92:93], v2 offset:17536
ds_read_b64_tr_b16 v[94:95], v2 offset:18048
v_mfma_f32_16x16x32_bf16 a[124:127], v[96:99], v[40:43], a[124:127]
s_waitcnt vmcnt(8)
s_barrier
s_waitcnt lgkmcnt(12)
ds_read_b64_tr_b16 v[96:97], v2 offset:17544
ds_read_b64_tr_b16 v[98:99], v2 offset:18056
v_mfma_f32_16x16x32_bf16 a[128:131], v[68:71], v[36:39], a[128:131]
s_add_u32 m0, s76, 0
s_add_u32 s60, s60, 261376
v_mfma_f32_16x16x32_bf16 a[132:135], v[68:71], v[40:43], a[132:135]
s_waitcnt lgkmcnt(12)
s_add_u32 s68, s68, 261376
v_mfma_f32_16x16x32_bf16 a[136:139], v[72:75], v[36:39], a[136:139]
ds_read_b64_tr_b16 v[68:69], v1 offset:24768
ds_read_b64_tr_b16 v[70:71], v1 offset:25280
v_mfma_f32_16x16x32_bf16 a[140:143], v[72:75], v[40:43], a[140:143]
s_waitcnt lgkmcnt(12)
buffer_load_dwordx4 v54, s[40:43], s60 offen offset:0 lds
v_mfma_f32_16x16x32_bf16 a[144:147], v[76:79], v[36:39], a[144:147]
ds_read_b64_tr_b16 v[72:73], v1 offset:24776
ds_read_b64_tr_b16 v[74:75], v1 offset:25288
v_mfma_f32_16x16x32_bf16 a[148:151], v[76:79], v[40:43], a[148:151]
s_waitcnt lgkmcnt(12)
buffer_load_dwordx4 v54, s[40:43], s68 offen offset:1024 lds
v_mfma_f32_16x16x32_bf16 a[152:155], v[80:83], v[36:39], a[152:155]
ds_read_b64_tr_b16 v[76:77], v2 offset:24768
ds_read_b64_tr_b16 v[78:79], v2 offset:25280
v_mfma_f32_16x16x32_bf16 a[156:159], v[80:83], v[40:43], a[156:159]
s_waitcnt lgkmcnt(12)
s_add_u32 m0, s76, 8256
v_mfma_f32_16x16x32_bf16 a[160:163], v[84:87], v[36:39], a[160:163]
ds_read_b64_tr_b16 v[80:81], v2 offset:24776
ds_read_b64_tr_b16 v[82:83], v2 offset:25288
v_mfma_f32_16x16x32_bf16 a[164:167], v[84:87], v[40:43], a[164:167]
s_waitcnt lgkmcnt(12)
s_add_u32 s60, s60, 256
v_mfma_f32_16x16x32_bf16 a[168:171], v[88:91], v[36:39], a[168:171]
ds_read_b64_tr_b16 v[84:85], v1 offset:25792
ds_read_b64_tr_b16 v[86:87], v1 offset:26304
v_mfma_f32_16x16x32_bf16 a[172:175], v[88:91], v[40:43], a[172:175]
s_waitcnt lgkmcnt(12)
s_add_u32 s68, s68, 256
v_mfma_f32_16x16x32_bf16 a[176:179], v[92:95], v[36:39], a[176:179]
ds_read_b64_tr_b16 v[88:89], v1 offset:25800
ds_read_b64_tr_b16 v[90:91], v1 offset:26312
v_mfma_f32_16x16x32_bf16 a[180:183], v[92:95], v[40:43], a[180:183]
s_waitcnt lgkmcnt(12)
buffer_load_dwordx4 v54, s[40:43], s60 offen offset:0 lds
v_mfma_f32_16x16x32_bf16 a[184:187], v[96:99], v[36:39], a[184:187]
ds_read_b64_tr_b16 v[92:93], v2 offset:25792
ds_read_b64_tr_b16 v[94:95], v2 offset:26304
v_mfma_f32_16x16x32_bf16 a[188:191], v[96:99], v[40:43], a[188:191]
s_waitcnt lgkmcnt(12)
buffer_load_dwordx4 v54, s[40:43], s68 offen offset:1024 lds
v_mfma_f32_16x16x32_bf16 a[192:195], v[68:71], v[36:39], a[192:195]
ds_read_b64_tr_b16 v[96:97], v2 offset:25800
ds_read_b64_tr_b16 v[98:99], v2 offset:26312
v_mfma_f32_16x16x32_bf16 a[196:199], v[68:71], v[40:43], a[196:199]
s_waitcnt lgkmcnt(12)
v_mfma_f32_16x16x32_bf16 a[200:203], v[72:75], v[36:39], a[200:203]
ds_read_b128 v[44:47], v4 offset:17472
ds_read_b128 v[48:51], v4 offset:19648
ds_read_b64_tr_b16 v[68:69], v1 offset:33024
ds_read_b64_tr_b16 v[70:71], v1 offset:33536
v_mfma_f32_16x16x32_bf16 a[204:207], v[72:75], v[40:43], a[204:207]
s_waitcnt lgkmcnt(14)
v_mfma_f32_16x16x32_bf16 a[208:211], v[76:79], v[36:39], a[208:211]
ds_read_b64_tr_b16 v[72:73], v1 offset:33032
ds_read_b64_tr_b16 v[74:75], v1 offset:33544
v_mfma_f32_16x16x32_bf16 a[212:215], v[76:79], v[40:43], a[212:215]
s_waitcnt lgkmcnt(14)
v_mfma_f32_16x16x32_bf16 a[216:219], v[80:83], v[36:39], a[216:219]
ds_read_b64_tr_b16 v[76:77], v2 offset:33024
ds_read_b64_tr_b16 v[78:79], v2 offset:33536
v_mfma_f32_16x16x32_bf16 a[220:223], v[80:83], v[40:43], a[220:223]
s_waitcnt lgkmcnt(14)
v_mfma_f32_16x16x32_bf16 a[224:227], v[84:87], v[36:39], a[224:227]
ds_read_b64_tr_b16 v[80:81], v2 offset:33032
ds_read_b64_tr_b16 v[82:83], v2 offset:33544
v_mfma_f32_16x16x32_bf16 a[228:231], v[84:87], v[40:43], a[228:231]
s_waitcnt lgkmcnt(14)
v_mfma_f32_16x16x32_bf16 a[232:235], v[88:91], v[36:39], a[232:235]
ds_read_b64_tr_b16 v[84:85], v1 offset:34048
ds_read_b64_tr_b16 v[86:87], v1 offset:34560
v_mfma_f32_16x16x32_bf16 a[236:239], v[88:91], v[40:43], a[236:239]
s_waitcnt lgkmcnt(14)
v_mfma_f32_16x16x32_bf16 a[240:243], v[92:95], v[36:39], a[240:243]
ds_read_b64_tr_b16 v[88:89], v1 offset:34056
ds_read_b64_tr_b16 v[90:91], v1 offset:34568
v_mfma_f32_16x16x32_bf16 a[244:247], v[92:95], v[40:43], a[244:247]
s_waitcnt lgkmcnt(14)
v_mfma_f32_16x16x32_bf16 a[248:251], v[96:99], v[36:39], a[248:251]
ds_read_b64_tr_b16 v[92:93], v2 offset:34048
ds_read_b64_tr_b16 v[94:95], v2 offset:34560
v_mfma_f32_16x16x32_bf16 a[252:255], v[96:99], v[40:43], a[252:255]
s_waitcnt vmcnt(8)
s_barrier
s_waitcnt lgkmcnt(12)
ds_read_b64_tr_b16 v[96:97], v2 offset:34056
ds_read_b64_tr_b16 v[98:99], v2 offset:34568
v_mfma_f32_16x16x32_bf16 a[0:3], v[68:71], v[44:47], a[0:3]
s_add_u32 m0, s76, 16512
s_add_u32 s60, s60, 256
v_mfma_f32_16x16x32_bf16 a[4:7], v[68:71], v[48:51], a[4:7]
s_waitcnt lgkmcnt(12)
s_add_u32 s68, s68, 256
v_mfma_f32_16x16x32_bf16 a[8:11], v[72:75], v[44:47], a[8:11]
ds_read_b64_tr_b16 v[68:69], v1 offset:41280
ds_read_b64_tr_b16 v[70:71], v1 offset:41792
v_mfma_f32_16x16x32_bf16 a[12:15], v[72:75], v[48:51], a[12:15]
s_waitcnt lgkmcnt(12)
buffer_load_dwordx4 v54, s[40:43], s60 offen offset:0 lds
v_mfma_f32_16x16x32_bf16 a[16:19], v[76:79], v[44:47], a[16:19]
ds_read_b64_tr_b16 v[72:73], v1 offset:41288
ds_read_b64_tr_b16 v[74:75], v1 offset:41800
v_mfma_f32_16x16x32_bf16 a[20:23], v[76:79], v[48:51], a[20:23]
s_waitcnt lgkmcnt(12)
buffer_load_dwordx4 v54, s[40:43], s68 offen offset:1024 lds
v_mfma_f32_16x16x32_bf16 a[24:27], v[80:83], v[44:47], a[24:27]
ds_read_b64_tr_b16 v[76:77], v2 offset:41280
ds_read_b64_tr_b16 v[78:79], v2 offset:41792
v_mfma_f32_16x16x32_bf16 a[28:31], v[80:83], v[48:51], a[28:31]
s_waitcnt lgkmcnt(12)
s_add_u32 m0, s76, 24768
v_mfma_f32_16x16x32_bf16 a[32:35], v[84:87], v[44:47], a[32:35]
ds_read_b64_tr_b16 v[80:81], v2 offset:41288
ds_read_b64_tr_b16 v[82:83], v2 offset:41800
v_mfma_f32_16x16x32_bf16 a[36:39], v[84:87], v[48:51], a[36:39]
s_waitcnt lgkmcnt(12)
s_add_u32 s60, s60, 256
v_mfma_f32_16x16x32_bf16 a[40:43], v[88:91], v[44:47], a[40:43]
ds_read_b64_tr_b16 v[84:85], v1 offset:42304
ds_read_b64_tr_b16 v[86:87], v1 offset:42816
v_mfma_f32_16x16x32_bf16 a[44:47], v[88:91], v[48:51], a[44:47]
s_waitcnt lgkmcnt(12)
s_add_u32 s68, s68, 256
v_mfma_f32_16x16x32_bf16 a[48:51], v[92:95], v[44:47], a[48:51]
ds_read_b64_tr_b16 v[88:89], v1 offset:42312
ds_read_b64_tr_b16 v[90:91], v1 offset:42824
v_mfma_f32_16x16x32_bf16 a[52:55], v[92:95], v[48:51], a[52:55]
s_waitcnt lgkmcnt(12)
buffer_load_dwordx4 v54, s[40:43], s60 offen offset:0 lds
v_mfma_f32_16x16x32_bf16 a[56:59], v[96:99], v[44:47], a[56:59]
ds_read_b64_tr_b16 v[92:93], v2 offset:42304
ds_read_b64_tr_b16 v[94:95], v2 offset:42816
v_mfma_f32_16x16x32_bf16 a[60:63], v[96:99], v[48:51], a[60:63]
s_waitcnt lgkmcnt(12)
buffer_load_dwordx4 v54, s[40:43], s68 offen offset:1024 lds
v_mfma_f32_16x16x32_bf16 a[64:67], v[68:71], v[44:47], a[64:67]
ds_read_b64_tr_b16 v[96:97], v2 offset:42312
ds_read_b64_tr_b16 v[98:99], v2 offset:42824
v_mfma_f32_16x16x32_bf16 a[68:71], v[68:71], v[48:51], a[68:71]
s_waitcnt lgkmcnt(12)
v_mfma_f32_16x16x32_bf16 a[72:75], v[72:75], v[44:47], a[72:75]
ds_read_b64_tr_b16 v[68:69], v1 offset:49536
ds_read_b64_tr_b16 v[70:71], v1 offset:50048
v_mfma_f32_16x16x32_bf16 a[76:79], v[72:75], v[48:51], a[76:79]
s_waitcnt lgkmcnt(12)
v_mfma_f32_16x16x32_bf16 a[80:83], v[76:79], v[44:47], a[80:83]
ds_read_b64_tr_b16 v[72:73], v1 offset:49544
ds_read_b64_tr_b16 v[74:75], v1 offset:50056
v_mfma_f32_16x16x32_bf16 a[84:87], v[76:79], v[48:51], a[84:87]
s_waitcnt lgkmcnt(12)
v_mfma_f32_16x16x32_bf16 a[88:91], v[80:83], v[44:47], a[88:91]
ds_read_b64_tr_b16 v[76:77], v2 offset:49536
ds_read_b64_tr_b16 v[78:79], v2 offset:50048
v_mfma_f32_16x16x32_bf16 a[92:95], v[80:83], v[48:51], a[92:95]
s_waitcnt lgkmcnt(12)
v_mfma_f32_16x16x32_bf16 a[96:99], v[84:87], v[44:47], a[96:99]
ds_read_b64_tr_b16 v[80:81], v2 offset:49544
ds_read_b64_tr_b16 v[82:83], v2 offset:50056
v_mfma_f32_16x16x32_bf16 a[100:103], v[84:87], v[48:51], a[100:103]
s_waitcnt lgkmcnt(12)
v_mfma_f32_16x16x32_bf16 a[104:107], v[88:91], v[44:47], a[104:107]
ds_read_b64_tr_b16 v[84:85], v1 offset:50560
ds_read_b64_tr_b16 v[86:87], v1 offset:51072
v_mfma_f32_16x16x32_bf16 a[108:111], v[88:91], v[48:51], a[108:111]
s_waitcnt lgkmcnt(12)
v_mfma_f32_16x16x32_bf16 a[112:115], v[92:95], v[44:47], a[112:115]
ds_read_b64_tr_b16 v[88:89], v1 offset:50568
ds_read_b64_tr_b16 v[90:91], v1 offset:51080
v_mfma_f32_16x16x32_bf16 a[116:119], v[92:95], v[48:51], a[116:119]
s_waitcnt lgkmcnt(12)
v_mfma_f32_16x16x32_bf16 a[120:123], v[96:99], v[44:47], a[120:123]
ds_read_b64_tr_b16 v[92:93], v2 offset:50560
ds_read_b64_tr_b16 v[94:95], v2 offset:51072
v_mfma_f32_16x16x32_bf16 a[124:127], v[96:99], v[48:51], a[124:127]
s_waitcnt vmcnt(4)
s_barrier
s_waitcnt lgkmcnt(12)
ds_read_b64_tr_b16 v[96:97], v2 offset:50568
ds_read_b64_tr_b16 v[98:99], v2 offset:51080
v_mfma_f32_16x16x32_bf16 a[128:131], v[68:71], v[44:47], a[128:131]
s_add_u32 m0, s76, 33024
s_add_u32 s60, s60, 261376
v_mfma_f32_16x16x32_bf16 a[132:135], v[68:71], v[48:51], a[132:135]
s_waitcnt lgkmcnt(12)
s_add_u32 s68, s68, 261376
v_mfma_f32_16x16x32_bf16 a[136:139], v[72:75], v[44:47], a[136:139]
ds_read_b64_tr_b16 v[68:69], v1 offset:57792
ds_read_b64_tr_b16 v[70:71], v1 offset:58304
v_mfma_f32_16x16x32_bf16 a[140:143], v[72:75], v[48:51], a[140:143]
s_waitcnt lgkmcnt(12)
buffer_load_dwordx4 v54, s[40:43], s60 offen offset:0 lds
v_mfma_f32_16x16x32_bf16 a[144:147], v[76:79], v[44:47], a[144:147]
ds_read_b64_tr_b16 v[72:73], v1 offset:57800
ds_read_b64_tr_b16 v[74:75], v1 offset:58312
v_mfma_f32_16x16x32_bf16 a[148:151], v[76:79], v[48:51], a[148:151]
s_waitcnt lgkmcnt(12)
buffer_load_dwordx4 v54, s[40:43], s68 offen offset:1024 lds
v_mfma_f32_16x16x32_bf16 a[152:155], v[80:83], v[44:47], a[152:155]
ds_read_b64_tr_b16 v[76:77], v2 offset:57792
ds_read_b64_tr_b16 v[78:79], v2 offset:58304
v_mfma_f32_16x16x32_bf16 a[156:159], v[80:83], v[48:51], a[156:159]
s_waitcnt lgkmcnt(12)
s_add_u32 m0, s76, 41280
v_mfma_f32_16x16x32_bf16 a[160:163], v[84:87], v[44:47], a[160:163]
ds_read_b64_tr_b16 v[80:81], v2 offset:57800
ds_read_b64_tr_b16 v[82:83], v2 offset:58312
v_mfma_f32_16x16x32_bf16 a[164:167], v[84:87], v[48:51], a[164:167]
s_waitcnt lgkmcnt(12)
s_add_u32 s60, s60, 256
v_mfma_f32_16x16x32_bf16 a[168:171], v[88:91], v[44:47], a[168:171]
ds_read_b64_tr_b16 v[84:85], v1 offset:58816
ds_read_b64_tr_b16 v[86:87], v1 offset:59328
v_mfma_f32_16x16x32_bf16 a[172:175], v[88:91], v[48:51], a[172:175]
s_waitcnt lgkmcnt(12)
s_add_u32 s68, s68, 256
v_mfma_f32_16x16x32_bf16 a[176:179], v[92:95], v[44:47], a[176:179]
ds_read_b64_tr_b16 v[88:89], v1 offset:58824
ds_read_b64_tr_b16 v[90:91], v1 offset:59336
v_mfma_f32_16x16x32_bf16 a[180:183], v[92:95], v[48:51], a[180:183]
s_waitcnt lgkmcnt(12)
buffer_load_dwordx4 v54, s[40:43], s60 offen offset:0 lds
v_mfma_f32_16x16x32_bf16 a[184:187], v[96:99], v[44:47], a[184:187]
ds_read_b64_tr_b16 v[92:93], v2 offset:58816
ds_read_b64_tr_b16 v[94:95], v2 offset:59328
v_mfma_f32_16x16x32_bf16 a[188:191], v[96:99], v[48:51], a[188:191]
s_waitcnt lgkmcnt(12)
buffer_load_dwordx4 v54, s[40:43], s68 offen offset:1024 lds
v_mfma_f32_16x16x32_bf16 a[192:195], v[68:71], v[44:47], a[192:195]
ds_read_b64_tr_b16 v[96:97], v2 offset:58824
ds_read_b64_tr_b16 v[98:99], v2 offset:59336
v_mfma_f32_16x16x32_bf16 a[196:199], v[68:71], v[48:51], a[196:199]
s_waitcnt lgkmcnt(12)
v_mfma_f32_16x16x32_bf16 a[200:203], v[72:75], v[44:47], a[200:203]
ds_read_b128 v[36:39], v4 offset:0
ds_read_b128 v[40:43], v4 offset:2176
ds_read_b64_tr_b16 v[68:69], v1 offset:0
ds_read_b64_tr_b16 v[70:71], v1 offset:512
v_mfma_f32_16x16x32_bf16 a[204:207], v[72:75], v[48:51], a[204:207]
s_waitcnt lgkmcnt(14)
v_mfma_f32_16x16x32_bf16 a[208:211], v[76:79], v[44:47], a[208:211]
ds_read_b64_tr_b16 v[72:73], v1 offset:8
ds_read_b64_tr_b16 v[74:75], v1 offset:520
v_mfma_f32_16x16x32_bf16 a[212:215], v[76:79], v[48:51], a[212:215]
s_waitcnt lgkmcnt(14)
v_mfma_f32_16x16x32_bf16 a[216:219], v[80:83], v[44:47], a[216:219]
ds_read_b64_tr_b16 v[76:77], v2 offset:0
ds_read_b64_tr_b16 v[78:79], v2 offset:512
v_mfma_f32_16x16x32_bf16 a[220:223], v[80:83], v[48:51], a[220:223]
s_waitcnt lgkmcnt(14)
v_mfma_f32_16x16x32_bf16 a[224:227], v[84:87], v[44:47], a[224:227]
ds_read_b64_tr_b16 v[80:81], v2 offset:8
ds_read_b64_tr_b16 v[82:83], v2 offset:520
v_mfma_f32_16x16x32_bf16 a[228:231], v[84:87], v[48:51], a[228:231]
s_waitcnt lgkmcnt(14)
v_mfma_f32_16x16x32_bf16 a[232:235], v[88:91], v[44:47], a[232:235]
ds_read_b64_tr_b16 v[84:85], v1 offset:1024
ds_read_b64_tr_b16 v[86:87], v1 offset:1536
v_mfma_f32_16x16x32_bf16 a[236:239], v[88:91], v[48:51], a[236:239]
s_waitcnt lgkmcnt(14)
v_mfma_f32_16x16x32_bf16 a[240:243], v[92:95], v[44:47], a[240:243]
ds_read_b64_tr_b16 v[88:89], v1 offset:1032
ds_read_b64_tr_b16 v[90:91], v1 offset:1544
v_mfma_f32_16x16x32_bf16 a[244:247], v[92:95], v[48:51], a[244:247]
s_waitcnt lgkmcnt(14)
v_mfma_f32_16x16x32_bf16 a[248:251], v[96:99], v[44:47], a[248:251]
ds_read_b64_tr_b16 v[92:93], v2 offset:1024
ds_read_b64_tr_b16 v[94:95], v2 offset:1536
v_mfma_f32_16x16x32_bf16 a[252:255], v[96:99], v[48:51], a[252:255]
s_waitcnt vmcnt(4)
s_barrier
s_waitcnt lgkmcnt(12)
ds_read_b64_tr_b16 v[96:97], v2 offset:1032
ds_read_b64_tr_b16 v[98:99], v2 offset:1544
v_mfma_f32_16x16x32_bf16 a[0:3], v[68:71], v[36:39], a[0:3]
s_add_u32 m0, s76, 49536
s_add_u32 s60, s60, 256
v_mfma_f32_16x16x32_bf16 a[4:7], v[68:71], v[40:43], a[4:7]
s_waitcnt lgkmcnt(12)
s_add_u32 s68, s68, 256
v_mfma_f32_16x16x32_bf16 a[8:11], v[72:75], v[36:39], a[8:11]
ds_read_b64_tr_b16 v[68:69], v1 offset:8256
ds_read_b64_tr_b16 v[70:71], v1 offset:8768
v_mfma_f32_16x16x32_bf16 a[12:15], v[72:75], v[40:43], a[12:15]
s_waitcnt lgkmcnt(12)
buffer_load_dwordx4 v54, s[40:43], s60 offen offset:0 lds
v_mfma_f32_16x16x32_bf16 a[16:19], v[76:79], v[36:39], a[16:19]
ds_read_b64_tr_b16 v[72:73], v1 offset:8264
ds_read_b64_tr_b16 v[74:75], v1 offset:8776
v_mfma_f32_16x16x32_bf16 a[20:23], v[76:79], v[40:43], a[20:23]
s_waitcnt lgkmcnt(12)
buffer_load_dwordx4 v54, s[40:43], s68 offen offset:1024 lds
v_mfma_f32_16x16x32_bf16 a[24:27], v[80:83], v[36:39], a[24:27]
ds_read_b64_tr_b16 v[76:77], v2 offset:8256
ds_read_b64_tr_b16 v[78:79], v2 offset:8768
v_mfma_f32_16x16x32_bf16 a[28:31], v[80:83], v[40:43], a[28:31]
s_waitcnt lgkmcnt(12)
s_add_u32 m0, s76, 57792
v_mfma_f32_16x16x32_bf16 a[32:35], v[84:87], v[36:39], a[32:35]
ds_read_b64_tr_b16 v[80:81], v2 offset:8264
ds_read_b64_tr_b16 v[82:83], v2 offset:8776
v_mfma_f32_16x16x32_bf16 a[36:39], v[84:87], v[40:43], a[36:39]
s_waitcnt lgkmcnt(12)
s_add_u32 s60, s60, 256
v_mfma_f32_16x16x32_bf16 a[40:43], v[88:91], v[36:39], a[40:43]
ds_read_b64_tr_b16 v[84:85], v1 offset:9280
ds_read_b64_tr_b16 v[86:87], v1 offset:9792
v_mfma_f32_16x16x32_bf16 a[44:47], v[88:91], v[40:43], a[44:47]
s_waitcnt lgkmcnt(12)
s_add_u32 s68, s68, 256
v_mfma_f32_16x16x32_bf16 a[48:51], v[92:95], v[36:39], a[48:51]
ds_read_b64_tr_b16 v[88:89], v1 offset:9288
ds_read_b64_tr_b16 v[90:91], v1 offset:9800
v_mfma_f32_16x16x32_bf16 a[52:55], v[92:95], v[40:43], a[52:55]
s_waitcnt lgkmcnt(12)
buffer_load_dwordx4 v54, s[40:43], s60 offen offset:0 lds
v_mfma_f32_16x16x32_bf16 a[56:59], v[96:99], v[36:39], a[56:59]
ds_read_b64_tr_b16 v[92:93], v2 offset:9280
ds_read_b64_tr_b16 v[94:95], v2 offset:9792
v_mfma_f32_16x16x32_bf16 a[60:63], v[96:99], v[40:43], a[60:63]
s_waitcnt lgkmcnt(12)
buffer_load_dwordx4 v54, s[40:43], s68 offen offset:1024 lds
v_mfma_f32_16x16x32_bf16 a[64:67], v[68:71], v[36:39], a[64:67]
ds_read_b64_tr_b16 v[96:97], v2 offset:9288
ds_read_b64_tr_b16 v[98:99], v2 offset:9800
v_mfma_f32_16x16x32_bf16 a[68:71], v[68:71], v[40:43], a[68:71]
s_waitcnt lgkmcnt(12)
s_add_u32 m0, s77, 83456
s_add_u32 s61, s61, 128
v_mfma_f32_16x16x32_bf16 a[72:75], v[72:75], v[36:39], a[72:75]
ds_read_b64_tr_b16 v[68:69], v1 offset:16512
ds_read_b64_tr_b16 v[70:71], v1 offset:17024
v_mfma_f32_16x16x32_bf16 a[76:79], v[72:75], v[40:43], a[76:79]
s_waitcnt lgkmcnt(12)
buffer_load_dwordx4 v55, s[44:47], s61 offen offset:0 lds
buffer_load_dwordx4 v56, s[44:47], s61 offen offset:1088 lds
v_mfma_f32_16x16x32_bf16 a[80:83], v[76:79], v[36:39], a[80:83]
ds_read_b64_tr_b16 v[72:73], v1 offset:16520
ds_read_b64_tr_b16 v[74:75], v1 offset:17032
v_mfma_f32_16x16x32_bf16 a[84:87], v[76:79], v[40:43], a[84:87]
s_waitcnt lgkmcnt(12)
buffer_load_dwordx4 v57, s[44:47], s61 offen offset:2176 lds
buffer_load_dwordx4 v58, s[44:47], s61 offen offset:3264 lds
v_mfma_f32_16x16x32_bf16 a[88:91], v[80:83], v[36:39], a[88:91]
ds_read_b64_tr_b16 v[76:77], v2 offset:16512
ds_read_b64_tr_b16 v[78:79], v2 offset:17024
v_mfma_f32_16x16x32_bf16 a[92:95], v[80:83], v[40:43], a[92:95]
s_waitcnt lgkmcnt(12)
v_mfma_f32_16x16x32_bf16 a[96:99], v[84:87], v[36:39], a[96:99]
ds_read_b64_tr_b16 v[80:81], v2 offset:16520
ds_read_b64_tr_b16 v[82:83], v2 offset:17032
v_mfma_f32_16x16x32_bf16 a[100:103], v[84:87], v[40:43], a[100:103]
s_waitcnt lgkmcnt(12)
v_mfma_f32_16x16x32_bf16 a[104:107], v[88:91], v[36:39], a[104:107]
ds_read_b64_tr_b16 v[84:85], v1 offset:17536
ds_read_b64_tr_b16 v[86:87], v1 offset:18048
v_mfma_f32_16x16x32_bf16 a[108:111], v[88:91], v[40:43], a[108:111]
s_waitcnt lgkmcnt(12)
v_mfma_f32_16x16x32_bf16 a[112:115], v[92:95], v[36:39], a[112:115]
ds_read_b64_tr_b16 v[88:89], v1 offset:17544
ds_read_b64_tr_b16 v[90:91], v1 offset:18056
v_mfma_f32_16x16x32_bf16 a[116:119], v[92:95], v[40:43], a[116:119]
s_waitcnt lgkmcnt(12)
v_mfma_f32_16x16x32_bf16 a[120:123], v[96:99], v[36:39], a[120:123]
ds_read_b64_tr_b16 v[92:93], v2 offset:17536
ds_read_b64_tr_b16 v[94:95], v2 offset:18048
v_mfma_f32_16x16x32_bf16 a[124:127], v[96:99], v[40:43], a[124:127]
s_sub_u32 s39, s39, 1
s_cmp_lg_u32 s39, 0
s_cbranch_scc1 L_loop1
s_waitcnt vmcnt(8)
s_barrier
s_waitcnt lgkmcnt(12)
ds_read_b64_tr_b16 v[96:97], v2 offset:17544
ds_read_b64_tr_b16 v[98:99], v2 offset:18056
v_mfma_f32_16x16x32_bf16 a[128:131], v[68:71], v[36:39], a[128:131]
s_add_u32 m0, s76, 0
s_add_u32 s60, s60, 261376
v_mfma_f32_16x16x32_bf16 a[132:135], v[68:71], v[40:43], a[132:135]
s_waitcnt lgkmcnt(12)
s_add_u32 s68, s68, 261376
v_mfma_f32_16x16x32_bf16 a[136:139], v[72:75], v[36:39], a[136:139]
ds_read_b64_tr_b16 v[68:69], v1 offset:24768
ds_read_b64_tr_b16 v[70:71], v1 offset:25280
v_mfma_f32_16x16x32_bf16 a[140:143], v[72:75], v[40:43], a[140:143]
s_waitcnt lgkmcnt(12)
buffer_load_dwordx4 v54, s[40:43], s60 offen offset:0 lds
v_mfma_f32_16x16x32_bf16 a[144:147], v[76:79], v[36:39], a[144:147]
ds_read_b64_tr_b16 v[72:73], v1 offset:24776
ds_read_b64_tr_b16 v[74:75], v1 offset:25288
v_mfma_f32_16x16x32_bf16 a[148:151], v[76:79], v[40:43], a[148:151]
s_waitcnt lgkmcnt(12)
buffer_load_dwordx4 v54, s[40:43], s68 offen offset:1024 lds
v_mfma_f32_16x16x32_bf16 a[152:155], v[80:83], v[36:39], a[152:155]
ds_read_b64_tr_b16 v[76:77], v2 offset:24768
ds_read_b64_tr_b16 v[78:79], v2 offset:25280
v_mfma_f32_16x16x32_bf16 a[156:159], v[80:83], v[40:43], a[156:159]
s_waitcnt lgkmcnt(12)
s_add_u32 m0, s76, 8256
v_mfma_f32_16x16x32_bf16 a[160:163], v[84:87], v[36:39], a[160:163]
ds_read_b64_tr_b16 v[80:81], v2 offset:24776
ds_read_b64_tr_b16 v[82:83], v2 offset:25288
v_mfma_f32_16x16x32_bf16 a[164:167], v[84:87], v[40:43], a[164:167]
s_waitcnt lgkmcnt(12)
s_add_u32 s60, s60, 256
v_mfma_f32_16x16x32_bf16 a[168:171], v[88:91], v[36:39], a[168:171]
ds_read_b64_tr_b16 v[84:85], v1 offset:25792
ds_read_b64_tr_b16 v[86:87], v1 offset:26304
v_mfma_f32_16x16x32_bf16 a[172:175], v[88:91], v[40:43], a[172:175]
s_waitcnt lgkmcnt(12)
s_add_u32 s68, s68, 256
v_mfma_f32_16x16x32_bf16 a[176:179], v[92:95], v[36:39], a[176:179]
ds_read_b64_tr_b16 v[88:89], v1 offset:25800
ds_read_b64_tr_b16 v[90:91], v1 offset:26312
v_mfma_f32_16x16x32_bf16 a[180:183], v[92:95], v[40:43], a[180:183]
s_waitcnt lgkmcnt(12)
buffer_load_dwordx4 v54, s[40:43], s60 offen offset:0 lds
v_mfma_f32_16x16x32_bf16 a[184:187], v[96:99], v[36:39], a[184:187]
ds_read_b64_tr_b16 v[92:93], v2 offset:25792
ds_read_b64_tr_b16 v[94:95], v2 offset:26304
v_mfma_f32_16x16x32_bf16 a[188:191], v[96:99], v[40:43], a[188:191]
s_waitcnt lgkmcnt(12)
buffer_load_dwordx4 v54, s[40:43], s68 offen offset:1024 lds
v_mfma_f32_16x16x32_bf16 a[192:195], v[68:71], v[36:39], a[192:195]
ds_read_b64_tr_b16 v[96:97], v2 offset:25800
ds_read_b64_tr_b16 v[98:99], v2 offset:26312
v_mfma_f32_16x16x32_bf16 a[196:199], v[68:71], v[40:43], a[196:199]
s_waitcnt lgkmcnt(12)
v_mfma_f32_16x16x32_bf16 a[200:203], v[72:75], v[36:39], a[200:203]
ds_read_b128 v[44:47], v4 offset:64
ds_read_b128 v[48:51], v4 offset:2240
ds_read_b64_tr_b16 v[68:69], v1 offset:33024
ds_read_b64_tr_b16 v[70:71], v1 offset:33536
v_mfma_f32_16x16x32_bf16 a[204:207], v[72:75], v[40:43], a[204:207]
s_waitcnt lgkmcnt(14)
v_mfma_f32_16x16x32_bf16 a[208:211], v[76:79], v[36:39], a[208:211]
ds_read_b64_tr_b16 v[72:73], v1 offset:33032
ds_read_b64_tr_b16 v[74:75], v1 offset:33544
v_mfma_f32_16x16x32_bf16 a[212:215], v[76:79], v[40:43], a[212:215]
s_waitcnt lgkmcnt(14)
v_mfma_f32_16x16x32_bf16 a[216:219], v[80:83], v[36:39], a[216:219]
ds_read_b64_tr_b16 v[76:77], v2 offset:33024
ds_read_b64_tr_b16 v[78:79], v2 offset:33536
v_mfma_f32_16x16x32_bf16 a[220:223], v[80:83], v[40:43], a[220:223]
s_waitcnt lgkmcnt(14)
v_mfma_f32_16x16x32_bf16 a[224:227], v[84:87], v[36:39], a[224:227]
ds_read_b64_tr_b16 v[80:81], v2 offset:33032
ds_read_b64_tr_b16 v[82:83], v2 offset:33544
v_mfma_f32_16x16x32_bf16 a[228:231], v[84:87], v[40:43], a[228:231]
s_waitcnt lgkmcnt(14)
v_mfma_f32_16x16x32_bf16 a[232:235], v[88:91], v[36:39], a[232:235]
ds_read_b64_tr_b16 v[84:85], v1 offset:34048
ds_read_b64_tr_b16 v[86:87], v1 offset:34560
v_mfma_f32_16x16x32_bf16 a[236:239], v[88:91], v[40:43], a[236:239]
s_waitcnt lgkmcnt(14)
v_mfma_f32_16x16x32_bf16 a[240:243], v[92:95], v[36:39], a[240:243]
ds_read_b64_tr_b16 v[88:89], v1 offset:34056
ds_read_b64_tr_b16 v[90:91], v1 offset:34568
v_mfma_f32_16x16x32_bf16 a[244:247], v[92:95], v[40:43], a[244:247]
s_waitcnt lgkmcnt(14)
v_mfma_f32_16x16x32_bf16 a[248:251], v[96:99], v[36:39], a[248:251]
ds_read_b64_tr_b16 v[92:93], v2 offset:34048
ds_read_b64_tr_b16 v[94:95], v2 offset:34560
v_mfma_f32_16x16x32_bf16 a[252:255], v[96:99], v[40:43], a[252:255]
s_waitcnt vmcnt(8)
s_barrier
s_waitcnt lgkmcnt(12)
ds_read_b64_tr_b16 v[96:97], v2 offset:34056
ds_read_b64_tr_b16 v[98:99], v2 offset:34568
v_mfma_f32_16x16x32_bf16 a[0:3], v[68:71], v[44:47], a[0:3]
s_add_u32 m0, s76, 16512
s_add_u32 s60, s60, 256
v_mfma_f32_16x16x32_bf16 a[4:7], v[68:71], v[48:51], a[4:7]
s_waitcnt lgkmcnt(12)
s_add_u32 s68, s68, 256
v_mfma_f32_16x16x32_bf16 a[8:11], v[72:75], v[44:47], a[8:11]
ds_read_b64_tr_b16 v[68:69], v1 offset:41280
ds_read_b64_tr_b16 v[70:71], v1 offset:41792
v_mfma_f32_16x16x32_bf16 a[12:15], v[72:75], v[48:51], a[12:15]
s_waitcnt lgkmcnt(12)
buffer_load_dwordx4 v54, s[40:43], s60 offen offset:0 lds
v_mfma_f32_16x16x32_bf16 a[16:19], v[76:79], v[44:47], a[16:19]
ds_read_b64_tr_b16 v[72:73], v1 offset:41288
ds_read_b64_tr_b16 v[74:75], v1 offset:41800
v_mfma_f32_16x16x32_bf16 a[20:23], v[76:79], v[48:51], a[20:23]
s_waitcnt lgkmcnt(12)
buffer_load_dwordx4 v54, s[40:43], s68 offen offset:1024 lds
v_mfma_f32_16x16x32_bf16 a[24:27], v[80:83], v[44:47], a[24:27]
ds_read_b64_tr_b16 v[76:77], v2 offset:41280
ds_read_b64_tr_b16 v[78:79], v2 offset:41792
v_mfma_f32_16x16x32_bf16 a[28:31], v[80:83], v[48:51], a[28:31]
s_waitcnt lgkmcnt(12)
s_add_u32 m0, s76, 24768
v_mfma_f32_16x16x32_bf16 a[32:35], v[84:87], v[44:47], a[32:35]
ds_read_b64_tr_b16 v[80:81], v2 offset:41288
ds_read_b64_tr_b16 v[82:83], v2 offset:41800
v_mfma_f32_16x16x32_bf16 a[36:39], v[84:87], v[48:51], a[36:39]
s_waitcnt lgkmcnt(12)
s_add_u32 s60, s60, 256
v_mfma_f32_16x16x32_bf16 a[40:43], v[88:91], v[44:47], a[40:43]
ds_read_b64_tr_b16 v[84:85], v1 offset:42304
ds_read_b64_tr_b16 v[86:87], v1 offset:42816
v_mfma_f32_16x16x32_bf16 a[44:47], v[88:91], v[48:51], a[44:47]
s_waitcnt lgkmcnt(12)
s_add_u32 s68, s68, 256
v_mfma_f32_16x16x32_bf16 a[48:51], v[92:95], v[44:47], a[48:51]
ds_read_b64_tr_b16 v[88:89], v1 offset:42312
ds_read_b64_tr_b16 v[90:91], v1 offset:42824
v_mfma_f32_16x16x32_bf16 a[52:55], v[92:95], v[48:51], a[52:55]
s_waitcnt lgkmcnt(12)
buffer_load_dwordx4 v54, s[40:43], s60 offen offset:0 lds
v_mfma_f32_16x16x32_bf16 a[56:59], v[96:99], v[44:47], a[56:59]
ds_read_b64_tr_b16 v[92:93], v2 offset:42304
ds_read_b64_tr_b16 v[94:95], v2 offset:42816
v_mfma_f32_16x16x32_bf16 a[60:63], v[96:99], v[48:51], a[60:63]
s_waitcnt lgkmcnt(12)
buffer_load_dwordx4 v54, s[40:43], s68 offen offset:1024 lds
v_mfma_f32_16x16x32_bf16 a[64:67], v[68:71], v[44:47], a[64:67]
ds_read_b64_tr_b16 v[96:97], v2 offset:42312
ds_read_b64_tr_b16 v[98:99], v2 offset:42824
v_mfma_f32_16x16x32_bf16 a[68:71], v[68:71], v[48:51], a[68:71]
s_waitcnt lgkmcnt(12)
v_mfma_f32_16x16x32_bf16 a[72:75], v[72:75], v[44:47], a[72:75]
ds_read_b64_tr_b16 v[68:69], v1 offset:49536
ds_read_b64_tr_b16 v[70:71], v1 offset:50048
v_mfma_f32_16x16x32_bf16 a[76:79], v[72:75], v[48:51], a[76:79]
s_waitcnt lgkmcnt(12)
v_mfma_f32_16x16x32_bf16 a[80:83], v[76:79], v[44:47], a[80:83]
ds_read_b64_tr_b16 v[72:73], v1 offset:49544
ds_read_b64_tr_b16 v[74:75], v1 offset:50056
v_mfma_f32_16x16x32_bf16 a[84:87], v[76:79], v[48:51], a[84:87]
s_waitcnt lgkmcnt(12)
v_mfma_f32_16x16x32_bf16 a[88:91], v[80:83], v[44:47], a[88:91]
ds_read_b64_tr_b16 v[76:77], v2 offset:49536
ds_read_b64_tr_b16 v[78:79], v2 offset:50048
v_mfma_f32_16x16x32_bf16 a[92:95], v[80:83], v[48:51], a[92:95]
s_waitcnt lgkmcnt(12)
v_mfma_f32_16x16x32_bf16 a[96:99], v[84:87], v[44:47], a[96:99]
ds_read_b64_tr_b16 v[80:81], v2 offset:49544
ds_read_b64_tr_b16 v[82:83], v2 offset:50056
v_mfma_f32_16x16x32_bf16 a[100:103], v[84:87], v[48:51], a[100:103]
s_waitcnt lgkmcnt(12)
v_mfma_f32_16x16x32_bf16 a[104:107], v[88:91], v[44:47], a[104:107]
ds_read_b64_tr_b16 v[84:85], v1 offset:50560
ds_read_b64_tr_b16 v[86:87], v1 offset:51072
v_mfma_f32_16x16x32_bf16 a[108:111], v[88:91], v[48:51], a[108:111]
s_waitcnt lgkmcnt(12)
v_mfma_f32_16x16x32_bf16 a[112:115], v[92:95], v[44:47], a[112:115]
ds_read_b64_tr_b16 v[88:89], v1 offset:50568
ds_read_b64_tr_b16 v[90:91], v1 offset:51080
v_mfma_f32_16x16x32_bf16 a[116:119], v[92:95], v[48:51], a[116:119]
s_waitcnt lgkmcnt(12)
v_mfma_f32_16x16x32_bf16 a[120:123], v[96:99], v[44:47], a[120:123]
ds_read_b64_tr_b16 v[92:93], v2 offset:50560
ds_read_b64_tr_b16 v[94:95], v2 offset:51072
v_mfma_f32_16x16x32_bf16 a[124:127], v[96:99], v[48:51], a[124:127]
s_barrier
s_waitcnt lgkmcnt(12)
ds_read_b64_tr_b16 v[96:97], v2 offset:50568
ds_read_b64_tr_b16 v[98:99], v2 offset:51080
v_mfma_f32_16x16x32_bf16 a[128:131], v[68:71], v[44:47], a[128:131]
s_add_u32 m0, s76, 33024
s_add_u32 s60, s60, 261376
v_mfma_f32_16x16x32_bf16 a[132:135], v[68:71], v[48:51], a[132:135]
s_waitcnt lgkmcnt(12)
s_add_u32 s68, s68, 261376
v_mfma_f32_16x16x32_bf16 a[136:139], v[72:75], v[44:47], a[136:139]
ds_read_b64_tr_b16 v[68:69], v1 offset:57792
ds_read_b64_tr_b16 v[70:71], v1 offset:58304
v_mfma_f32_16x16x32_bf16 a[140:143], v[72:75], v[48:51], a[140:143]
s_waitcnt lgkmcnt(12)
buffer_load_dwordx4 v54, s[40:43], s60 offen offset:0 lds
v_mfma_f32_16x16x32_bf16 a[144:147], v[76:79], v[44:47], a[144:147]
ds_read_b64_tr_b16 v[72:73], v1 offset:57800
ds_read_b64_tr_b16 v[74:75], v1 offset:58312
v_mfma_f32_16x16x32_bf16 a[148:151], v[76:79], v[48:51], a[148:151]
s_waitcnt lgkmcnt(12)
buffer_load_dwordx4 v54, s[40:43], s68 offen offset:1024 lds
v_mfma_f32_16x16x32_bf16 a[152:155], v[80:83], v[44:47], a[152:155]
ds_read_b64_tr_b16 v[76:77], v2 offset:57792
ds_read_b64_tr_b16 v[78:79], v2 offset:58304
v_mfma_f32_16x16x32_bf16 a[156:159], v[80:83], v[48:51], a[156:159]
s_waitcnt lgkmcnt(12)
s_add_u32 m0, s76, 41280
v_mfma_f32_16x16x32_bf16 a[160:163], v[84:87], v[44:47], a[160:163]
ds_read_b64_tr_b16 v[80:81], v2 offset:57800
ds_read_b64_tr_b16 v[82:83], v2 offset:58312
v_mfma_f32_16x16x32_bf16 a[164:167], v[84:87], v[48:51], a[164:167]
s_waitcnt lgkmcnt(12)
s_add_u32 s60, s60, 256
v_mfma_f32_16x16x32_bf16 a[168:171], v[88:91], v[44:47], a[168:171]
ds_read_b64_tr_b16 v[84:85], v1 offset:58816
ds_read_b64_tr_b16 v[86:87], v1 offset:59328
v_mfma_f32_16x16x32_bf16 a[172:175], v[88:91], v[48:51], a[172:175]
s_waitcnt lgkmcnt(12)
s_add_u32 s68, s68, 256
v_mfma_f32_16x16x32_bf16 a[176:179], v[92:95], v[44:47], a[176:179]
ds_read_b64_tr_b16 v[88:89], v1 offset:58824
ds_read_b64_tr_b16 v[90:91], v1 offset:59336
v_mfma_f32_16x16x32_bf16 a[180:183], v[92:95], v[48:51], a[180:183]
s_waitcnt lgkmcnt(12)
buffer_load_dwordx4 v54, s[40:43], s60 offen offset:0 lds
v_mfma_f32_16x16x32_bf16 a[184:187], v[96:99], v[44:47], a[184:187]
ds_read_b64_tr_b16 v[92:93], v2 offset:58816
ds_read_b64_tr_b16 v[94:95], v2 offset:59328
v_mfma_f32_16x16x32_bf16 a[188:191], v[96:99], v[48:51], a[188:191]
s_waitcnt lgkmcnt(12)
buffer_load_dwordx4 v54, s[40:43], s68 offen offset:1024 lds
v_mfma_f32_16x16x32_bf16 a[192:195], v[68:71], v[44:47], a[192:195]
ds_read_b64_tr_b16 v[96:97], v2 offset:58824
ds_read_b64_tr_b16 v[98:99], v2 offset:59336
v_mfma_f32_16x16x32_bf16 a[196:199], v[68:71], v[48:51], a[196:199]
s_waitcnt lgkmcnt(12)
v_mfma_f32_16x16x32_bf16 a[200:203], v[72:75], v[44:47], a[200:203]
v_mfma_f32_16x16x32_bf16 a[204:207], v[72:75], v[48:51], a[204:207]
s_waitcnt lgkmcnt(10)
v_mfma_f32_16x16x32_bf16 a[208:211], v[76:79], v[44:47], a[208:211]
v_mfma_f32_16x16x32_bf16 a[212:215], v[76:79], v[48:51], a[212:215]
s_waitcnt lgkmcnt(8)
v_mfma_f32_16x16x32_bf16 a[216:219], v[80:83], v[44:47], a[216:219]
v_mfma_f32_16x16x32_bf16 a[220:223], v[80:83], v[48:51], a[220:223]
s_waitcnt lgkmcnt(6)
v_mfma_f32_16x16x32_bf16 a[224:227], v[84:87], v[44:47], a[224:227]
v_mfma_f32_16x16x32_bf16 a[228:231], v[84:87], v[48:51], a[228:231]
s_waitcnt lgkmcnt(4)
v_mfma_f32_16x16x32_bf16 a[232:235], v[88:91], v[44:47], a[232:235]
v_mfma_f32_16x16x32_bf16 a[236:239], v[88:91], v[48:51], a[236:239]
s_waitcnt lgkmcnt(2)
v_mfma_f32_16x16x32_bf16 a[240:243], v[92:95], v[44:47], a[240:243]
v_mfma_f32_16x16x32_bf16 a[244:247], v[92:95], v[48:51], a[244:247]
s_waitcnt lgkmcnt(0)
v_mfma_f32_16x16x32_bf16 a[248:251], v[96:99], v[44:47], a[248:251]
v_mfma_f32_16x16x32_bf16 a[252:255], v[96:99], v[48:51], a[252:255]
s_waitcnt vmcnt(0) lgkmcnt(0)
s_barrier
s_add_u32 m0, s69, 33024
s_nop 0
buffer_load_dwordx4 v7, s[80:83], s64 offen offset:0 nt lds
buffer_load_dwordx4 v7, s[80:83], s66 offen offset:1024 nt lds
s_add_u32 m0, s69, 41280
s_add_u32 s64, s64, 8192
s_add_u32 s66, s66, 8192
buffer_load_dwordx4 v7, s[80:83], s64 offen offset:0 nt lds
buffer_load_dwordx4 v7, s[80:83], s66 offen offset:1024 nt lds
s_add_u32 m0, s76, 0
s_nop 0
buffer_load_dwordx4 v8, s[92:95], s65 offen offset:0 nt lds
buffer_load_dwordx4 v8, s[92:95], s67 offen offset:1024 nt lds
s_add_u32 m0, s69, 49536
s_add_u32 s64, s64, 8192
s_add_u32 s66, s66, 8192
buffer_load_dwordx4 v7, s[80:83], s64 offen offset:0 nt lds
buffer_load_dwordx4 v7, s[80:83], s66 offen offset:1024 nt lds
s_add_u32 m0, s76, 8256
s_add_u32 s65, s65, 8192
s_add_u32 s67, s67, 8192
buffer_load_dwordx4 v8, s[92:95], s65 offen offset:0 nt lds
buffer_load_dwordx4 v8, s[92:95], s67 offen offset:1024 nt lds
s_add_u32 m0, s69, 57792
s_add_u32 s64, s64, 8192
s_add_u32 s66, s66, 8192
buffer_load_dwordx4 v7, s[80:83], s64 offen offset:0 nt lds
buffer_load_dwordx4 v7, s[80:83], s66 offen offset:1024 nt lds
v_mov_b32 v4, v63
s_add_u32 m0, s78, 66048
s_nop 0
buffer_load_dwordx4 v4, s[48:51], s62 offen offset:0 nt lds
s_add_u32 m0, s78, 70400
s_add_u32 s62, s62, 128
buffer_load_dwordx4 v4, s[48:51], s62 offen offset:0 nt lds
s_add_u32 m0, s78, 83456
s_add_u32 s62, s62, 128
buffer_load_dwordx4 v4, s[48:51], s62 offen offset:0 nt lds
s_add_u32 m0, s78, 87808
s_add_u32 s62, s62, 128
buffer_load_dwordx4 v4, s[48:51], s62 offen offset:0 nt lds
s_add_u32 m0, s78, 118272
s_add_u32 s62, s62, 128
buffer_load_dwordx4 v4, s[48:51], s62 offen offset:0 nt lds
s_add_u32 m0, s78, 122624
s_add_u32 s62, s62, 128
buffer_load_dwordx4 v4, s[48:51], s62 offen offset:0 nt lds
s_nop 7
v_mbcnt_lo_u32_b32 v15, -1, 0
v_mbcnt_hi_u32_b32 v15, -1, v15
v_accvgpr_read_b32 v68, a0
v_accvgpr_read_b32 v69, a1
v_accvgpr_read_b32 v70, a2
v_accvgpr_read_b32 v71, a3
v_accvgpr_write_b32 a0, 0
v_accvgpr_write_b32 a1, 0
v_accvgpr_write_b32 a2, 0
v_accvgpr_write_b32 a3, 0
v_pk_mul_f32 v[68:69], v[68:69], s[26:27]
v_pk_mul_f32 v[70:71], v[70:71], s[26:27]
v_cvt_pk_bf16_f32 v164, v68, v69
v_cvt_pk_bf16_f32 v165, v70, v71
v_accvgpr_read_b32 v72, a8
v_accvgpr_read_b32 v73, a9
v_accvgpr_read_b32 v74, a10
v_accvgpr_read_b32 v75, a11
v_accvgpr_write_b32 a8, 0
v_accvgpr_write_b32 a9, 0
v_accvgpr_write_b32 a10, 0
v_accvgpr_write_b32 a11, 0
v_pk_mul_f32 v[72:73], v[72:73], s[26:27]
v_pk_mul_f32 v[74:75], v[74:75], s[26:27]
v_cvt_pk_bf16_f32 v166, v72, v73
v_cvt_pk_bf16_f32 v167, v74, v75
v_accvgpr_read_b32 v76, a4
v_accvgpr_read_b32 v77, a5
v_accvgpr_read_b32 v78, a6
v_accvgpr_read_b32 v79, a7
v_accvgpr_write_b32 a4, 0
v_accvgpr_write_b32 a5, 0
v_accvgpr_write_b32 a6, 0
v_accvgpr_write_b32 a7, 0
v_pk_mul_f32 v[76:77], v[76:77], s[26:27]
v_pk_mul_f32 v[78:79], v[78:79], s[26:27]
v_cvt_pk_bf16_f32 v168, v76, v77
v_cvt_pk_bf16_f32 v169, v78, v79
v_accvgpr_read_b32 v80, a12
v_accvgpr_read_b32 v81, a13
v_accvgpr_read_b32 v82, a14
v_accvgpr_read_b32 v83, a15
v_accvgpr_write_b32 a12, 0
v_accvgpr_write_b32 a13, 0
v_accvgpr_write_b32 a14, 0
v_accvgpr_write_b32 a15, 0
v_pk_mul_f32 v[80:81], v[80:81], s[26:27]
v_pk_mul_f32 v[82:83], v[82:83], s[26:27]
v_cvt_pk_bf16_f32 v170, v80, v81
v_cvt_pk_bf16_f32 v171, v82, v83
v_accvgpr_read_b32 v84, a16
v_accvgpr_read_b32 v85, a17
v_accvgpr_read_b32 v86, a18
v_accvgpr_read_b32 v87, a19
v_accvgpr_write_b32 a16, 0
v_accvgpr_write_b32 a17, 0
v_accvgpr_write_b32 a18, 0
v_accvgpr_write_b32 a19, 0
v_pk_mul_f32 v[84:85], v[84:85], s[26:27]
v_pk_mul_f32 v[86:87], v[86:87], s[26:27]
v_cvt_pk_bf16_f32 v172, v84, v85
v_cvt_pk_bf16_f32 v173, v86, v87
v_accvgpr_read_b32 v88, a24
v_accvgpr_read_b32 v89, a25
v_accvgpr_read_b32 v90, a26
v_accvgpr_read_b32 v91, a27
v_accvgpr_write_b32 a24, 0
v_accvgpr_write_b32 a25, 0
v_accvgpr_write_b32 a26, 0
v_accvgpr_write_b32 a27, 0
v_pk_mul_f32 v[88:89], v[88:89], s[26:27]
v_pk_mul_f32 v[90:91], v[90:91], s[26:27]
v_cvt_pk_bf16_f32 v174, v88, v89
v_cvt_pk_bf16_f32 v175, v90, v91
v_accvgpr_read_b32 v92, a20
v_accvgpr_read_b32 v93, a21
v_accvgpr_read_b32 v94, a22
v_accvgpr_read_b32 v95, a23
v_accvgpr_write_b32 a20, 0
v_accvgpr_write_b32 a21, 0
v_accvgpr_write_b32 a22, 0
v_accvgpr_write_b32 a23, 0
v_pk_mul_f32 v[92:93], v[92:93], s[26:27]
v_pk_mul_f32 v[94:95], v[94:95], s[26:27]
v_cvt_pk_bf16_f32 v176, v92, v93
v_cvt_pk_bf16_f32 v177, v94, v95
v_accvgpr_read_b32 v96, a28
v_accvgpr_read_b32 v97, a29
v_accvgpr_read_b32 v98, a30
v_accvgpr_read_b32 v99, a31
v_accvgpr_write_b32 a28, 0
v_accvgpr_write_b32 a29, 0
v_accvgpr_write_b32 a30, 0
v_accvgpr_write_b32 a31, 0
v_pk_mul_f32 v[96:97], v[96:97], s[26:27]
v_pk_mul_f32 v[98:99], v[98:99], s[26:27]
v_cvt_pk_bf16_f32 v178, v96, v97
v_cvt_pk_bf16_f32 v179, v98, v99
v_accvgpr_read_b32 v100, a32
v_accvgpr_read_b32 v101, a33
v_accvgpr_read_b32 v102, a34
v_accvgpr_read_b32 v103, a35
v_accvgpr_write_b32 a32, 0
v_accvgpr_write_b32 a33, 0
v_accvgpr_write_b32 a34, 0
v_accvgpr_write_b32 a35, 0
v_pk_mul_f32 v[100:101], v[100:101], s[26:27]
v_pk_mul_f32 v[102:103], v[102:103], s[26:27]
v_cvt_pk_bf16_f32 v180, v100, v101
v_cvt_pk_bf16_f32 v181, v102, v103
v_accvgpr_read_b32 v104, a40
v_accvgpr_read_b32 v105, a41
v_accvgpr_read_b32 v106, a42
v_accvgpr_read_b32 v107, a43
v_accvgpr_write_b32 a40, 0
v_accvgpr_write_b32 a41, 0
v_accvgpr_write_b32 a42, 0
v_accvgpr_write_b32 a43, 0
v_pk_mul_f32 v[104:105], v[104:105], s[26:27]
v_pk_mul_f32 v[106:107], v[106:107], s[26:27]
v_cvt_pk_bf16_f32 v182, v104, v105
v_cvt_pk_bf16_f32 v183, v106, v107
v_accvgpr_read_b32 v108, a36
v_accvgpr_read_b32 v109, a37
v_accvgpr_read_b32 v110, a38
v_accvgpr_read_b32 v111, a39
v_accvgpr_write_b32 a36, 0
v_accvgpr_write_b32 a37, 0
v_accvgpr_write_b32 a38, 0
v_accvgpr_write_b32 a39, 0
v_pk_mul_f32 v[108:109], v[108:109], s[26:27]
v_pk_mul_f32 v[110:111], v[110:111], s[26:27]
v_cvt_pk_bf16_f32 v184, v108, v109
v_cvt_pk_bf16_f32 v185, v110, v111
v_accvgpr_read_b32 v112, a44
v_accvgpr_read_b32 v113, a45
v_accvgpr_read_b32 v114, a46
v_accvgpr_read_b32 v115, a47
v_accvgpr_write_b32 a44, 0
v_accvgpr_write_b32 a45, 0
v_accvgpr_write_b32 a46, 0
v_accvgpr_write_b32 a47, 0
v_pk_mul_f32 v[112:113], v[112:113], s[26:27]
v_pk_mul_f32 v[114:115], v[114:115], s[26:27]
v_cvt_pk_bf16_f32 v186, v112, v113
v_cvt_pk_bf16_f32 v187, v114, v115
v_accvgpr_read_b32 v116, a48
v_accvgpr_read_b32 v117, a49
v_accvgpr_read_b32 v118, a50
v_accvgpr_read_b32 v119, a51
v_accvgpr_write_b32 a48, 0
v_accvgpr_write_b32 a49, 0
v_accvgpr_write_b32 a50, 0
v_accvgpr_write_b32 a51, 0
v_pk_mul_f32 v[116:117], v[116:117], s[26:27]
v_pk_mul_f32 v[118:119], v[118:119], s[26:27]
v_cvt_pk_bf16_f32 v188, v116, v117
v_cvt_pk_bf16_f32 v189, v118, v119
v_accvgpr_read_b32 v120, a56
v_accvgpr_read_b32 v121, a57
v_accvgpr_read_b32 v122, a58
v_accvgpr_read_b32 v123, a59
v_accvgpr_write_b32 a56, 0
v_accvgpr_write_b32 a57, 0
v_accvgpr_write_b32 a58, 0
v_accvgpr_write_b32 a59, 0
v_pk_mul_f32 v[120:121], v[120:121], s[26:27]
v_pk_mul_f32 v[122:123], v[122:123], s[26:27]
v_cvt_pk_bf16_f32 v190, v120, v121
v_cvt_pk_bf16_f32 v191, v122, v123
v_accvgpr_read_b32 v124, a52
v_accvgpr_read_b32 v125, a53
v_accvgpr_read_b32 v126, a54
v_accvgpr_read_b32 v127, a55
v_accvgpr_write_b32 a52, 0
v_accvgpr_write_b32 a53, 0
v_accvgpr_write_b32 a54, 0
v_accvgpr_write_b32 a55, 0
v_pk_mul_f32 v[124:125], v[124:125], s[26:27]
v_pk_mul_f32 v[126:127], v[126:127], s[26:27]
v_cvt_pk_bf16_f32 v192, v124, v125
v_cvt_pk_bf16_f32 v193, v126, v127
v_accvgpr_read_b32 v128, a60
v_accvgpr_read_b32 v129, a61
v_accvgpr_read_b32 v130, a62
v_accvgpr_read_b32 v131, a63
v_accvgpr_write_b32 a60, 0
v_accvgpr_write_b32 a61, 0
v_accvgpr_write_b32 a62, 0
v_accvgpr_write_b32 a63, 0
v_pk_mul_f32 v[128:129], v[128:129], s[26:27]
v_pk_mul_f32 v[130:131], v[130:131], s[26:27]
v_cvt_pk_bf16_f32 v194, v128, v129
v_cvt_pk_bf16_f32 v195, v130, v131
v_accvgpr_read_b32 v68, a64
v_accvgpr_read_b32 v69, a65
v_accvgpr_read_b32 v70, a66
v_accvgpr_read_b32 v71, a67
v_accvgpr_write_b32 a64, 0
v_accvgpr_write_b32 a65, 0
v_accvgpr_write_b32 a66, 0
v_accvgpr_write_b32 a67, 0
v_pk_mul_f32 v[68:69], v[68:69], s[26:27]
v_pk_mul_f32 v[70:71], v[70:71], s[26:27]
v_cvt_pk_bf16_f32 v196, v68, v69
v_cvt_pk_bf16_f32 v197, v70, v71
v_accvgpr_read_b32 v72, a72
v_accvgpr_read_b32 v73, a73
v_accvgpr_read_b32 v74, a74
v_accvgpr_read_b32 v75, a75
v_accvgpr_write_b32 a72, 0
v_accvgpr_write_b32 a73, 0
v_accvgpr_write_b32 a74, 0
v_accvgpr_write_b32 a75, 0
v_pk_mul_f32 v[72:73], v[72:73], s[26:27]
v_pk_mul_f32 v[74:75], v[74:75], s[26:27]
v_cvt_pk_bf16_f32 v198, v72, v73
v_cvt_pk_bf16_f32 v199, v74, v75
v_accvgpr_read_b32 v76, a68
v_accvgpr_read_b32 v77, a69
v_accvgpr_read_b32 v78, a70
v_accvgpr_read_b32 v79, a71
v_accvgpr_write_b32 a68, 0
v_accvgpr_write_b32 a69, 0
v_accvgpr_write_b32 a70, 0
v_accvgpr_write_b32 a71, 0
v_pk_mul_f32 v[76:77], v[76:77], s[26:27]
v_pk_mul_f32 v[78:79], v[78:79], s[26:27]
v_cvt_pk_bf16_f32 v200, v76, v77
v_cvt_pk_bf16_f32 v201, v78, v79
v_accvgpr_read_b32 v80, a76
v_accvgpr_read_b32 v81, a77
v_accvgpr_read_b32 v82, a78
v_accvgpr_read_b32 v83, a79
v_accvgpr_write_b32 a76, 0
v_accvgpr_write_b32 a77, 0
v_accvgpr_write_b32 a78, 0
v_accvgpr_write_b32 a79, 0
v_pk_mul_f32 v[80:81], v[80:81], s[26:27]
v_pk_mul_f32 v[82:83], v[82:83], s[26:27]
v_cvt_pk_bf16_f32 v202, v80, v81
v_cvt_pk_bf16_f32 v203, v82, v83
v_accvgpr_read_b32 v84, a80
v_accvgpr_read_b32 v85, a81
v_accvgpr_read_b32 v86, a82
v_accvgpr_read_b32 v87, a83
v_accvgpr_write_b32 a80, 0
v_accvgpr_write_b32 a81, 0
v_accvgpr_write_b32 a82, 0
v_accvgpr_write_b32 a83, 0
v_pk_mul_f32 v[84:85], v[84:85], s[26:27]
v_pk_mul_f32 v[86:87], v[86:87], s[26:27]
v_cvt_pk_bf16_f32 v204, v84, v85
v_cvt_pk_bf16_f32 v205, v86, v87
v_accvgpr_read_b32 v88, a88
v_accvgpr_read_b32 v89, a89
v_accvgpr_read_b32 v90, a90
v_accvgpr_read_b32 v91, a91
v_accvgpr_write_b32 a88, 0
v_accvgpr_write_b32 a89, 0
v_accvgpr_write_b32 a90, 0
v_accvgpr_write_b32 a91, 0
v_pk_mul_f32 v[88:89], v[88:89], s[26:27]
v_pk_mul_f32 v[90:91], v[90:91], s[26:27]
v_cvt_pk_bf16_f32 v206, v88, v89
v_cvt_pk_bf16_f32 v207, v90, v91
v_accvgpr_read_b32 v92, a84
v_accvgpr_read_b32 v93, a85
v_accvgpr_read_b32 v94, a86
v_accvgpr_read_b32 v95, a87
v_accvgpr_write_b32 a84, 0
v_accvgpr_write_b32 a85, 0
v_accvgpr_write_b32 a86, 0
v_accvgpr_write_b32 a87, 0
v_pk_mul_f32 v[92:93], v[92:93], s[26:27]
v_pk_mul_f32 v[94:95], v[94:95], s[26:27]
v_cvt_pk_bf16_f32 v208, v92, v93
v_cvt_pk_bf16_f32 v209, v94, v95
v_accvgpr_read_b32 v96, a92
v_accvgpr_read_b32 v97, a93
v_accvgpr_read_b32 v98, a94
v_accvgpr_read_b32 v99, a95
v_accvgpr_write_b32 a92, 0
v_accvgpr_write_b32 a93, 0
v_accvgpr_write_b32 a94, 0
v_accvgpr_write_b32 a95, 0
v_pk_mul_f32 v[96:97], v[96:97], s[26:27]
v_pk_mul_f32 v[98:99], v[98:99], s[26:27]
v_cvt_pk_bf16_f32 v210, v96, v97
v_cvt_pk_bf16_f32 v211, v98, v99
v_accvgpr_read_b32 v100, a96
v_accvgpr_read_b32 v101, a97
v_accvgpr_read_b32 v102, a98
v_accvgpr_read_b32 v103, a99
v_accvgpr_write_b32 a96, 0
v_accvgpr_write_b32 a97, 0
v_accvgpr_write_b32 a98, 0
v_accvgpr_write_b32 a99, 0
v_pk_mul_f32 v[100:101], v[100:101], s[26:27]
v_pk_mul_f32 v[102:103], v[102:103], s[26:27]
v_cvt_pk_bf16_f32 v212, v100, v101
v_cvt_pk_bf16_f32 v213, v102, v103
v_accvgpr_read_b32 v104, a104
v_accvgpr_read_b32 v105, a105
v_accvgpr_read_b32 v106, a106
v_accvgpr_read_b32 v107, a107
v_accvgpr_write_b32 a104, 0
v_accvgpr_write_b32 a105, 0
v_accvgpr_write_b32 a106, 0
v_accvgpr_write_b32 a107, 0
v_pk_mul_f32 v[104:105], v[104:105], s[26:27]
v_pk_mul_f32 v[106:107], v[106:107], s[26:27]
v_cvt_pk_bf16_f32 v214, v104, v105
v_cvt_pk_bf16_f32 v215, v106, v107
v_accvgpr_read_b32 v108, a100
v_accvgpr_read_b32 v109, a101
v_accvgpr_read_b32 v110, a102
v_accvgpr_read_b32 v111, a103
v_accvgpr_write_b32 a100, 0
v_accvgpr_write_b32 a101, 0
v_accvgpr_write_b32 a102, 0
v_accvgpr_write_b32 a103, 0
v_pk_mul_f32 v[108:109], v[108:109], s[26:27]
v_pk_mul_f32 v[110:111], v[110:111], s[26:27]
v_cvt_pk_bf16_f32 v216, v108, v109
v_cvt_pk_bf16_f32 v217, v110, v111
v_accvgpr_read_b32 v112, a108
v_accvgpr_read_b32 v113, a109
v_accvgpr_read_b32 v114, a110
v_accvgpr_read_b32 v115, a111
v_accvgpr_write_b32 a108, 0
v_accvgpr_write_b32 a109, 0
v_accvgpr_write_b32 a110, 0
v_accvgpr_write_b32 a111, 0
v_pk_mul_f32 v[112:113], v[112:113], s[26:27]
v_pk_mul_f32 v[114:115], v[114:115], s[26:27]
v_cvt_pk_bf16_f32 v218, v112, v113
v_cvt_pk_bf16_f32 v219, v114, v115
v_accvgpr_read_b32 v116, a112
v_accvgpr_read_b32 v117, a113
v_accvgpr_read_b32 v118, a114
v_accvgpr_read_b32 v119, a115
v_accvgpr_write_b32 a112, 0
v_accvgpr_write_b32 a113, 0
v_accvgpr_write_b32 a114, 0
v_accvgpr_write_b32 a115, 0
v_pk_mul_f32 v[116:117], v[116:117], s[26:27]
v_pk_mul_f32 v[118:119], v[118:119], s[26:27]
v_cvt_pk_bf16_f32 v220, v116, v117
v_cvt_pk_bf16_f32 v221, v118, v119
v_accvgpr_read_b32 v120, a120
v_accvgpr_read_b32 v121, a121
v_accvgpr_read_b32 v122, a122
v_accvgpr_read_b32 v123, a123
v_accvgpr_write_b32 a120, 0
v_accvgpr_write_b32 a121, 0
v_accvgpr_write_b32 a122, 0
v_accvgpr_write_b32 a123, 0
v_pk_mul_f32 v[120:121], v[120:121], s[26:27]
v_pk_mul_f32 v[122:123], v[122:123], s[26:27]
v_cvt_pk_bf16_f32 v222, v120, v121
v_cvt_pk_bf16_f32 v223, v122, v123
v_accvgpr_read_b32 v124, a116
v_accvgpr_read_b32 v125, a117
v_accvgpr_read_b32 v126, a118
v_accvgpr_read_b32 v127, a119
v_accvgpr_write_b32 a116, 0
v_accvgpr_write_b32 a117, 0
v_accvgpr_write_b32 a118, 0
v_accvgpr_write_b32 a119, 0
v_pk_mul_f32 v[124:125], v[124:125], s[26:27]
v_pk_mul_f32 v[126:127], v[126:127], s[26:27]
v_cvt_pk_bf16_f32 v224, v124, v125
v_cvt_pk_bf16_f32 v225, v126, v127
v_accvgpr_read_b32 v128, a124
v_accvgpr_read_b32 v129, a125
v_accvgpr_read_b32 v130, a126
v_accvgpr_read_b32 v131, a127
v_accvgpr_write_b32 a124, 0
v_accvgpr_write_b32 a125, 0
v_accvgpr_write_b32 a126, 0
v_accvgpr_write_b32 a127, 0
v_pk_mul_f32 v[128:129], v[128:129], s[26:27]
v_pk_mul_f32 v[130:131], v[130:131], s[26:27]
v_cvt_pk_bf16_f32 v226, v128, v129
v_cvt_pk_bf16_f32 v227, v130, v131
buffer_store_dwordx4 v[196:199], v10, s[28:31], s38 offen offset:0 nt
buffer_store_dwordx4 v[200:203], v10, s[28:31], s38 offen offset:1024 nt
buffer_store_dwordx4 v[204:207], v10, s[28:31], s38 offen offset:2048 nt
buffer_store_dwordx4 v[208:211], v10, s[28:31], s38 offen offset:3072 nt
buffer_store_dwordx4 v[212:215], v10, s[28:31], s74 offen offset:0 nt
buffer_store_dwordx4 v[216:219], v10, s[28:31], s74 offen offset:1024 nt
buffer_store_dwordx4 v[220:223], v10, s[28:31], s74 offen offset:2048 nt
buffer_store_dwordx4 v[224:227], v10, s[28:31], s74 offen offset:3072 nt
s_add_u32 s38, s38, 8192
s_add_u32 s74, s74, 8192
v_accvgpr_read_b32 v68, a128
v_accvgpr_read_b32 v69, a129
v_accvgpr_read_b32 v70, a130
v_accvgpr_read_b32 v71, a131
v_accvgpr_write_b32 a128, 0
v_accvgpr_write_b32 a129, 0
v_accvgpr_write_b32 a130, 0
v_accvgpr_write_b32 a131, 0
v_pk_mul_f32 v[68:69], v[68:69], s[26:27]
v_pk_mul_f32 v[70:71], v[70:71], s[26:27]
v_cvt_pk_bf16_f32 v196, v68, v69
v_cvt_pk_bf16_f32 v197, v70, v71
v_accvgpr_read_b32 v72, a136
v_accvgpr_read_b32 v73, a137
v_accvgpr_read_b32 v74, a138
v_accvgpr_read_b32 v75, a139
v_accvgpr_write_b32 a136, 0
v_accvgpr_write_b32 a137, 0
v_accvgpr_write_b32 a138, 0
v_accvgpr_write_b32 a139, 0
v_pk_mul_f32 v[72:73], v[72:73], s[26:27]
v_pk_mul_f32 v[74:75], v[74:75], s[26:27]
v_cvt_pk_bf16_f32 v198, v72, v73
v_cvt_pk_bf16_f32 v199, v74, v75
v_accvgpr_read_b32 v76, a132
v_accvgpr_read_b32 v77, a133
v_accvgpr_read_b32 v78, a134
v_accvgpr_read_b32 v79, a135
v_accvgpr_write_b32 a132, 0
v_accvgpr_write_b32 a133, 0
v_accvgpr_write_b32 a134, 0
v_accvgpr_write_b32 a135, 0
v_pk_mul_f32 v[76:77], v[76:77], s[26:27]
v_pk_mul_f32 v[78:79], v[78:79], s[26:27]
v_cvt_pk_bf16_f32 v200, v76, v77
v_cvt_pk_bf16_f32 v201, v78, v79
v_accvgpr_read_b32 v80, a140
v_accvgpr_read_b32 v81, a141
v_accvgpr_read_b32 v82, a142
v_accvgpr_read_b32 v83, a143
v_accvgpr_write_b32 a140, 0
v_accvgpr_write_b32 a141, 0
v_accvgpr_write_b32 a142, 0
v_accvgpr_write_b32 a143, 0
v_pk_mul_f32 v[80:81], v[80:81], s[26:27]
v_pk_mul_f32 v[82:83], v[82:83], s[26:27]
v_cvt_pk_bf16_f32 v202, v80, v81
v_cvt_pk_bf16_f32 v203, v82, v83
v_accvgpr_read_b32 v84, a144
v_accvgpr_read_b32 v85, a145
v_accvgpr_read_b32 v86, a146
v_accvgpr_read_b32 v87, a147
v_accvgpr_write_b32 a144, 0
v_accvgpr_write_b32 a145, 0
v_accvgpr_write_b32 a146, 0
v_accvgpr_write_b32 a147, 0
v_pk_mul_f32 v[84:85], v[84:85], s[26:27]
v_pk_mul_f32 v[86:87], v[86:87], s[26:27]
v_cvt_pk_bf16_f32 v204, v84, v85
v_cvt_pk_bf16_f32 v205, v86, v87
v_accvgpr_read_b32 v88, a152
v_accvgpr_read_b32 v89, a153
v_accvgpr_read_b32 v90, a154
v_accvgpr_read_b32 v91, a155
v_accvgpr_write_b32 a152, 0
v_accvgpr_write_b32 a153, 0
v_accvgpr_write_b32 a154, 0
v_accvgpr_write_b32 a155, 0
v_pk_mul_f32 v[88:89], v[88:89], s[26:27]
v_pk_mul_f32 v[90:91], v[90:91], s[26:27]
v_cvt_pk_bf16_f32 v206, v88, v89
v_cvt_pk_bf16_f32 v207, v90, v91
v_accvgpr_read_b32 v92, a148
v_accvgpr_read_b32 v93, a149
v_accvgpr_read_b32 v94, a150
v_accvgpr_read_b32 v95, a151
v_accvgpr_write_b32 a148, 0
v_accvgpr_write_b32 a149, 0
v_accvgpr_write_b32 a150, 0
v_accvgpr_write_b32 a151, 0
v_pk_mul_f32 v[92:93], v[92:93], s[26:27]
v_pk_mul_f32 v[94:95], v[94:95], s[26:27]
v_cvt_pk_bf16_f32 v208, v92, v93
v_cvt_pk_bf16_f32 v209, v94, v95
v_accvgpr_read_b32 v96, a156
v_accvgpr_read_b32 v97, a157
v_accvgpr_read_b32 v98, a158
v_accvgpr_read_b32 v99, a159
v_accvgpr_write_b32 a156, 0
v_accvgpr_write_b32 a157, 0
v_accvgpr_write_b32 a158, 0
v_accvgpr_write_b32 a159, 0
v_pk_mul_f32 v[96:97], v[96:97], s[26:27]
v_pk_mul_f32 v[98:99], v[98:99], s[26:27]
v_cvt_pk_bf16_f32 v210, v96, v97
v_cvt_pk_bf16_f32 v211, v98, v99
v_accvgpr_read_b32 v100, a160
v_accvgpr_read_b32 v101, a161
v_accvgpr_read_b32 v102, a162
v_accvgpr_read_b32 v103, a163
v_accvgpr_write_b32 a160, 0
v_accvgpr_write_b32 a161, 0
v_accvgpr_write_b32 a162, 0
v_accvgpr_write_b32 a163, 0
v_pk_mul_f32 v[100:101], v[100:101], s[26:27]
v_pk_mul_f32 v[102:103], v[102:103], s[26:27]
v_cvt_pk_bf16_f32 v212, v100, v101
v_cvt_pk_bf16_f32 v213, v102, v103
v_accvgpr_read_b32 v104, a168
v_accvgpr_read_b32 v105, a169
v_accvgpr_read_b32 v106, a170
v_accvgpr_read_b32 v107, a171
v_accvgpr_write_b32 a168, 0
v_accvgpr_write_b32 a169, 0
v_accvgpr_write_b32 a170, 0
v_accvgpr_write_b32 a171, 0
v_pk_mul_f32 v[104:105], v[104:105], s[26:27]
v_pk_mul_f32 v[106:107], v[106:107], s[26:27]
v_cvt_pk_bf16_f32 v214, v104, v105
v_cvt_pk_bf16_f32 v215, v106, v107
v_accvgpr_read_b32 v108, a164
v_accvgpr_read_b32 v109, a165
v_accvgpr_read_b32 v110, a166
v_accvgpr_read_b32 v111, a167
v_accvgpr_write_b32 a164, 0
v_accvgpr_write_b32 a165, 0
v_accvgpr_write_b32 a166, 0
v_accvgpr_write_b32 a167, 0
v_pk_mul_f32 v[108:109], v[108:109], s[26:27]
v_pk_mul_f32 v[110:111], v[110:111], s[26:27]
v_cvt_pk_bf16_f32 v216, v108, v109
v_cvt_pk_bf16_f32 v217, v110, v111
v_accvgpr_read_b32 v112, a172
v_accvgpr_read_b32 v113, a173
v_accvgpr_read_b32 v114, a174
v_accvgpr_read_b32 v115, a175
v_accvgpr_write_b32 a172, 0
v_accvgpr_write_b32 a173, 0
v_accvgpr_write_b32 a174, 0
v_accvgpr_write_b32 a175, 0
v_pk_mul_f32 v[112:113], v[112:113], s[26:27]
v_pk_mul_f32 v[114:115], v[114:115], s[26:27]
v_cvt_pk_bf16_f32 v218, v112, v113
v_cvt_pk_bf16_f32 v219, v114, v115
v_accvgpr_read_b32 v116, a176
v_accvgpr_read_b32 v117, a177
v_accvgpr_read_b32 v118, a178
v_accvgpr_read_b32 v119, a179
v_accvgpr_write_b32 a176, 0
v_accvgpr_write_b32 a177, 0
v_accvgpr_write_b32 a178, 0
v_accvgpr_write_b32 a179, 0
v_pk_mul_f32 v[116:117], v[116:117], s[26:27]
v_pk_mul_f32 v[118:119], v[118:119], s[26:27]
v_cvt_pk_bf16_f32 v220, v116, v117
v_cvt_pk_bf16_f32 v221, v118, v119
v_accvgpr_read_b32 v120, a184
v_accvgpr_read_b32 v121, a185
v_accvgpr_read_b32 v122, a186
v_accvgpr_read_b32 v123, a187
v_accvgpr_write_b32 a184, 0
v_accvgpr_write_b32 a185, 0
v_accvgpr_write_b32 a186, 0
v_accvgpr_write_b32 a187, 0
v_pk_mul_f32 v[120:121], v[120:121], s[26:27]
v_pk_mul_f32 v[122:123], v[122:123], s[26:27]
v_cvt_pk_bf16_f32 v222, v120, v121
v_cvt_pk_bf16_f32 v223, v122, v123
v_accvgpr_read_b32 v124, a180
v_accvgpr_read_b32 v125, a181
v_accvgpr_read_b32 v126, a182
v_accvgpr_read_b32 v127, a183
v_accvgpr_write_b32 a180, 0
v_accvgpr_write_b32 a181, 0
v_accvgpr_write_b32 a182, 0
v_accvgpr_write_b32 a183, 0
v_pk_mul_f32 v[124:125], v[124:125], s[26:27]
v_pk_mul_f32 v[126:127], v[126:127], s[26:27]
v_cvt_pk_bf16_f32 v224, v124, v125
v_cvt_pk_bf16_f32 v225, v126, v127
v_accvgpr_read_b32 v128, a188
v_accvgpr_read_b32 v129, a189
v_accvgpr_read_b32 v130, a190
v_accvgpr_read_b32 v131, a191
v_accvgpr_write_b32 a188, 0
v_accvgpr_write_b32 a189, 0
v_accvgpr_write_b32 a190, 0
v_accvgpr_write_b32 a191, 0
v_pk_mul_f32 v[128:129], v[128:129], s[26:27]
v_pk_mul_f32 v[130:131], v[130:131], s[26:27]
v_cvt_pk_bf16_f32 v226, v128, v129
v_cvt_pk_bf16_f32 v227, v130, v131
buffer_store_dwordx4 v[196:199], v10, s[28:31], s38 offen offset:0 nt
buffer_store_dwordx4 v[200:203], v10, s[28:31], s38 offen offset:1024 nt
buffer_store_dwordx4 v[204:207], v10, s[28:31], s38 offen offset:2048 nt
buffer_store_dwordx4 v[208:211], v10, s[28:31], s38 offen offset:3072 nt
buffer_store_dwordx4 v[212:215], v10, s[28:31], s74 offen offset:0 nt
buffer_store_dwordx4 v[216:219], v10, s[28:31], s74 offen offset:1024 nt
buffer_store_dwordx4 v[220:223], v10, s[28:31], s74 offen offset:2048 nt
buffer_store_dwordx4 v[224:227], v10, s[28:31], s74 offen offset:3072 nt
s_add_u32 s38, s38, 8192
s_add_u32 s74, s74, 8192
v_accvgpr_read_b32 v68, a192
v_accvgpr_read_b32 v69, a193
v_accvgpr_read_b32 v70, a194
v_accvgpr_read_b32 v71, a195
v_accvgpr_write_b32 a192, 0
v_accvgpr_write_b32 a193, 0
v_accvgpr_write_b32 a194, 0
v_accvgpr_write_b32 a195, 0
v_pk_mul_f32 v[68:69], v[68:69], s[26:27]
v_pk_mul_f32 v[70:71], v[70:71], s[26:27]
v_cvt_pk_bf16_f32 v196, v68, v69
v_cvt_pk_bf16_f32 v197, v70, v71
v_accvgpr_read_b32 v72, a200
v_accvgpr_read_b32 v73, a201
v_accvgpr_read_b32 v74, a202
v_accvgpr_read_b32 v75, a203
v_accvgpr_write_b32 a200, 0
v_accvgpr_write_b32 a201, 0
v_accvgpr_write_b32 a202, 0
v_accvgpr_write_b32 a203, 0
v_pk_mul_f32 v[72:73], v[72:73], s[26:27]
v_pk_mul_f32 v[74:75], v[74:75], s[26:27]
v_cvt_pk_bf16_f32 v198, v72, v73
v_cvt_pk_bf16_f32 v199, v74, v75
v_accvgpr_read_b32 v76, a196
v_accvgpr_read_b32 v77, a197
v_accvgpr_read_b32 v78, a198
v_accvgpr_read_b32 v79, a199
v_accvgpr_write_b32 a196, 0
v_accvgpr_write_b32 a197, 0
v_accvgpr_write_b32 a198, 0
v_accvgpr_write_b32 a199, 0
v_pk_mul_f32 v[76:77], v[76:77], s[26:27]
v_pk_mul_f32 v[78:79], v[78:79], s[26:27]
v_cvt_pk_bf16_f32 v200, v76, v77
v_cvt_pk_bf16_f32 v201, v78, v79
v_accvgpr_read_b32 v80, a204
v_accvgpr_read_b32 v81, a205
v_accvgpr_read_b32 v82, a206
v_accvgpr_read_b32 v83, a207
v_accvgpr_write_b32 a204, 0
v_accvgpr_write_b32 a205, 0
v_accvgpr_write_b32 a206, 0
v_accvgpr_write_b32 a207, 0
v_pk_mul_f32 v[80:81], v[80:81], s[26:27]
v_pk_mul_f32 v[82:83], v[82:83], s[26:27]
v_cvt_pk_bf16_f32 v202, v80, v81
v_cvt_pk_bf16_f32 v203, v82, v83
v_accvgpr_read_b32 v84, a208
v_accvgpr_read_b32 v85, a209
v_accvgpr_read_b32 v86, a210
v_accvgpr_read_b32 v87, a211
v_accvgpr_write_b32 a208, 0
v_accvgpr_write_b32 a209, 0
v_accvgpr_write_b32 a210, 0
v_accvgpr_write_b32 a211, 0
v_pk_mul_f32 v[84:85], v[84:85], s[26:27]
v_pk_mul_f32 v[86:87], v[86:87], s[26:27]
v_cvt_pk_bf16_f32 v204, v84, v85
v_cvt_pk_bf16_f32 v205, v86, v87
v_accvgpr_read_b32 v88, a216
v_accvgpr_read_b32 v89, a217
v_accvgpr_read_b32 v90, a218
v_accvgpr_read_b32 v91, a219
v_accvgpr_write_b32 a216, 0
v_accvgpr_write_b32 a217, 0
v_accvgpr_write_b32 a218, 0
v_accvgpr_write_b32 a219, 0
v_pk_mul_f32 v[88:89], v[88:89], s[26:27]
v_pk_mul_f32 v[90:91], v[90:91], s[26:27]
v_cvt_pk_bf16_f32 v206, v88, v89
v_cvt_pk_bf16_f32 v207, v90, v91
v_accvgpr_read_b32 v92, a212
v_accvgpr_read_b32 v93, a213
v_accvgpr_read_b32 v94, a214
v_accvgpr_read_b32 v95, a215
v_accvgpr_write_b32 a212, 0
v_accvgpr_write_b32 a213, 0
v_accvgpr_write_b32 a214, 0
v_accvgpr_write_b32 a215, 0
v_pk_mul_f32 v[92:93], v[92:93], s[26:27]
v_pk_mul_f32 v[94:95], v[94:95], s[26:27]
v_cvt_pk_bf16_f32 v208, v92, v93
v_cvt_pk_bf16_f32 v209, v94, v95
v_accvgpr_read_b32 v96, a220
v_accvgpr_read_b32 v97, a221
v_accvgpr_read_b32 v98, a222
v_accvgpr_read_b32 v99, a223
v_accvgpr_write_b32 a220, 0
v_accvgpr_write_b32 a221, 0
v_accvgpr_write_b32 a222, 0
v_accvgpr_write_b32 a223, 0
v_pk_mul_f32 v[96:97], v[96:97], s[26:27]
v_pk_mul_f32 v[98:99], v[98:99], s[26:27]
v_cvt_pk_bf16_f32 v210, v96, v97
v_cvt_pk_bf16_f32 v211, v98, v99
v_accvgpr_read_b32 v100, a224
v_accvgpr_read_b32 v101, a225
v_accvgpr_read_b32 v102, a226
v_accvgpr_read_b32 v103, a227
v_accvgpr_write_b32 a224, 0
v_accvgpr_write_b32 a225, 0
v_accvgpr_write_b32 a226, 0
v_accvgpr_write_b32 a227, 0
v_pk_mul_f32 v[100:101], v[100:101], s[26:27]
v_pk_mul_f32 v[102:103], v[102:103], s[26:27]
v_cvt_pk_bf16_f32 v212, v100, v101
v_cvt_pk_bf16_f32 v213, v102, v103
v_accvgpr_read_b32 v104, a232
v_accvgpr_read_b32 v105, a233
v_accvgpr_read_b32 v106, a234
v_accvgpr_read_b32 v107, a235
v_accvgpr_write_b32 a232, 0
v_accvgpr_write_b32 a233, 0
v_accvgpr_write_b32 a234, 0
v_accvgpr_write_b32 a235, 0
v_pk_mul_f32 v[104:105], v[104:105], s[26:27]
v_pk_mul_f32 v[106:107], v[106:107], s[26:27]
v_cvt_pk_bf16_f32 v214, v104, v105
v_cvt_pk_bf16_f32 v215, v106, v107
v_accvgpr_read_b32 v108, a228
v_accvgpr_read_b32 v109, a229
v_accvgpr_read_b32 v110, a230
v_accvgpr_read_b32 v111, a231
v_accvgpr_write_b32 a228, 0
v_accvgpr_write_b32 a229, 0
v_accvgpr_write_b32 a230, 0
v_accvgpr_write_b32 a231, 0
v_pk_mul_f32 v[108:109], v[108:109], s[26:27]
v_pk_mul_f32 v[110:111], v[110:111], s[26:27]
v_cvt_pk_bf16_f32 v216, v108, v109
v_cvt_pk_bf16_f32 v217, v110, v111
v_accvgpr_read_b32 v112, a236
v_accvgpr_read_b32 v113, a237
v_accvgpr_read_b32 v114, a238
v_accvgpr_read_b32 v115, a239
v_accvgpr_write_b32 a236, 0
v_accvgpr_write_b32 a237, 0
v_accvgpr_write_b32 a238, 0
v_accvgpr_write_b32 a239, 0
v_pk_mul_f32 v[112:113], v[112:113], s[26:27]
v_pk_mul_f32 v[114:115], v[114:115], s[26:27]
v_cvt_pk_bf16_f32 v218, v112, v113
v_cvt_pk_bf16_f32 v219, v114, v115
v_accvgpr_read_b32 v116, a240
v_accvgpr_read_b32 v117, a241
v_accvgpr_read_b32 v118, a242
v_accvgpr_read_b32 v119, a243
v_accvgpr_write_b32 a240, 0
v_accvgpr_write_b32 a241, 0
v_accvgpr_write_b32 a242, 0
v_accvgpr_write_b32 a243, 0
v_pk_mul_f32 v[116:117], v[116:117], s[26:27]
v_pk_mul_f32 v[118:119], v[118:119], s[26:27]
v_cvt_pk_bf16_f32 v220, v116, v117
v_cvt_pk_bf16_f32 v221, v118, v119
v_accvgpr_read_b32 v120, a248
v_accvgpr_read_b32 v121, a249
v_accvgpr_read_b32 v122, a250
v_accvgpr_read_b32 v123, a251
v_accvgpr_write_b32 a248, 0
v_accvgpr_write_b32 a249, 0
v_accvgpr_write_b32 a250, 0
v_accvgpr_write_b32 a251, 0
v_pk_mul_f32 v[120:121], v[120:121], s[26:27]
v_pk_mul_f32 v[122:123], v[122:123], s[26:27]
v_cvt_pk_bf16_f32 v222, v120, v121
v_cvt_pk_bf16_f32 v223, v122, v123
v_accvgpr_read_b32 v124, a244
v_accvgpr_read_b32 v125, a245
v_accvgpr_read_b32 v126, a246
v_accvgpr_read_b32 v127, a247
v_accvgpr_write_b32 a244, 0
v_accvgpr_write_b32 a245, 0
v_accvgpr_write_b32 a246, 0
v_accvgpr_write_b32 a247, 0
v_pk_mul_f32 v[124:125], v[124:125], s[26:27]
v_pk_mul_f32 v[126:127], v[126:127], s[26:27]
v_cvt_pk_bf16_f32 v224, v124, v125
v_cvt_pk_bf16_f32 v225, v126, v127
v_accvgpr_read_b32 v128, a252
v_accvgpr_read_b32 v129, a253
v_accvgpr_read_b32 v130, a254
v_accvgpr_read_b32 v131, a255
v_accvgpr_write_b32 a252, 0
v_accvgpr_write_b32 a253, 0
v_accvgpr_write_b32 a254, 0
v_accvgpr_write_b32 a255, 0
v_pk_mul_f32 v[128:129], v[128:129], s[26:27]
v_pk_mul_f32 v[130:131], v[130:131], s[26:27]
v_cvt_pk_bf16_f32 v226, v128, v129
v_cvt_pk_bf16_f32 v227, v130, v131
buffer_store_dwordx4 v[196:199], v10, s[28:31], s38 offen offset:0 nt
buffer_store_dwordx4 v[200:203], v10, s[28:31], s38 offen offset:1024 nt
buffer_store_dwordx4 v[204:207], v10, s[28:31], s38 offen offset:2048 nt
buffer_store_dwordx4 v[208:211], v10, s[28:31], s38 offen offset:3072 nt
buffer_store_dwordx4 v[212:215], v10, s[28:31], s74 offen offset:0 nt
buffer_store_dwordx4 v[216:219], v10, s[28:31], s74 offen offset:1024 nt
buffer_store_dwordx4 v[220:223], v10, s[28:31], s74 offen offset:2048 nt
buffer_store_dwordx4 v[224:227], v10, s[28:31], s74 offen offset:3072 nt
s_add_u32 s38, s38, 8192
s_add_u32 s74, s74, 8192
v_mov_b32 v132, 0
v_mov_b32 v133, 0
v_mov_b32 v134, 0
v_mov_b32 v135, 0
v_mov_b32 v136, 0
v_mov_b32 v137, 0
v_mov_b32 v138, 0
v_mov_b32 v139, 0
v_mov_b32 v140, 0
v_mov_b32 v141, 0
v_mov_b32 v142, 0
v_mov_b32 v143, 0
v_mov_b32 v144, 0
v_mov_b32 v145, 0
v_mov_b32 v146, 0
v_mov_b32 v147, 0
v_mov_b32 v148, 0
v_mov_b32 v149, 0
v_mov_b32 v150, 0
v_mov_b32 v151, 0
v_mov_b32 v152, 0
v_mov_b32 v153, 0
v_mov_b32 v154, 0
v_mov_b32 v155, 0
v_mov_b32 v156, 0
v_mov_b32 v157, 0
v_mov_b32 v158, 0
v_mov_b32 v159, 0
v_mov_b32 v160, 0
v_mov_b32 v161, 0
v_mov_b32 v162, 0
v_mov_b32 v163, 0
s_nop 3
v_mov_b32 v196, 0
v_mov_b32 v197, 0
v_mov_b32 v198, 0
v_mov_b32 v199, 0
v_mov_b32 v200, 0
v_mov_b32 v201, 0
v_mov_b32 v202, 0
v_mov_b32 v203, 0
v_mov_b32 v204, 0
v_mov_b32 v205, 0
v_mov_b32 v206, 0
v_mov_b32 v207, 0
v_mov_b32 v208, 0
v_mov_b32 v209, 0
v_mov_b32 v210, 0
v_mov_b32 v211, 0
v_mov_b32 v212, 0
v_mov_b32 v213, 0
v_mov_b32 v214, 0
v_mov_b32 v215, 0
v_mov_b32 v216, 0
v_mov_b32 v217, 0
v_mov_b32 v218, 0
v_mov_b32 v219, 0
v_mov_b32 v220, 0
v_mov_b32 v221, 0
v_mov_b32 v222, 0
v_mov_b32 v223, 0
v_mov_b32 v224, 0
v_mov_b32 v225, 0
v_mov_b32 v226, 0
v_mov_b32 v227, 0
s_mov_b32 s38, 0
s_movk_i32 s74, 4096
L_head_C:
s_waitcnt vmcnt(0) lgkmcnt(0)
s_barrier
ds_read_b128 v[228:231], v3 offset:0
ds_read_b128 v[232:235], v3 offset:64
ds_read_b128 v[236:239], v3 offset:1024
ds_read_b128 v[240:243], v3 offset:1088
ds_read_b128 v[244:247], v3 offset:512
ds_read_b128 v[248:251], v3 offset:576
ds_read_b128 v[252:255], v3 offset:1536
s_waitcnt lgkmcnt(6)
v_mfma_f32_16x16x32_bf16 v[36:39], v[228:231], v[164:167], 0
v_mfma_f32_16x16x32_bf16 v[44:47], v[228:231], v[168:171], 0
s_waitcnt lgkmcnt(5)
v_mfma_f32_16x16x32_bf16 v[36:39], v[232:235], v[172:175], v[36:39]
ds_read_b128 v[228:231], v3 offset:1600
v_mfma_f32_16x16x32_bf16 v[44:47], v[232:235], v[176:179], v[44:47]
s_waitcnt lgkmcnt(5)
v_mfma_f32_16x16x32_bf16 v[36:39], v[236:239], v[180:183], v[36:39]
v_mfma_f32_16x16x32_bf16 v[44:47], v[236:239], v[184:187], v[44:47]
s_waitcnt lgkmcnt(4)
v_mfma_f32_16x16x32_bf16 v[36:39], v[240:243], v[188:191], v[36:39]
v_mfma_f32_16x16x32_bf16 v[44:47], v[240:243], v[192:195], v[44:47]
s_waitcnt vmcnt(28) lgkmcnt(0)
s_barrier
ds_read_b64_tr_b16 v[240:241], v5 offset:0
ds_read_b64_tr_b16 v[242:243], v5 offset:512
v_mfma_f32_16x16x32_bf16 v[40:43], v[244:247], v[164:167], 0
v_mfma_f32_16x16x32_bf16 v[48:51], v[244:247], v[168:171], 0
ds_read_b64_tr_b16 v[244:245], v6 offset:0
ds_read_b64_tr_b16 v[246:247], v6 offset:512
v_mfma_f32_16x16x32_bf16 v[40:43], v[248:251], v[172:175], v[40:43]
v_mfma_f32_16x16x32_bf16 v[48:51], v[248:251], v[176:179], v[48:51]
ds_read_b64_tr_b16 v[248:249], v5 offset:64
ds_read_b64_tr_b16 v[250:251], v5 offset:576
v_mfma_f32_16x16x32_bf16 v[40:43], v[252:255], v[180:183], v[40:43]
v_mfma_f32_16x16x32_bf16 v[48:51], v[252:255], v[184:187], v[48:51]
ds_read_b64_tr_b16 v[252:253], v6 offset:64
ds_read_b64_tr_b16 v[254:255], v6 offset:576
v_mfma_f32_16x16x32_bf16 v[40:43], v[228:231], v[188:191], v[40:43]
s_add_u32 m0, s78, 100864
s_add_u32 s62, s62, 128
v_mfma_f32_16x16x32_bf16 v[48:51], v[228:231], v[192:195], v[48:51]
s_waitcnt lgkmcnt(6)
ds_read_b64_tr_b16 v[228:229], v5 offset:4352
ds_read_b64_tr_b16 v[230:231], v5 offset:4864
buffer_load_dwordx4 v4, s[48:51], s62 offen offset:0 nt lds
v_mfma_f32_16x16x32_bf16 a[0:3], v[240:243], v[196:199], a[0:3]
ds_read_b64_tr_b16 v[232:233], v6 offset:4352
ds_read_b64_tr_b16 v[234:235], v6 offset:4864
ds_read_b64_tr_b16 v[236:237], v5 offset:4416
ds_read_b64_tr_b16 v[238:239], v5 offset:4928
v_mfma_f32_16x16x32_bf16 a[4:7], v[240:243], v[200:203], a[4:7]
s_waitcnt lgkmcnt(10)
s_add_u32 m0, s78, 105216
s_add_u32 s62, s62, 128
v_mfma_f32_16x16x32_bf16 a[8:11], v[244:247], v[196:199], a[8:11]
ds_read_b64_tr_b16 v[240:241], v6 offset:4416
ds_read_b64_tr_b16 v[242:243], v6 offset:4928
v_mfma_f32_16x16x32_bf16 a[12:15], v[244:247], v[200:203], a[12:15]
s_waitcnt lgkmcnt(10)
buffer_load_dwordx4 v4, s[48:51], s62 offen offset:0 nt lds
s_add_u32 m0, s78, 109568
v_max3_f32 v15, v36, v37, v38
v_max3_f32 v16, v39, v40, v41
v_max3_f32 v15, v15, v42, v43
v_max_f32 v15, v15, v16
v_mov_b32 v16, v15
s_nop 1
v_permlane32_swap_b32 v15, v16
v_max_f32 v15, v15, v16
v_mov_b32 v16, v15
s_nop 1
v_permlane16_swap_b32 v15, v16
v_max_f32 v15, v15, v16
v_sub_f32 v20, 0, v15
v_sub_f32 v21, 0, v15
v_sub_f32 v22, 0, v15
v_sub_f32 v23, 0, v15
v_sub_f32 v36, v36, v15
v_sub_f32 v37, v37, v15
v_sub_f32 v38, v38, v15
v_sub_f32 v39, v39, v15
v_sub_f32 v40, v40, v15
v_sub_f32 v41, v41, v15
v_sub_f32 v42, v42, v15
v_sub_f32 v43, v43, v15
v_mov_b32 v11, 0
v_max3_f32 v15, v44, v45, v46
v_max3_f32 v16, v47, v48, v49
v_max3_f32 v15, v15, v50, v51
v_max_f32 v15, v15, v16
v_mov_b32 v16, v15
s_nop 1
v_permlane32_swap_b32 v15, v16
v_max_f32 v15, v15, v16
v_mov_b32 v16, v15
s_nop 1
v_permlane16_swap_b32 v15, v16
v_max_f32 v15, v15, v16
v_sub_f32 v24, 0, v15
v_sub_f32 v25, 0, v15
v_sub_f32 v26, 0, v15
v_mfma_f32_16x16x32_bf16 a[16:19], v[248:251], v[196:199], a[16:19]
ds_read_b128 v[244:247], v3 offset:8256
s_add_u32 s62, s62, 128
v_mfma_f32_16x16x32_bf16 a[20:23], v[248:251], v[200:203], a[20:23]
s_waitcnt lgkmcnt(9)
buffer_load_dwordx4 v4, s[48:51], s62 offen offset:0 nt lds
v_sub_f32 v27, 0, v15
v_sub_f32 v44, v44, v15
v_mfma_f32_16x16x32_bf16 a[24:27], v[252:255], v[196:199], a[24:27]
ds_read_b128 v[248:251], v3 offset:8320
s_add_u32 m0, s69, 33024
v_mfma_f32_16x16x32_bf16 a[28:31], v[252:255], v[200:203], a[28:31]
s_waitcnt lgkmcnt(8)
s_add_u32 s64, s64, 8192
v_sub_f32 v45, v45, v15
v_sub_f32 v46, v46, v15
v_mfma_f32_16x16x32_bf16 a[32:35], v[228:231], v[196:199], a[32:35]
ds_read_b128 v[252:255], v3 offset:9280
s_add_u32 s66, s66, 8192
v_mfma_f32_16x16x32_bf16 a[36:39], v[228:231], v[200:203], a[36:39]
s_waitcnt lgkmcnt(7)
buffer_load_dwordx4 v7, s[80:83], s64 offen offset:0 nt lds
v_sub_f32 v47, v47, v15
v_sub_f32 v48, v48, v15
v_mfma_f32_16x16x32_bf16 a[40:43], v[232:235], v[196:199], a[40:43]
ds_read_b128 v[228:231], v3 offset:9344
buffer_load_dwordx4 v7, s[80:83], s66 offen offset:1024 nt lds
v_mfma_f32_16x16x32_bf16 a[44:47], v[232:235], v[200:203], a[44:47]
s_waitcnt lgkmcnt(6)
s_add_u32 m0, s76, 16512
v_sub_f32 v49, v49, v15
v_sub_f32 v50, v50, v15
v_mfma_f32_16x16x32_bf16 a[48:51], v[236:239], v[196:199], a[48:51]
ds_read_b128 v[232:235], v3 offset:8768
s_add_u32 s65, s65, 8192
v_mfma_f32_16x16x32_bf16 a[52:55], v[236:239], v[200:203], a[52:55]
s_waitcnt lgkmcnt(5)
s_add_u32 s67, s67, 8192
v_sub_f32 v51, v51, v15
v_mov_b32 v12, 0
v_mfma_f32_16x16x32_bf16 a[56:59], v[240:243], v[196:199], a[56:59]
ds_read_b128 v[236:239], v3 offset:8832
buffer_load_dwordx4 v8, s[92:95], s65 offen offset:0 nt lds
v_mfma_f32_16x16x32_bf16 a[60:63], v[240:243], v[200:203], a[60:63]
s_waitcnt lgkmcnt(5)
buffer_load_dwordx4 v8, s[92:95], s67 offen offset:1024 nt lds
v_exp_f32 v16, v36
v_exp_f32 v17, v37
v_mov_b32 v13, v16
v_add_f32 v13, v13, v17
v_cvt_pk_bf16_f32 v28, v16, v17
v_exp_f32 v18, v38
v_exp_f32 v19, v39
v_add_f32 v13, v13, v18
v_add_f32 v13, v13, v19
v_cvt_pk_bf16_f32 v29, v18, v19
v_exp_f32 v16, v40
v_exp_f32 v17, v41
v_add_f32 v13, v13, v16
v_add_f32 v13, v13, v17
v_cvt_pk_bf16_f32 v30, v16, v17
v_exp_f32 v18, v42
v_exp_f32 v19, v43
v_add_f32 v13, v13, v18
v_add_f32 v13, v13, v19
v_cvt_pk_bf16_f32 v31, v18, v19
v_exp_f32 v16, v44
v_exp_f32 v17, v45
v_mov_b32 v14, v16
v_add_f32 v14, v14, v17
v_cvt_pk_bf16_f32 v32, v16, v17
v_exp_f32 v18, v46
v_exp_f32 v19, v47
v_add_f32 v14, v14, v18
v_mfma_f32_16x16x32_bf16 v[52:55], v[244:247], v[164:167], v[20:23]
ds_read_b128 v[240:243], v3 offset:9792
v_add_f32 v14, v14, v19
v_mfma_f32_16x16x32_bf16 v[60:63], v[244:247], v[168:171], v[24:27]
s_waitcnt lgkmcnt(5)
v_cvt_pk_bf16_f32 v33, v18, v19
v_mfma_f32_16x16x32_bf16 v[52:55], v[248:251], v[172:175], v[52:55]
ds_read_b128 v[244:247], v3 offset:9856
v_mfma_f32_16x16x32_bf16 v[60:63], v[248:251], v[176:179], v[60:63]
s_waitcnt lgkmcnt(5)
v_exp_f32 v16, v48
v_mfma_f32_16x16x32_bf16 v[52:55], v[252:255], v[180:183], v[52:55]
v_exp_f32 v17, v49
v_mfma_f32_16x16x32_bf16 v[60:63], v[252:255], v[184:187], v[60:63]
s_waitcnt lgkmcnt(4)
v_add_f32 v14, v14, v16
v_mfma_f32_16x16x32_bf16 v[52:55], v[228:231], v[188:191], v[52:55]
v_add_f32 v14, v14, v17
v_cvt_pk_bf16_f32 v34, v16, v17
v_mfma_f32_16x16x32_bf16 v[60:63], v[228:231], v[192:195], v[60:63]
s_waitcnt vmcnt(33) lgkmcnt(0)
s_barrier
ds_read_b64_tr_b16 v[248:249], v1 offset:0
ds_read_b64_tr_b16 v[250:251], v1 offset:512
v_mfma_f32_16x16x32_bf16 v[56:59], v[232:235], v[164:167], v[20:23]
ds_read_b64_tr_b16 v[252:253], v1 offset:8
ds_read_b64_tr_b16 v[254:255], v1 offset:520
ds_read_b64_tr_b16 v[228:229], v2 offset:0
ds_read_b64_tr_b16 v[230:231], v2 offset:512
v_mfma_f32_16x16x32_bf16 v[64:67], v[232:235], v[168:171], v[24:27]
v_exp_f32 v18, v50
v_mfma_f32_16x16x32_bf16 v[56:59], v[236:239], v[172:175], v[56:59]
ds_read_b64_tr_b16 v[232:233], v2 offset:8
ds_read_b64_tr_b16 v[234:235], v2 offset:520
v_mfma_f32_16x16x32_bf16 v[64:67], v[236:239], v[176:179], v[64:67]
v_exp_f32 v19, v51
v_mfma_f32_16x16x32_bf16 v[56:59], v[240:243], v[180:183], v[56:59]
ds_read_b64_tr_b16 v[236:237], v1 offset:1024
ds_read_b64_tr_b16 v[238:239], v1 offset:1536
v_mfma_f32_16x16x32_bf16 v[64:67], v[240:243], v[184:187], v[64:67]
v_add_f32 v14, v14, v18
v_add_f32 v14, v14, v19
v_mfma_f32_16x16x32_bf16 v[56:59], v[244:247], v[188:191], v[56:59]
ds_read_b64_tr_b16 v[240:241], v1 offset:1032
ds_read_b64_tr_b16 v[242:243], v1 offset:1544
v_mfma_f32_16x16x32_bf16 v[64:67], v[244:247], v[192:195], v[64:67]
s_waitcnt lgkmcnt(10)
v_cvt_pk_bf16_f32 v35, v18, v19
v_add_f32 v11, v11, v13
v_add_f32 v12, v12, v14
s_nop 0
v_mfma_f32_16x16x32_bf16 v[68:71], v[248:251], v[28:31], 0
ds_read_b64_tr_b16 v[244:245], v2 offset:1024
ds_read_b64_tr_b16 v[246:247], v2 offset:1536
v_mfma_f32_16x16x32_bf16 v[72:75], v[248:251], v[32:35], 0
s_waitcnt lgkmcnt(10)
v_mfma_f32_16x16x32_bf16 v[76:79], v[252:255], v[28:31], 0
ds_read_b64_tr_b16 v[248:249], v2 offset:1032
ds_read_b64_tr_b16 v[250:251], v2 offset:1544
v_mfma_f32_16x16x32_bf16 v[80:83], v[252:255], v[32:35], 0
s_waitcnt lgkmcnt(10)
v_exp_f32 v16, v52
v_exp_f32 v17, v53
v_mov_b32 v13, v16
v_add_f32 v13, v13, v17
v_mfma_f32_16x16x32_bf16 v[84:87], v[228:231], v[28:31], 0
ds_read_b64_tr_b16 v[252:253], v5 offset:17408
ds_read_b64_tr_b16 v[254:255], v5 offset:17920
v_mfma_f32_16x16x32_bf16 v[88:91], v[228:231], v[32:35], 0
s_waitcnt lgkmcnt(10)
v_mfma_f32_16x16x32_bf16 v[92:95], v[232:235], v[28:31], 0
ds_read_b64_tr_b16 v[228:229], v6 offset:17408
ds_read_b64_tr_b16 v[230:231], v6 offset:17920
v_mfma_f32_16x16x32_bf16 v[96:99], v[232:235], v[32:35], 0
s_waitcnt lgkmcnt(10)
v_mfma_f32_16x16x32_bf16 v[100:103], v[236:239], v[28:31], 0
ds_read_b64_tr_b16 v[232:233], v5 offset:17472
ds_read_b64_tr_b16 v[234:235], v5 offset:17984
v_mfma_f32_16x16x32_bf16 v[104:107], v[236:239], v[32:35], 0
s_waitcnt lgkmcnt(10)
v_mfma_f32_16x16x32_bf16 v[108:111], v[240:243], v[28:31], 0
ds_read_b64_tr_b16 v[236:237], v6 offset:17472
ds_read_b64_tr_b16 v[238:239], v6 offset:17984
v_mfma_f32_16x16x32_bf16 v[112:115], v[240:243], v[32:35], 0
s_waitcnt lgkmcnt(10)
v_mfma_f32_16x16x32_bf16 v[116:119], v[244:247], v[28:31], 0
ds_read_b64_tr_b16 v[240:241], v5 offset:21760
ds_read_b64_tr_b16 v[242:243], v5 offset:22272
v_mfma_f32_16x16x32_bf16 v[120:123], v[244:247], v[32:35], 0
s_waitcnt lgkmcnt(10)
v_mfma_f32_16x16x32_bf16 v[124:127], v[248:251], v[28:31], 0
ds_read_b64_tr_b16 v[244:245], v6 offset:21760
ds_read_b64_tr_b16 v[246:247], v6 offset:22272
v_mfma_f32_16x16x32_bf16 v[128:131], v[248:251], v[32:35], 0
s_waitcnt lgkmcnt(10)
s_add_u32 m0, s78, 66048
s_add_u32 s62, s62, 35840
v_cvt_pk_bf16_f32 v28, v16, v17
v_exp_f32 v18, v54
v_exp_f32 v19, v55
v_add_f32 v13, v13, v18
v_add_f32 v13, v13, v19
v_cvt_pk_bf16_f32 v29, v18, v19
v_exp_f32 v16, v56
v_exp_f32 v17, v57
v_add_f32 v13, v13, v16
v_add_f32 v13, v13, v17
v_cvt_pk_bf16_f32 v30, v16, v17
v_exp_f32 v18, v58
v_exp_f32 v19, v59
v_mfma_f32_16x16x32_bf16 a[64:67], v[252:255], v[196:199], a[64:67]
ds_read_b64_tr_b16 v[248:249], v5 offset:21824
ds_read_b64_tr_b16 v[250:251], v5 offset:22336
v_mfma_f32_16x16x32_bf16 a[68:71], v[252:255], v[200:203], a[68:71]
s_waitcnt lgkmcnt(10)
buffer_load_dwordx4 v4, s[48:51], s62 offen offset:0 nt lds
s_add_u32 m0, s78, 70400
v_add_f32 v13, v13, v18
v_mfma_f32_16x16x32_bf16 a[72:75], v[228:231], v[196:199], a[72:75]
ds_read_b64_tr_b16 v[252:253], v6 offset:21824
ds_read_b64_tr_b16 v[254:255], v6 offset:22336
v_mfma_f32_16x16x32_bf16 a[76:79], v[228:231], v[200:203], a[76:79]
s_waitcnt lgkmcnt(10)
s_add_u32 s62, s62, 128
buffer_load_dwordx4 v4, s[48:51], s62 offen offset:0 nt lds
v_add_f32 v13, v13, v19
v_cvt_pk_bf16_f32 v31, v18, v19
v_mfma_f32_16x16x32_bf16 a[80:83], v[232:235], v[196:199], a[80:83]
ds_read_b128 v[228:231], v3 offset:16512
s_add_u32 m0, s69, 41280
v_mfma_f32_16x16x32_bf16 a[84:87], v[232:235], v[200:203], a[84:87]
s_waitcnt lgkmcnt(9)
s_add_u32 s64, s64, 8192
v_exp_f32 v16, v60
v_mfma_f32_16x16x32_bf16 a[88:91], v[236:239], v[196:199], a[88:91]
ds_read_b128 v[232:235], v3 offset:16576
s_add_u32 s66, s66, 8192
v_mfma_f32_16x16x32_bf16 a[92:95], v[236:239], v[200:203], a[92:95]
s_waitcnt lgkmcnt(8)
buffer_load_dwordx4 v7, s[80:83], s64 offen offset:0 nt lds
v_exp_f32 v17, v61
v_mfma_f32_16x16x32_bf16 a[96:99], v[240:243], v[196:199], a[96:99]
ds_read_b128 v[236:239], v3 offset:17536
buffer_load_dwordx4 v7, s[80:83], s66 offen offset:1024 nt lds
v_mfma_f32_16x16x32_bf16 a[100:103], v[240:243], v[200:203], a[100:103]
s_waitcnt lgkmcnt(7)
s_add_u32 m0, s76, 24768
v_mov_b32 v14, v16
v_add_f32 v14, v14, v17
v_mfma_f32_16x16x32_bf16 a[104:107], v[244:247], v[196:199], a[104:107]
ds_read_b128 v[240:243], v3 offset:17600
s_add_u32 s65, s65, 8192
v_mfma_f32_16x16x32_bf16 a[108:111], v[244:247], v[200:203], a[108:111]
s_waitcnt lgkmcnt(6)
s_add_u32 s67, s67, 8192
v_cvt_pk_bf16_f32 v32, v16, v17
v_exp_f32 v18, v62
v_mfma_f32_16x16x32_bf16 a[112:115], v[248:251], v[196:199], a[112:115]
ds_read_b128 v[244:247], v3 offset:17024
buffer_load_dwordx4 v8, s[92:95], s65 offen offset:0 nt lds
v_mfma_f32_16x16x32_bf16 a[116:119], v[248:251], v[200:203], a[116:119]
s_waitcnt lgkmcnt(5)
buffer_load_dwordx4 v8, s[92:95], s67 offen offset:1024 nt lds
v_exp_f32 v19, v63
v_mfma_f32_16x16x32_bf16 a[120:123], v[252:255], v[196:199], a[120:123]
ds_read_b128 v[248:251], v3 offset:17088
buffer_load_dword v0, v9, s[48:51], s89 offen offset:0
v_mfma_f32_16x16x32_bf16 a[124:127], v[252:255], v[200:203], a[124:127]
s_waitcnt lgkmcnt(5)
s_add_u32 s89, s89, 147456
v_add_f32 v14, v14, v18
v_mfma_f32_16x16x32_bf16 v[36:39], v[228:231], v[164:167], v[20:23]
ds_read_b128 v[252:255], v3 offset:18048
v_add_f32 v14, v14, v19
v_mfma_f32_16x16x32_bf16 v[44:47], v[228:231], v[168:171], v[24:27]
s_waitcnt lgkmcnt(5)
v_cvt_pk_bf16_f32 v33, v18, v19
v_mfma_f32_16x16x32_bf16 v[36:39], v[232:235], v[172:175], v[36:39]
ds_read_b128 v[228:231], v3 offset:18112
v_mfma_f32_16x16x32_bf16 v[44:47], v[232:235], v[176:179], v[44:47]
s_waitcnt lgkmcnt(5)
v_exp_f32 v16, v64
v_mfma_f32_16x16x32_bf16 v[36:39], v[236:239], v[180:183], v[36:39]
v_exp_f32 v17, v65
v_mfma_f32_16x16x32_bf16 v[44:47], v[236:239], v[184:187], v[44:47]
s_waitcnt lgkmcnt(4)
v_add_f32 v14, v14, v16
v_mfma_f32_16x16x32_bf16 v[36:39], v[240:243], v[188:191], v[36:39]
v_add_f32 v14, v14, v17
v_cvt_pk_bf16_f32 v34, v16, v17
v_mfma_f32_16x16x32_bf16 v[44:47], v[240:243], v[192:195], v[44:47]
s_waitcnt vmcnt(38) lgkmcnt(0)
s_barrier
ds_read_b64_tr_b16 v[236:237], v1 offset:8256
ds_read_b64_tr_b16 v[238:239], v1 offset:8768
v_mfma_f32_16x16x32_bf16 v[40:43], v[244:247], v[164:167], v[20:23]
ds_read_b64_tr_b16 v[240:241], v1 offset:8264
ds_read_b64_tr_b16 v[242:243], v1 offset:8776
v_mfma_f32_16x16x32_bf16 v[48:51], v[244:247], v[168:171], v[24:27]
v_exp_f32 v18, v66
v_mfma_f32_16x16x32_bf16 v[40:43], v[248:251], v[172:175], v[40:43]
ds_read_b64_tr_b16 v[244:245], v2 offset:8256
ds_read_b64_tr_b16 v[246:247], v2 offset:8768
v_mfma_f32_16x16x32_bf16 v[48:51], v[248:251], v[176:179], v[48:51]
v_exp_f32 v19, v67
v_mfma_f32_16x16x32_bf16 v[40:43], v[252:255], v[180:183], v[40:43]
ds_read_b64_tr_b16 v[248:249], v2 offset:8264
ds_read_b64_tr_b16 v[250:251], v2 offset:8776
v_mfma_f32_16x16x32_bf16 v[48:51], v[252:255], v[184:187], v[48:51]
v_add_f32 v14, v14, v18
v_add_f32 v14, v14, v19
v_mfma_f32_16x16x32_bf16 v[40:43], v[228:231], v[188:191], v[40:43]
ds_read_b64_tr_b16 v[252:253], v1 offset:9280
ds_read_b64_tr_b16 v[254:255], v1 offset:9792
v_mfma_f32_16x16x32_bf16 v[48:51], v[228:231], v[192:195], v[48:51]
s_waitcnt lgkmcnt(8)
v_cvt_pk_bf16_f32 v35, v18, v19
v_add_f32 v15, v13, v14
v_cmp_nle_f32 s[70:71], v15, s73
s_cmp_lg_u64 s[70:71], 0
s_cbranch_scc1 L_tr_CB1
L_back_CB1:
v_add_f32 v11, v11, v13
v_add_f32 v12, v12, v14
v_mfma_f32_16x16x32_bf16 v[68:71], v[236:239], v[28:31], v[68:71]
ds_read_b64_tr_b16 v[228:229], v1 offset:9288
ds_read_b64_tr_b16 v[230:231], v1 offset:9800
ds_read_b64_tr_b16 v[232:233], v2 offset:9280
ds_read_b64_tr_b16 v[234:235], v2 offset:9792
v_mfma_f32_16x16x32_bf16 v[72:75], v[236:239], v[32:35], v[72:75]
s_waitcnt lgkmcnt(10)
v_mfma_f32_16x16x32_bf16 v[76:79], v[240:243], v[28:31], v[76:79]
ds_read_b64_tr_b16 v[236:237], v2 offset:9288
ds_read_b64_tr_b16 v[238:239], v2 offset:9800
v_mfma_f32_16x16x32_bf16 v[80:83], v[240:243], v[32:35], v[80:83]
s_waitcnt lgkmcnt(10)
v_exp_f32 v16, v36
v_exp_f32 v17, v37
v_mov_b32 v13, v16
v_add_f32 v13, v13, v17
v_mfma_f32_16x16x32_bf16 v[84:87], v[244:247], v[28:31], v[84:87]
ds_read_b64_tr_b16 v[240:241], v5 offset:52224
ds_read_b64_tr_b16 v[242:243], v5 offset:52736
v_mfma_f32_16x16x32_bf16 v[88:91], v[244:247], v[32:35], v[88:91]
s_waitcnt lgkmcnt(10)
v_mfma_f32_16x16x32_bf16 v[92:95], v[248:251], v[28:31], v[92:95]
ds_read_b64_tr_b16 v[244:245], v6 offset:52224
ds_read_b64_tr_b16 v[246:247], v6 offset:52736
v_mfma_f32_16x16x32_bf16 v[96:99], v[248:251], v[32:35], v[96:99]
s_waitcnt lgkmcnt(10)
v_mfma_f32_16x16x32_bf16 v[100:103], v[252:255], v[28:31], v[100:103]
ds_read_b64_tr_b16 v[248:249], v5 offset:52288
ds_read_b64_tr_b16 v[250:251], v5 offset:52800
v_mfma_f32_16x16x32_bf16 v[104:107], v[252:255], v[32:35], v[104:107]
s_waitcnt lgkmcnt(10)
v_mfma_f32_16x16x32_bf16 v[108:111], v[228:231], v[28:31], v[108:111]
ds_read_b64_tr_b16 v[252:253], v6 offset:52288
ds_read_b64_tr_b16 v[254:255], v6 offset:52800
v_mfma_f32_16x16x32_bf16 v[112:115], v[228:231], v[32:35], v[112:115]
s_waitcnt lgkmcnt(10)
v_mfma_f32_16x16x32_bf16 v[116:119], v[232:235], v[28:31], v[116:119]
ds_read_b64_tr_b16 v[228:229], v5 offset:56576
ds_read_b64_tr_b16 v[230:231], v5 offset:57088
v_mfma_f32_16x16x32_bf16 v[120:123], v[232:235], v[32:35], v[120:123]
s_waitcnt lgkmcnt(10)
v_mfma_f32_16x16x32_bf16 v[124:127], v[236:239], v[28:31], v[124:127]
ds_read_b64_tr_b16 v[232:233], v6 offset:56576
ds_read_b64_tr_b16 v[234:235], v6 offset:57088
v_mfma_f32_16x16x32_bf16 v[128:131], v[236:239], v[32:35], v[128:131]
s_waitcnt lgkmcnt(10)
s_add_u32 m0, s78, 83456
v_cvt_pk_bf16_f32 v28, v16, v17
v_exp_f32 v18, v38
v_exp_f32 v19, v39
v_add_f32 v13, v13, v18
v_add_f32 v13, v13, v19
v_cvt_pk_bf16_f32 v29, v18, v19
v_exp_f32 v16, v40
v_exp_f32 v17, v41
v_add_f32 v13, v13, v16
v_add_f32 v13, v13, v17
v_cvt_pk_bf16_f32 v30, v16, v17
v_exp_f32 v18, v42
v_exp_f32 v19, v43
v_mfma_f32_16x16x32_bf16 a[128:131], v[240:243], v[196:199], a[128:131]
ds_read_b64_tr_b16 v[236:237], v5 offset:56640
ds_read_b64_tr_b16 v[238:239], v5 offset:57152
v_mfma_f32_16x16x32_bf16 a[132:135], v[240:243], v[200:203], a[132:135]
s_waitcnt lgkmcnt(10)
s_add_u32 s62, s62, 128
v_add_f32 v13, v13, v18
v_mfma_f32_16x16x32_bf16 a[136:139], v[244:247], v[196:199], a[136:139]
ds_read_b64_tr_b16 v[240:241], v6 offset:56640
ds_read_b64_tr_b16 v[242:243], v6 offset:57152
v_mfma_f32_16x16x32_bf16 a[140:143], v[244:247], v[200:203], a[140:143]
s_waitcnt lgkmcnt(10)
buffer_load_dwordx4 v4, s[48:51], s62 offen offset:0 nt lds
s_add_u32 m0, s78, 87808
v_add_f32 v13, v13, v19
v_cvt_pk_bf16_f32 v31, v18, v19
v_mfma_f32_16x16x32_bf16 a[144:147], v[248:251], v[196:199], a[144:147]
ds_read_b128 v[244:247], v3 offset:24768
s_add_u32 s62, s62, 128
v_mfma_f32_16x16x32_bf16 a[148:151], v[248:251], v[200:203], a[148:151]
s_waitcnt lgkmcnt(9)
buffer_load_dwordx4 v4, s[48:51], s62 offen offset:0 nt lds
v_exp_f32 v16, v44
v_mfma_f32_16x16x32_bf16 a[152:155], v[252:255], v[196:199], a[152:155]
ds_read_b128 v[248:251], v3 offset:24832
s_add_u32 m0, s69, 49536
v_mfma_f32_16x16x32_bf16 a[156:159], v[252:255], v[200:203], a[156:159]
s_waitcnt lgkmcnt(8)
s_add_u32 s64, s64, 8192
v_exp_f32 v17, v45
v_mfma_f32_16x16x32_bf16 a[160:163], v[228:231], v[196:199], a[160:163]
ds_read_b128 v[252:255], v3 offset:25792
s_add_u32 s66, s66, 8192
v_mfma_f32_16x16x32_bf16 a[164:167], v[228:231], v[200:203], a[164:167]
s_waitcnt lgkmcnt(7)
buffer_load_dwordx4 v7, s[80:83], s64 offen offset:0 nt lds
v_mov_b32 v14, v16
v_add_f32 v14, v14, v17
v_mfma_f32_16x16x32_bf16 a[168:171], v[232:235], v[196:199], a[168:171]
ds_read_b128 v[228:231], v3 offset:25856
buffer_load_dwordx4 v7, s[80:83], s66 offen offset:1024 nt lds
v_mfma_f32_16x16x32_bf16 a[172:175], v[232:235], v[200:203], a[172:175]
s_waitcnt lgkmcnt(6)
s_add_u32 m0, s76, 0
v_cvt_pk_bf16_f32 v32, v16, v17
v_exp_f32 v18, v46
v_mfma_f32_16x16x32_bf16 a[176:179], v[236:239], v[196:199], a[176:179]
ds_read_b128 v[232:235], v3 offset:25280
s_add_u32 s65, s65, 8192
v_mfma_f32_16x16x32_bf16 a[180:183], v[236:239], v[200:203], a[180:183]
s_waitcnt lgkmcnt(5)
s_add_u32 s67, s67, 8192
v_exp_f32 v19, v47
v_mfma_f32_16x16x32_bf16 a[184:187], v[240:243], v[196:199], a[184:187]
ds_read_b128 v[236:239], v3 offset:25344
buffer_load_dwordx4 v8, s[92:95], s65 offen offset:0 nt lds
v_mfma_f32_16x16x32_bf16 a[188:191], v[240:243], v[200:203], a[188:191]
s_waitcnt lgkmcnt(5)
buffer_load_dwordx4 v8, s[92:95], s67 offen offset:1024 nt lds
v_add_f32 v14, v14, v18
v_mfma_f32_16x16x32_bf16 v[52:55], v[244:247], v[164:167], v[20:23]
ds_read_b128 v[240:243], v3 offset:26304
v_add_f32 v14, v14, v19
v_mfma_f32_16x16x32_bf16 v[60:63], v[244:247], v[168:171], v[24:27]
s_waitcnt lgkmcnt(5)
v_cvt_pk_bf16_f32 v33, v18, v19
v_mfma_f32_16x16x32_bf16 v[52:55], v[248:251], v[172:175], v[52:55]
ds_read_b128 v[244:247], v3 offset:26368
v_mfma_f32_16x16x32_bf16 v[60:63], v[248:251], v[176:179], v[60:63]
s_waitcnt lgkmcnt(5)
v_exp_f32 v16, v48
v_mfma_f32_16x16x32_bf16 v[52:55], v[252:255], v[180:183], v[52:55]
v_exp_f32 v17, v49
v_mfma_f32_16x16x32_bf16 v[60:63], v[252:255], v[184:187], v[60:63]
s_waitcnt lgkmcnt(4)
v_add_f32 v14, v14, v16
v_mfma_f32_16x16x32_bf16 v[52:55], v[228:231], v[188:191], v[52:55]
v_add_f32 v14, v14, v17
v_cvt_pk_bf16_f32 v34, v16, v17
v_mfma_f32_16x16x32_bf16 v[60:63], v[228:231], v[192:195], v[60:63]
s_mov_b32 s39, 3
L_loop2:
s_waitcnt vmcnt(12) lgkmcnt(0)
s_barrier
ds_read_b64_tr_b16 v[252:253], v1 offset:16512
ds_read_b64_tr_b16 v[254:255], v1 offset:17024
v_mfma_f32_16x16x32_bf16 v[56:59], v[232:235], v[164:167], v[20:23]
ds_read_b64_tr_b16 v[228:229], v1 offset:16520
ds_read_b64_tr_b16 v[230:231], v1 offset:17032
v_mfma_f32_16x16x32_bf16 v[64:67], v[232:235], v[168:171], v[24:27]
v_exp_f32 v18, v50
v_mfma_f32_16x16x32_bf16 v[56:59], v[236:239], v[172:175], v[56:59]
ds_read_b64_tr_b16 v[232:233], v2 offset:16512
ds_read_b64_tr_b16 v[234:235], v2 offset:17024
v_mfma_f32_16x16x32_bf16 v[64:67], v[236:239], v[176:179], v[64:67]
v_exp_f32 v19, v51
v_mfma_f32_16x16x32_bf16 v[56:59], v[240:243], v[180:183], v[56:59]
ds_read_b64_tr_b16 v[236:237], v2 offset:16520
ds_read_b64_tr_b16 v[238:239], v2 offset:17032
v_mfma_f32_16x16x32_bf16 v[64:67], v[240:243], v[184:187], v[64:67]
v_add_f32 v14, v14, v18
v_add_f32 v14, v14, v19
v_mfma_f32_16x16x32_bf16 v[56:59], v[244:247], v[188:191], v[56:59]
ds_read_b64_tr_b16 v[240:241], v1 offset:17536
ds_read_b64_tr_b16 v[242:243], v1 offset:18048
v_mfma_f32_16x16x32_bf16 v[64:67], v[244:247], v[192:195], v[64:67]
s_waitcnt lgkmcnt(8)
v_cvt_pk_bf16_f32 v35, v18, v19
v_add_f32 v15, v13, v14
v_cmp_nle_f32 s[70:71], v15, s73
s_cmp_lg_u64 s[70:71], 0
s_cbranch_scc1 L_tr_CB2
L_back_CB2:
v_add_f32 v11, v11, v13
v_add_f32 v12, v12, v14
v_mfma_f32_16x16x32_bf16 v[68:71], v[252:255], v[28:31], v[68:71]
ds_read_b64_tr_b16 v[244:245], v1 offset:17544
ds_read_b64_tr_b16 v[246:247], v1 offset:18056
ds_read_b64_tr_b16 v[248:249], v2 offset:17536
ds_read_b64_tr_b16 v[250:251], v2 offset:18048
v_mfma_f32_16x16x32_bf16 v[72:75], v[252:255], v[32:35], v[72:75]
s_waitcnt lgkmcnt(10)
v_mfma_f32_16x16x32_bf16 v[76:79], v[228:231], v[28:31], v[76:79]
ds_read_b64_tr_b16 v[252:253], v2 offset:17544
ds_read_b64_tr_b16 v[254:255], v2 offset:18056
v_mfma_f32_16x16x32_bf16 v[80:83], v[228:231], v[32:35], v[80:83]
s_waitcnt lgkmcnt(10)
v_exp_f32 v16, v52
v_exp_f32 v17, v53
v_mfma_f32_16x16x32_bf16 v[84:87], v[232:235], v[28:31], v[84:87]
ds_read_b64_tr_b16 v[228:229], v5 offset:34816
ds_read_b64_tr_b16 v[230:231], v5 offset:35328
v_mfma_f32_16x16x32_bf16 v[88:91], v[232:235], v[32:35], v[88:91]
s_waitcnt lgkmcnt(10)
v_mov_b32 v13, v16
v_add_f32 v13, v13, v17
v_mfma_f32_16x16x32_bf16 v[92:95], v[236:239], v[28:31], v[92:95]
ds_read_b64_tr_b16 v[232:233], v6 offset:34816
ds_read_b64_tr_b16 v[234:235], v6 offset:35328
v_mfma_f32_16x16x32_bf16 v[96:99], v[236:239], v[32:35], v[96:99]
s_waitcnt lgkmcnt(10)
v_mfma_f32_16x16x32_bf16 v[100:103], v[240:243], v[28:31], v[100:103]
ds_read_b64_tr_b16 v[236:237], v5 offset:34880
ds_read_b64_tr_b16 v[238:239], v5 offset:35392
v_mfma_f32_16x16x32_bf16 v[104:107], v[240:243], v[32:35], v[104:107]
s_waitcnt lgkmcnt(10)
v_mfma_f32_16x16x32_bf16 v[108:111], v[244:247], v[28:31], v[108:111]
ds_read_b64_tr_b16 v[240:241], v6 offset:34880
ds_read_b64_tr_b16 v[242:243], v6 offset:35392
v_mfma_f32_16x16x32_bf16 v[112:115], v[244:247], v[32:35], v[112:115]
s_waitcnt lgkmcnt(10)
v_mfma_f32_16x16x32_bf16 v[116:119], v[248:251], v[28:31], v[116:119]
ds_read_b64_tr_b16 v[244:245], v5 offset:39168
ds_read_b64_tr_b16 v[246:247], v5 offset:39680
v_mfma_f32_16x16x32_bf16 v[120:123], v[248:251], v[32:35], v[120:123]
s_waitcnt lgkmcnt(10)
v_mfma_f32_16x16x32_bf16 v[124:127], v[252:255], v[28:31], v[124:127]
ds_read_b64_tr_b16 v[248:249], v6 offset:39168
ds_read_b64_tr_b16 v[250:251], v6 offset:39680
v_mfma_f32_16x16x32_bf16 v[128:131], v[252:255], v[32:35], v[128:131]
s_waitcnt lgkmcnt(10)
v_cvt_pk_bf16_f32 v28, v16, v17
v_exp_f32 v18, v54
v_exp_f32 v19, v55
v_add_f32 v13, v13, v18
v_add_f32 v13, v13, v19
v_cvt_pk_bf16_f32 v29, v18, v19
v_exp_f32 v16, v56
v_mfma_f32_16x16x32_bf16 a[192:195], v[228:231], v[196:199], a[192:195]
ds_read_b64_tr_b16 v[252:253], v5 offset:39232
ds_read_b64_tr_b16 v[254:255], v5 offset:39744
v_mfma_f32_16x16x32_bf16 a[196:199], v[228:231], v[200:203], a[196:199]
s_waitcnt lgkmcnt(10)
v_exp_f32 v17, v57
v_mfma_f32_16x16x32_bf16 a[200:203], v[232:235], v[196:199], a[200:203]
ds_read_b64_tr_b16 v[228:229], v6 offset:39232
ds_read_b64_tr_b16 v[230:231], v6 offset:39744
v_mfma_f32_16x16x32_bf16 a[204:207], v[232:235], v[200:203], a[204:207]
s_waitcnt lgkmcnt(10)
v_add_f32 v13, v13, v16
v_add_f32 v13, v13, v17
v_mfma_f32_16x16x32_bf16 a[208:211], v[236:239], v[196:199], a[208:211]
ds_read_b64_tr_b16 v[232:233], v5 offset:43520
ds_read_b64_tr_b16 v[234:235], v5 offset:44032
v_mfma_f32_16x16x32_bf16 a[212:215], v[236:239], v[200:203], a[212:215]
s_waitcnt lgkmcnt(10)
v_cvt_pk_bf16_f32 v30, v16, v17
v_exp_f32 v18, v58
v_mfma_f32_16x16x32_bf16 a[216:219], v[240:243], v[196:199], a[216:219]
ds_read_b64_tr_b16 v[236:237], v6 offset:43520
ds_read_b64_tr_b16 v[238:239], v6 offset:44032
v_mfma_f32_16x16x32_bf16 a[220:223], v[240:243], v[200:203], a[220:223]
s_waitcnt lgkmcnt(10)
s_add_u32 m0, s78, 118272
v_exp_f32 v19, v59
v_mfma_f32_16x16x32_bf16 a[224:227], v[244:247], v[196:199], a[224:227]
ds_read_b64_tr_b16 v[240:241], v5 offset:43584
ds_read_b64_tr_b16 v[242:243], v5 offset:44096
v_mfma_f32_16x16x32_bf16 a[228:231], v[244:247], v[200:203], a[228:231]
s_waitcnt lgkmcnt(10)
s_add_u32 s62, s62, 128
v_add_f32 v13, v13, v18
v_mfma_f32_16x16x32_bf16 a[232:235], v[248:251], v[196:199], a[232:235]
ds_read_b64_tr_b16 v[244:245], v6 offset:43584
ds_read_b64_tr_b16 v[246:247], v6 offset:44096
v_mfma_f32_16x16x32_bf16 a[236:239], v[248:251], v[200:203], a[236:239]
s_waitcnt lgkmcnt(10)
buffer_load_dwordx4 v4, s[48:51], s62 offen offset:0 nt lds
s_add_u32 m0, s78, 122624
v_add_f32 v13, v13, v19
v_cvt_pk_bf16_f32 v31, v18, v19
v_mfma_f32_16x16x32_bf16 a[240:243], v[252:255], v[196:199], a[240:243]
ds_read_b128 v[248:251], v3 offset:0
s_add_u32 s62, s62, 128
v_mfma_f32_16x16x32_bf16 a[244:247], v[252:255], v[200:203], a[244:247]
s_waitcnt lgkmcnt(9)
buffer_load_dwordx4 v4, s[48:51], s62 offen offset:0 nt lds
v_exp_f32 v16, v60
v_mfma_f32_16x16x32_bf16 a[248:251], v[228:231], v[196:199], a[248:251]
ds_read_b128 v[252:255], v3 offset:64
s_add_u32 m0, s69, 57792
v_mfma_f32_16x16x32_bf16 a[252:255], v[228:231], v[200:203], a[252:255]
s_waitcnt lgkmcnt(8)
s_add_u32 s64, s64, 8192
v_exp_f32 v17, v61
v_mfma_f32_16x16x32_bf16 v[132:135], v[232:235], v[196:199], v[132:135]
ds_read_b128 v[228:231], v3 offset:1024
s_add_u32 s66, s66, 8192
v_mfma_f32_16x16x32_bf16 v[136:139], v[232:235], v[200:203], v[136:139]
s_waitcnt lgkmcnt(7)
buffer_load_dwordx4 v7, s[80:83], s64 offen offset:0 nt lds
v_mov_b32 v14, v16
v_add_f32 v14, v14, v17
v_mfma_f32_16x16x32_bf16 v[140:143], v[236:239], v[196:199], v[140:143]
ds_read_b128 v[232:235], v3 offset:1088
buffer_load_dwordx4 v7, s[80:83], s66 offen offset:1024 nt lds
v_mfma_f32_16x16x32_bf16 v[144:147], v[236:239], v[200:203], v[144:147]
s_waitcnt lgkmcnt(6)
s_add_u32 m0, s76, 8256
v_cvt_pk_bf16_f32 v32, v16, v17
v_exp_f32 v18, v62
v_mfma_f32_16x16x32_bf16 v[148:151], v[240:243], v[196:199], v[148:151]
ds_read_b128 v[236:239], v3 offset:512
s_add_u32 s65, s65, 8192
v_mfma_f32_16x16x32_bf16 v[152:155], v[240:243], v[200:203], v[152:155]
s_waitcnt lgkmcnt(5)
s_add_u32 s67, s67, 8192
v_exp_f32 v19, v63
v_mfma_f32_16x16x32_bf16 v[156:159], v[244:247], v[196:199], v[156:159]
ds_read_b128 v[240:243], v3 offset:576
buffer_load_dwordx4 v8, s[92:95], s65 offen offset:0 nt lds
v_mfma_f32_16x16x32_bf16 v[160:163], v[244:247], v[200:203], v[160:163]
s_waitcnt lgkmcnt(5)
buffer_load_dwordx4 v8, s[92:95], s67 offen offset:1024 nt lds
v_add_f32 v14, v14, v18
v_mfma_f32_16x16x32_bf16 v[36:39], v[248:251], v[164:167], v[20:23]
ds_read_b128 v[244:247], v3 offset:1536
v_add_f32 v14, v14, v19
v_mfma_f32_16x16x32_bf16 v[44:47], v[248:251], v[168:171], v[24:27]
s_waitcnt lgkmcnt(5)
v_cvt_pk_bf16_f32 v33, v18, v19
v_mfma_f32_16x16x32_bf16 v[36:39], v[252:255], v[172:175], v[36:39]
ds_read_b128 v[248:251], v3 offset:1600
v_mov_b32 v196, v204
v_mfma_f32_16x16x32_bf16 v[44:47], v[252:255], v[176:179], v[44:47]
s_waitcnt lgkmcnt(5)
v_exp_f32 v16, v64
v_mfma_f32_16x16x32_bf16 v[36:39], v[228:231], v[180:183], v[36:39]
v_exp_f32 v17, v65
v_mfma_f32_16x16x32_bf16 v[44:47], v[228:231], v[184:187], v[44:47]
s_waitcnt lgkmcnt(4)
v_add_f32 v14, v14, v16
v_mfma_f32_16x16x32_bf16 v[36:39], v[232:235], v[188:191], v[36:39]
v_add_f32 v14, v14, v17
v_cvt_pk_bf16_f32 v34, v16, v17
v_mfma_f32_16x16x32_bf16 v[44:47], v[232:235], v[192:195], v[44:47]
s_waitcnt vmcnt(12) lgkmcnt(0)
s_barrier
ds_read_b64_tr_b16 v[232:233], v1 offset:24768
ds_read_b64_tr_b16 v[234:235], v1 offset:25280
v_mfma_f32_16x16x32_bf16 v[40:43], v[236:239], v[164:167], v[20:23]
v_exp_f32 v18, v66
v_mfma_f32_16x16x32_bf16 v[48:51], v[236:239], v[168:171], v[24:27]
ds_read_b64_tr_b16 v[236:237], v1 offset:24776
ds_read_b64_tr_b16 v[238:239], v1 offset:25288
v_mfma_f32_16x16x32_bf16 v[40:43], v[240:243], v[172:175], v[40:43]
v_exp_f32 v19, v67
v_mfma_f32_16x16x32_bf16 v[48:51], v[240:243], v[176:179], v[48:51]
ds_read_b64_tr_b16 v[240:241], v2 offset:24768
ds_read_b64_tr_b16 v[242:243], v2 offset:25280
v_mfma_f32_16x16x32_bf16 v[40:43], v[244:247], v[180:183], v[40:43]
v_add_f32 v14, v14, v18
v_add_f32 v14, v14, v19
v_mfma_f32_16x16x32_bf16 v[48:51], v[244:247], v[184:187], v[48:51]
ds_read_b64_tr_b16 v[244:245], v2 offset:24776
ds_read_b64_tr_b16 v[246:247], v2 offset:25288
v_mfma_f32_16x16x32_bf16 v[40:43], v[248:251], v[188:191], v[40:43]
v_cvt_pk_bf16_f32 v35, v18, v19
v_mov_b32 v197, v205
v_mfma_f32_16x16x32_bf16 v[48:51], v[248:251], v[192:195], v[48:51]
s_waitcnt lgkmcnt(6)
ds_read_b64_tr_b16 v[248:249], v1 offset:25792
ds_read_b64_tr_b16 v[250:251], v1 offset:26304
v_add_f32 v15, v13, v14
v_cmp_nle_f32 s[70:71], v15, s73
s_cmp_lg_u64 s[70:71], 0
s_cbranch_scc1 L_tr_CB3
L_back_CB3:
v_add_f32 v11, v11, v13
v_add_f32 v12, v12, v14
v_mfma_f32_16x16x32_bf16 v[68:71], v[232:235], v[28:31], v[68:71]
ds_read_b64_tr_b16 v[252:253], v1 offset:25800
ds_read_b64_tr_b16 v[254:255], v1 offset:26312
ds_read_b64_tr_b16 v[228:229], v2 offset:25792
ds_read_b64_tr_b16 v[230:231], v2 offset:26304
v_mfma_f32_16x16x32_bf16 v[72:75], v[232:235], v[32:35], v[72:75]
s_waitcnt lgkmcnt(10)
v_mov_b32 v198, v206
v_mfma_f32_16x16x32_bf16 v[76:79], v[236:239], v[28:31], v[76:79]
ds_read_b64_tr_b16 v[232:233], v2 offset:25800
ds_read_b64_tr_b16 v[234:235], v2 offset:26312
v_mfma_f32_16x16x32_bf16 v[80:83], v[236:239], v[32:35], v[80:83]
s_waitcnt lgkmcnt(10)
v_mov_b32 v199, v207
v_exp_f32 v16, v36
v_exp_f32 v17, v37
v_mov_b32 v13, v16
v_add_f32 v13, v13, v17
v_mfma_f32_16x16x32_bf16 v[84:87], v[240:243], v[28:31], v[84:87]
ds_read_b64_tr_b16 v[236:237], v5 offset:0
ds_read_b64_tr_b16 v[238:239], v5 offset:512
v_mfma_f32_16x16x32_bf16 v[88:91], v[240:243], v[32:35], v[88:91]
s_waitcnt lgkmcnt(10)
v_mov_b32 v200, v208
v_mfma_f32_16x16x32_bf16 v[92:95], v[244:247], v[28:31], v[92:95]
ds_read_b64_tr_b16 v[240:241], v6 offset:0
ds_read_b64_tr_b16 v[242:243], v6 offset:512
v_mfma_f32_16x16x32_bf16 v[96:99], v[244:247], v[32:35], v[96:99]
s_waitcnt lgkmcnt(10)
v_mov_b32 v201, v209
v_mfma_f32_16x16x32_bf16 v[100:103], v[248:251], v[28:31], v[100:103]
ds_read_b64_tr_b16 v[244:245], v5 offset:64
ds_read_b64_tr_b16 v[246:247], v5 offset:576
v_mfma_f32_16x16x32_bf16 v[104:107], v[248:251], v[32:35], v[104:107]
s_waitcnt lgkmcnt(10)
v_mov_b32 v202, v210
v_mfma_f32_16x16x32_bf16 v[108:111], v[252:255], v[28:31], v[108:111]
ds_read_b64_tr_b16 v[248:249], v6 offset:64
ds_read_b64_tr_b16 v[250:251], v6 offset:576
v_mfma_f32_16x16x32_bf16 v[112:115], v[252:255], v[32:35], v[112:115]
s_waitcnt lgkmcnt(10)
v_mov_b32 v203, v211
v_mfma_f32_16x16x32_bf16 v[116:119], v[228:231], v[28:31], v[116:119]
ds_read_b64_tr_b16 v[252:253], v5 offset:4352
ds_read_b64_tr_b16 v[254:255], v5 offset:4864
v_mfma_f32_16x16x32_bf16 v[120:123], v[228:231], v[32:35], v[120:123]
s_waitcnt lgkmcnt(10)
v_mfma_f32_16x16x32_bf16 v[124:127], v[232:235], v[28:31], v[124:127]
ds_read_b64_tr_b16 v[228:229], v6 offset:4352
ds_read_b64_tr_b16 v[230:231], v6 offset:4864
v_mfma_f32_16x16x32_bf16 v[128:131], v[232:235], v[32:35], v[128:131]
s_waitcnt lgkmcnt(10)
s_add_u32 m0, s78, 100864
s_add_u32 s62, s62, 128
buffer_load_dwordx4 v4, s[48:51], s62 offen offset:0 nt lds
v_cvt_pk_bf16_f32 v28, v16, v17
v_exp_f32 v18, v38
v_exp_f32 v19, v39
v_add_f32 v13, v13, v18
v_add_f32 v13, v13, v19
v_cvt_pk_bf16_f32 v29, v18, v19
v_exp_f32 v16, v40
v_exp_f32 v17, v41
v_add_f32 v13, v13, v16
v_add_f32 v13, v13, v17
v_cvt_pk_bf16_f32 v30, v16, v17
v_exp_f32 v18, v42
v_exp_f32 v19, v43
v_mfma_f32_16x16x32_bf16 a[0:3], v[236:239], v[204:207], a[0:3]
ds_read_b64_tr_b16 v[232:233], v5 offset:4416
ds_read_b64_tr_b16 v[234:235], v5 offset:4928
v_mfma_f32_16x16x32_bf16 a[4:7], v[236:239], v[208:211], a[4:7]
s_waitcnt lgkmcnt(10)
s_add_u32 m0, s78, 105216
s_add_u32 s62, s62, 128
v_add_f32 v13, v13, v18
v_mfma_f32_16x16x32_bf16 a[8:11], v[240:243], v[204:207], a[8:11]
ds_read_b64_tr_b16 v[236:237], v6 offset:4416
ds_read_b64_tr_b16 v[238:239], v6 offset:4928
v_mfma_f32_16x16x32_bf16 a[12:15], v[240:243], v[208:211], a[12:15]
s_waitcnt lgkmcnt(10)
buffer_load_dwordx4 v4, s[48:51], s62 offen offset:0 nt lds
s_add_u32 m0, s78, 109568
v_add_f32 v13, v13, v19
v_cvt_pk_bf16_f32 v31, v18, v19
v_mfma_f32_16x16x32_bf16 a[16:19], v[244:247], v[204:207], a[16:19]
ds_read_b128 v[240:243], v3 offset:8256
s_add_u32 s62, s62, 128
v_mfma_f32_16x16x32_bf16 a[20:23], v[244:247], v[208:211], a[20:23]
s_waitcnt lgkmcnt(9)
buffer_load_dwordx4 v4, s[48:51], s62 offen offset:0 nt lds
v_exp_f32 v16, v44
v_mfma_f32_16x16x32_bf16 a[24:27], v[248:251], v[204:207], a[24:27]
ds_read_b128 v[244:247], v3 offset:8320
s_add_u32 m0, s69, 33024
v_mfma_f32_16x16x32_bf16 a[28:31], v[248:251], v[208:211], a[28:31]
s_waitcnt lgkmcnt(8)
s_add_u32 s64, s64, 8192
v_exp_f32 v17, v45
v_mfma_f32_16x16x32_bf16 a[32:35], v[252:255], v[204:207], a[32:35]
ds_read_b128 v[248:251], v3 offset:9280
s_add_u32 s66, s66, 8192
v_mfma_f32_16x16x32_bf16 a[36:39], v[252:255], v[208:211], a[36:39]
s_waitcnt lgkmcnt(7)
buffer_load_dwordx4 v7, s[80:83], s64 offen offset:0 nt lds
v_mov_b32 v14, v16
v_add_f32 v14, v14, v17
v_mfma_f32_16x16x32_bf16 a[40:43], v[228:231], v[204:207], a[40:43]
ds_read_b128 v[252:255], v3 offset:9344
buffer_load_dwordx4 v7, s[80:83], s66 offen offset:1024 nt lds
v_mfma_f32_16x16x32_bf16 a[44:47], v[228:231], v[208:211], a[44:47]
s_waitcnt lgkmcnt(6)
s_add_u32 m0, s76, 16512
v_cvt_pk_bf16_f32 v32, v16, v17
v_exp_f32 v18, v46
v_mfma_f32_16x16x32_bf16 a[48:51], v[232:235], v[204:207], a[48:51]
ds_read_b128 v[228:231], v3 offset:8768
s_add_u32 s65, s65, 8192
v_mfma_f32_16x16x32_bf16 a[52:55], v[232:235], v[208:211], a[52:55]
s_waitcnt lgkmcnt(5)
s_add_u32 s67, s67, 8192
v_exp_f32 v19, v47
v_mfma_f32_16x16x32_bf16 a[56:59], v[236:239], v[204:207], a[56:59]
ds_read_b128 v[232:235], v3 offset:8832
buffer_load_dwordx4 v8, s[92:95], s65 offen offset:0 nt lds
v_mfma_f32_16x16x32_bf16 a[60:63], v[236:239], v[208:211], a[60:63]
s_waitcnt lgkmcnt(5)
buffer_load_dwordx4 v8, s[92:95], s67 offen offset:1024 nt lds
v_add_f32 v14, v14, v18
v_mfma_f32_16x16x32_bf16 v[52:55], v[240:243], v[164:167], v[20:23]
ds_read_b128 v[236:239], v3 offset:9792
v_add_f32 v14, v14, v19
v_mfma_f32_16x16x32_bf16 v[60:63], v[240:243], v[168:171], v[24:27]
s_waitcnt lgkmcnt(5)
v_cvt_pk_bf16_f32 v33, v18, v19
v_mfma_f32_16x16x32_bf16 v[52:55], v[244:247], v[172:175], v[52:55]
ds_read_b128 v[240:243], v3 offset:9856
v_mfma_f32_16x16x32_bf16 v[60:63], v[244:247], v[176:179], v[60:63]
s_waitcnt lgkmcnt(5)
v_exp_f32 v16, v48
v_mfma_f32_16x16x32_bf16 v[52:55], v[248:251], v[180:183], v[52:55]
v_exp_f32 v17, v49
v_mfma_f32_16x16x32_bf16 v[60:63], v[248:251], v[184:187], v[60:63]
s_waitcnt lgkmcnt(4)
v_add_f32 v14, v14, v16
v_mfma_f32_16x16x32_bf16 v[52:55], v[252:255], v[188:191], v[52:55]
v_add_f32 v14, v14, v17
v_cvt_pk_bf16_f32 v34, v16, v17
v_mfma_f32_16x16x32_bf16 v[60:63], v[252:255], v[192:195], v[60:63]
s_waitcnt vmcnt(13) lgkmcnt(0)
s_barrier
ds_read_b64_tr_b16 v[248:249], v1 offset:0
ds_read_b64_tr_b16 v[250:251], v1 offset:512
v_mfma_f32_16x16x32_bf16 v[56:59], v[228:231], v[164:167], v[20:23]
ds_read_b64_tr_b16 v[252:253], v1 offset:8
ds_read_b64_tr_b16 v[254:255], v1 offset:520
v_mfma_f32_16x16x32_bf16 v[64:67], v[228:231], v[168:171], v[24:27]
v_exp_f32 v18, v50
v_mfma_f32_16x16x32_bf16 v[56:59], v[232:235], v[172:175], v[56:59]
ds_read_b64_tr_b16 v[228:229], v2 offset:0
ds_read_b64_tr_b16 v[230:231], v2 offset:512
v_mfma_f32_16x16x32_bf16 v[64:67], v[232:235], v[176:179], v[64:67]
v_exp_f32 v19, v51
v_mfma_f32_16x16x32_bf16 v[56:59], v[236:239], v[180:183], v[56:59]
ds_read_b64_tr_b16 v[232:233], v2 offset:8
ds_read_b64_tr_b16 v[234:235], v2 offset:520
v_mfma_f32_16x16x32_bf16 v[64:67], v[236:239], v[184:187], v[64:67]
v_add_f32 v14, v14, v18
v_add_f32 v14, v14, v19
v_mfma_f32_16x16x32_bf16 v[56:59], v[240:243], v[188:191], v[56:59]
ds_read_b64_tr_b16 v[236:237], v1 offset:1024
ds_read_b64_tr_b16 v[238:239], v1 offset:1536
v_mfma_f32_16x16x32_bf16 v[64:67], v[240:243], v[192:195], v[64:67]
s_waitcnt lgkmcnt(8)
v_cvt_pk_bf16_f32 v35, v18, v19
v_add_f32 v15, v13, v14
v_cmp_nle_f32 s[70:71], v15, s73
s_cmp_lg_u64 s[70:71], 0
s_cbranch_scc1 L_tr_CB4
L_back_CB4:
v_add_f32 v11, v11, v13
v_add_f32 v12, v12, v14
v_mfma_f32_16x16x32_bf16 v[68:71], v[248:251], v[28:31], v[68:71]
ds_read_b64_tr_b16 v[240:241], v1 offset:1032
ds_read_b64_tr_b16 v[242:243], v1 offset:1544
ds_read_b64_tr_b16 v[244:245], v2 offset:1024
ds_read_b64_tr_b16 v[246:247], v2 offset:1536
v_mfma_f32_16x16x32_bf16 v[72:75], v[248:251], v[32:35], v[72:75]
s_waitcnt lgkmcnt(10)
v_mfma_f32_16x16x32_bf16 v[76:79], v[252:255], v[28:31], v[76:79]
ds_read_b64_tr_b16 v[248:249], v2 offset:1032
ds_read_b64_tr_b16 v[250:251], v2 offset:1544
v_mfma_f32_16x16x32_bf16 v[80:83], v[252:255], v[32:35], v[80:83]
s_waitcnt lgkmcnt(10)
v_exp_f32 v16, v52
v_exp_f32 v17, v53
v_mov_b32 v13, v16
v_add_f32 v13, v13, v17
v_mfma_f32_16x16x32_bf16 v[84:87], v[228:231], v[28:31], v[84:87]
ds_read_b64_tr_b16 v[252:253], v5 offset:17408
ds_read_b64_tr_b16 v[254:255], v5 offset:17920
v_mfma_f32_16x16x32_bf16 v[88:91], v[228:231], v[32:35], v[88:91]
s_waitcnt lgkmcnt(10)
v_mfma_f32_16x16x32_bf16 v[92:95], v[232:235], v[28:31], v[92:95]
ds_read_b64_tr_b16 v[228:229], v6 offset:17408
ds_read_b64_tr_b16 v[230:231], v6 offset:17920
v_mfma_f32_16x16x32_bf16 v[96:99], v[232:235], v[32:35], v[96:99]
s_waitcnt lgkmcnt(10)
v_mfma_f32_16x16x32_bf16 v[100:103], v[236:239], v[28:31], v[100:103]
ds_read_b64_tr_b16 v[232:233], v5 offset:17472
ds_read_b64_tr_b16 v[234:235], v5 offset:17984
v_mfma_f32_16x16x32_bf16 v[104:107], v[236:239], v[32:35], v[104:107]
s_waitcnt lgkmcnt(10)
v_mfma_f32_16x16x32_bf16 v[108:111], v[240:243], v[28:31], v[108:111]
ds_read_b64_tr_b16 v[236:237], v6 offset:17472
ds_read_b64_tr_b16 v[238:239], v6 offset:17984
v_mfma_f32_16x16x32_bf16 v[112:115], v[240:243], v[32:35], v[112:115]
s_waitcnt lgkmcnt(10)
v_mfma_f32_16x16x32_bf16 v[116:119], v[244:247], v[28:31], v[116:119]
ds_read_b64_tr_b16 v[240:241], v5 offset:21760
ds_read_b64_tr_b16 v[242:243], v5 offset:22272
v_mfma_f32_16x16x32_bf16 v[120:123], v[244:247], v[32:35], v[120:123]
s_waitcnt lgkmcnt(10)
v_mfma_f32_16x16x32_bf16 v[124:127], v[248:251], v[28:31], v[124:127]
ds_read_b64_tr_b16 v[244:245], v6 offset:21760
ds_read_b64_tr_b16 v[246:247], v6 offset:22272
v_mfma_f32_16x16x32_bf16 v[128:131], v[248:251], v[32:35], v[128:131]
s_waitcnt lgkmcnt(10)
s_add_u32 m0, s78, 66048
v_cvt_pk_bf16_f32 v28, v16, v17
v_exp_f32 v18, v54
v_exp_f32 v19, v55
v_add_f32 v13, v13, v18
v_add_f32 v13, v13, v19
v_cvt_pk_bf16_f32 v29, v18, v19
v_exp_f32 v16, v56
v_exp_f32 v17, v57
v_add_f32 v13, v13, v16
v_add_f32 v13, v13, v17
v_cvt_pk_bf16_f32 v30, v16, v17
v_exp_f32 v18, v58
v_exp_f32 v19, v59
v_mfma_f32_16x16x32_bf16 a[64:67], v[252:255], v[204:207], a[64:67]
ds_read_b64_tr_b16 v[248:249], v5 offset:21824
ds_read_b64_tr_b16 v[250:251], v5 offset:22336
v_mfma_f32_16x16x32_bf16 a[68:71], v[252:255], v[208:211], a[68:71]
s_waitcnt lgkmcnt(10)
s_add_u32 s62, s62, 35840
v_add_f32 v13, v13, v18
v_mfma_f32_16x16x32_bf16 a[72:75], v[228:231], v[204:207], a[72:75]
ds_read_b64_tr_b16 v[252:253], v6 offset:21824
ds_read_b64_tr_b16 v[254:255], v6 offset:22336
v_mfma_f32_16x16x32_bf16 a[76:79], v[228:231], v[208:211], a[76:79]
s_waitcnt lgkmcnt(10)
buffer_load_dwordx4 v4, s[48:51], s62 offen offset:0 nt lds
s_add_u32 m0, s78, 70400
v_add_f32 v13, v13, v19
v_cvt_pk_bf16_f32 v31, v18, v19
v_mfma_f32_16x16x32_bf16 a[80:83], v[232:235], v[204:207], a[80:83]
ds_read_b128 v[228:231], v3 offset:16512
s_add_u32 s62, s62, 128
v_mfma_f32_16x16x32_bf16 a[84:87], v[232:235], v[208:211], a[84:87]
s_waitcnt lgkmcnt(9)
buffer_load_dwordx4 v4, s[48:51], s62 offen offset:0 nt lds
v_exp_f32 v16, v60
v_mfma_f32_16x16x32_bf16 a[88:91], v[236:239], v[204:207], a[88:91]
ds_read_b128 v[232:235], v3 offset:16576
s_add_u32 m0, s69, 41280
v_mfma_f32_16x16x32_bf16 a[92:95], v[236:239], v[208:211], a[92:95]
s_waitcnt lgkmcnt(8)
s_add_u32 s64, s64, 8192
v_exp_f32 v17, v61
v_mfma_f32_16x16x32_bf16 a[96:99], v[240:243], v[204:207], a[96:99]
ds_read_b128 v[236:239], v3 offset:17536
s_add_u32 s66, s66, 8192
v_mfma_f32_16x16x32_bf16 a[100:103], v[240:243], v[208:211], a[100:103]
s_waitcnt lgkmcnt(7)
buffer_load_dwordx4 v7, s[80:83], s64 offen offset:0 nt lds
v_mov_b32 v14, v16
v_add_f32 v14, v14, v17
v_mfma_f32_16x16x32_bf16 a[104:107], v[244:247], v[204:207], a[104:107]
ds_read_b128 v[240:243], v3 offset:17600
buffer_load_dwordx4 v7, s[80:83], s66 offen offset:1024 nt lds
v_mfma_f32_16x16x32_bf16 a[108:111], v[244:247], v[208:211], a[108:111]
s_waitcnt lgkmcnt(6)
s_add_u32 m0, s76, 24768
v_cvt_pk_bf16_f32 v32, v16, v17
v_exp_f32 v18, v62
v_mfma_f32_16x16x32_bf16 a[112:115], v[248:251], v[204:207], a[112:115]
ds_read_b128 v[244:247], v3 offset:17024
s_add_u32 s65, s65, 8192
v_mfma_f32_16x16x32_bf16 a[116:119], v[248:251], v[208:211], a[116:119]
s_waitcnt lgkmcnt(5)
s_add_u32 s67, s67, 8192
v_exp_f32 v19, v63
v_mfma_f32_16x16x32_bf16 a[120:123], v[252:255], v[204:207], a[120:123]
ds_read_b128 v[248:251], v3 offset:17088
buffer_load_dwordx4 v8, s[92:95], s65 offen offset:0 nt lds
v_mfma_f32_16x16x32_bf16 a[124:127], v[252:255], v[208:211], a[124:127]
s_waitcnt lgkmcnt(5)
buffer_load_dwordx4 v8, s[92:95], s67 offen offset:1024 nt lds
v_add_f32 v14, v14, v18
v_mfma_f32_16x16x32_bf16 v[36:39], v[228:231], v[164:167], v[20:23]
ds_read_b128 v[252:255], v3 offset:18048
v_add_f32 v14, v14, v19
v_mfma_f32_16x16x32_bf16 v[44:47], v[228:231], v[168:171], v[24:27]
s_waitcnt lgkmcnt(5)
v_cvt_pk_bf16_f32 v33, v18, v19
v_mfma_f32_16x16x32_bf16 v[36:39], v[232:235], v[172:175], v[36:39]
ds_read_b128 v[228:231], v3 offset:18112
v_mov_b32 v204, v212
v_mfma_f32_16x16x32_bf16 v[44:47], v[232:235], v[176:179], v[44:47]
s_waitcnt lgkmcnt(5)
v_exp_f32 v16, v64
v_mfma_f32_16x16x32_bf16 v[36:39], v[236:239], v[180:183], v[36:39]
v_exp_f32 v17, v65
v_mfma_f32_16x16x32_bf16 v[44:47], v[236:239], v[184:187], v[44:47]
s_waitcnt lgkmcnt(4)
v_add_f32 v14, v14, v16
v_mfma_f32_16x16x32_bf16 v[36:39], v[240:243], v[188:191], v[36:39]
v_add_f32 v14, v14, v17
v_cvt_pk_bf16_f32 v34, v16, v17
v_mfma_f32_16x16x32_bf16 v[44:47], v[240:243], v[192:195], v[44:47]
s_waitcnt vmcnt(13) lgkmcnt(0)
s_barrier
ds_read_b64_tr_b16 v[236:237], v1 offset:8256
ds_read_b64_tr_b16 v[238:239], v1 offset:8768
v_mfma_f32_16x16x32_bf16 v[40:43], v[244:247], v[164:167], v[20:23]
ds_read_b64_tr_b16 v[240:241], v1 offset:8264
ds_read_b64_tr_b16 v[242:243], v1 offset:8776
v_mfma_f32_16x16x32_bf16 v[48:51], v[244:247], v[168:171], v[24:27]
v_exp_f32 v18, v66
v_mfma_f32_16x16x32_bf16 v[40:43], v[248:251], v[172:175], v[40:43]
ds_read_b64_tr_b16 v[244:245], v2 offset:8256
ds_read_b64_tr_b16 v[246:247], v2 offset:8768
v_mfma_f32_16x16x32_bf16 v[48:51], v[248:251], v[176:179], v[48:51]
v_exp_f32 v19, v67
v_mfma_f32_16x16x32_bf16 v[40:43], v[252:255], v[180:183], v[40:43]
ds_read_b64_tr_b16 v[248:249], v2 offset:8264
ds_read_b64_tr_b16 v[250:251], v2 offset:8776
v_mfma_f32_16x16x32_bf16 v[48:51], v[252:255], v[184:187], v[48:51]
v_add_f32 v14, v14, v18
v_add_f32 v14, v14, v19
v_mfma_f32_16x16x32_bf16 v[40:43], v[228:231], v[188:191], v[40:43]
ds_read_b64_tr_b16 v[252:253], v1 offset:9280
ds_read_b64_tr_b16 v[254:255], v1 offset:9792
v_mfma_f32_16x16x32_bf16 v[48:51], v[228:231], v[192:195], v[48:51]
s_waitcnt lgkmcnt(8)
v_cvt_pk_bf16_f32 v35, v18, v19
v_mov_b32 v205, v213
v_add_f32 v15, v13, v14
v_cmp_nle_f32 s[70:71], v15, s73
s_cmp_lg_u64 s[70:71], 0
s_cbranch_scc1 L_tr_CB5
L_back_CB5:
v_add_f32 v11, v11, v13
v_add_f32 v12, v12, v14
v_mfma_f32_16x16x32_bf16 v[68:71], v[236:239], v[28:31], v[68:71]
ds_read_b64_tr_b16 v[228:229], v1 offset:9288
ds_read_b64_tr_b16 v[230:231], v1 offset:9800
ds_read_b64_tr_b16 v[232:233], v2 offset:9280
ds_read_b64_tr_b16 v[234:235], v2 offset:9792
v_mfma_f32_16x16x32_bf16 v[72:75], v[236:239], v[32:35], v[72:75]
s_waitcnt lgkmcnt(10)
v_mov_b32 v206, v214
v_mov_b32 v207, v215
v_mfma_f32_16x16x32_bf16 v[76:79], v[240:243], v[28:31], v[76:79]
ds_read_b64_tr_b16 v[236:237], v2 offset:9288
ds_read_b64_tr_b16 v[238:239], v2 offset:9800
v_mfma_f32_16x16x32_bf16 v[80:83], v[240:243], v[32:35], v[80:83]
s_waitcnt lgkmcnt(10)
v_mov_b32 v208, v216
v_mov_b32 v209, v217
v_exp_f32 v16, v36
v_exp_f32 v17, v37
v_mov_b32 v13, v16
v_add_f32 v13, v13, v17
v_mfma_f32_16x16x32_bf16 v[84:87], v[244:247], v[28:31], v[84:87]
ds_read_b64_tr_b16 v[240:241], v5 offset:52224
ds_read_b64_tr_b16 v[242:243], v5 offset:52736
v_mfma_f32_16x16x32_bf16 v[88:91], v[244:247], v[32:35], v[88:91]
s_waitcnt lgkmcnt(10)
v_mov_b32 v210, v218
v_mov_b32 v211, v219
v_mfma_f32_16x16x32_bf16 v[92:95], v[248:251], v[28:31], v[92:95]
ds_read_b64_tr_b16 v[244:245], v6 offset:52224
ds_read_b64_tr_b16 v[246:247], v6 offset:52736
v_mfma_f32_16x16x32_bf16 v[96:99], v[248:251], v[32:35], v[96:99]
s_waitcnt lgkmcnt(10)
v_mov_b32 v212, v220
v_mov_b32 v213, v221
v_mfma_f32_16x16x32_bf16 v[100:103], v[252:255], v[28:31], v[100:103]
ds_read_b64_tr_b16 v[248:249], v5 offset:52288
ds_read_b64_tr_b16 v[250:251], v5 offset:52800
v_mfma_f32_16x16x32_bf16 v[104:107], v[252:255], v[32:35], v[104:107]
s_waitcnt lgkmcnt(10)
v_mov_b32 v214, v222
v_mov_b32 v215, v223
v_mfma_f32_16x16x32_bf16 v[108:111], v[228:231], v[28:31], v[108:111]
ds_read_b64_tr_b16 v[252:253], v6 offset:52288
ds_read_b64_tr_b16 v[254:255], v6 offset:52800
v_mfma_f32_16x16x32_bf16 v[112:115], v[228:231], v[32:35], v[112:115]
s_waitcnt lgkmcnt(10)
v_mov_b32 v216, v224
v_mov_b32 v217, v225
v_mfma_f32_16x16x32_bf16 v[116:119], v[232:235], v[28:31], v[116:119]
ds_read_b64_tr_b16 v[228:229], v5 offset:56576
ds_read_b64_tr_b16 v[230:231], v5 offset:57088
v_mfma_f32_16x16x32_bf16 v[120:123], v[232:235], v[32:35], v[120:123]
s_waitcnt lgkmcnt(10)
v_mov_b32 v218, v226
v_mov_b32 v219, v227
v_mfma_f32_16x16x32_bf16 v[124:127], v[236:239], v[28:31], v[124:127]
ds_read_b64_tr_b16 v[232:233], v6 offset:56576
ds_read_b64_tr_b16 v[234:235], v6 offset:57088
v_mfma_f32_16x16x32_bf16 v[128:131], v[236:239], v[32:35], v[128:131]
s_waitcnt lgkmcnt(10)
s_add_u32 m0, s78, 83456
v_cvt_pk_bf16_f32 v28, v16, v17
v_exp_f32 v18, v38
v_exp_f32 v19, v39
v_add_f32 v13, v13, v18
v_add_f32 v13, v13, v19
v_cvt_pk_bf16_f32 v29, v18, v19
v_exp_f32 v16, v40
v_exp_f32 v17, v41
v_add_f32 v13, v13, v16
v_add_f32 v13, v13, v17
v_cvt_pk_bf16_f32 v30, v16, v17
v_exp_f32 v18, v42
v_exp_f32 v19, v43
v_mfma_f32_16x16x32_bf16 a[128:131], v[240:243], v[196:199], a[128:131]
ds_read_b64_tr_b16 v[236:237], v5 offset:56640
ds_read_b64_tr_b16 v[238:239], v5 offset:57152
v_mfma_f32_16x16x32_bf16 a[132:135], v[240:243], v[200:203], a[132:135]
s_waitcnt lgkmcnt(10)
s_add_u32 s62, s62, 128
v_add_f32 v13, v13, v18
v_mfma_f32_16x16x32_bf16 a[136:139], v[244:247], v[196:199], a[136:139]
ds_read_b64_tr_b16 v[240:241], v6 offset:56640
ds_read_b64_tr_b16 v[242:243], v6 offset:57152
v_mfma_f32_16x16x32_bf16 a[140:143], v[244:247], v[200:203], a[140:143]
s_waitcnt lgkmcnt(10)
buffer_load_dwordx4 v4, s[48:51], s62 offen offset:0 nt lds
s_add_u32 m0, s78, 87808
v_add_f32 v13, v13, v19
v_cvt_pk_bf16_f32 v31, v18, v19
v_mfma_f32_16x16x32_bf16 a[144:147], v[248:251], v[196:199], a[144:147]
ds_read_b128 v[244:247], v3 offset:24768
s_add_u32 s62, s62, 128
v_mfma_f32_16x16x32_bf16 a[148:151], v[248:251], v[200:203], a[148:151]
s_waitcnt lgkmcnt(9)
buffer_load_dwordx4 v4, s[48:51], s62 offen offset:0 nt lds
v_exp_f32 v16, v44
v_mfma_f32_16x16x32_bf16 a[152:155], v[252:255], v[196:199], a[152:155]
ds_read_b128 v[248:251], v3 offset:24832
s_add_u32 m0, s69, 49536
v_mfma_f32_16x16x32_bf16 a[156:159], v[252:255], v[200:203], a[156:159]
s_waitcnt lgkmcnt(8)
s_add_u32 s64, s64, 8192
v_exp_f32 v17, v45
v_mfma_f32_16x16x32_bf16 a[160:163], v[228:231], v[196:199], a[160:163]
ds_read_b128 v[252:255], v3 offset:25792
s_add_u32 s66, s66, 8192
v_mfma_f32_16x16x32_bf16 a[164:167], v[228:231], v[200:203], a[164:167]
s_waitcnt lgkmcnt(7)
buffer_load_dwordx4 v7, s[80:83], s64 offen offset:0 nt lds
v_mov_b32 v14, v16
v_add_f32 v14, v14, v17
v_mfma_f32_16x16x32_bf16 a[168:171], v[232:235], v[196:199], a[168:171]
ds_read_b128 v[228:231], v3 offset:25856
buffer_load_dwordx4 v7, s[80:83], s66 offen offset:1024 nt lds
v_mfma_f32_16x16x32_bf16 a[172:175], v[232:235], v[200:203], a[172:175]
s_waitcnt lgkmcnt(6)
s_add_u32 m0, s76, 0
v_cvt_pk_bf16_f32 v32, v16, v17
v_exp_f32 v18, v46
v_mfma_f32_16x16x32_bf16 a[176:179], v[236:239], v[196:199], a[176:179]
ds_read_b128 v[232:235], v3 offset:25280
s_add_u32 s65, s65, 8192
v_mfma_f32_16x16x32_bf16 a[180:183], v[236:239], v[200:203], a[180:183]
s_waitcnt lgkmcnt(5)
s_add_u32 s67, s67, 8192
v_exp_f32 v19, v47
v_mfma_f32_16x16x32_bf16 a[184:187], v[240:243], v[196:199], a[184:187]
ds_read_b128 v[236:239], v3 offset:25344
buffer_load_dwordx4 v8, s[92:95], s65 offen offset:0 nt lds
v_mfma_f32_16x16x32_bf16 a[188:191], v[240:243], v[200:203], a[188:191]
s_waitcnt lgkmcnt(5)
buffer_load_dwordx4 v8, s[92:95], s67 offen offset:1024 nt lds
v_add_f32 v14, v14, v18
v_mfma_f32_16x16x32_bf16 v[52:55], v[244:247], v[164:167], v[20:23]
ds_read_b128 v[240:243], v3 offset:26304
v_add_f32 v14, v14, v19
v_mfma_f32_16x16x32_bf16 v[60:63], v[244:247], v[168:171], v[24:27]
s_waitcnt lgkmcnt(5)
v_cvt_pk_bf16_f32 v33, v18, v19
v_mfma_f32_16x16x32_bf16 v[52:55], v[248:251], v[172:175], v[52:55]
ds_read_b128 v[244:247], v3 offset:26368
v_mfma_f32_16x16x32_bf16 v[60:63], v[248:251], v[176:179], v[60:63]
s_waitcnt lgkmcnt(5)
v_exp_f32 v16, v48
v_mfma_f32_16x16x32_bf16 v[52:55], v[252:255], v[180:183], v[52:55]
v_exp_f32 v17, v49
v_mfma_f32_16x16x32_bf16 v[60:63], v[252:255], v[184:187], v[60:63]
s_waitcnt lgkmcnt(4)
v_add_f32 v14, v14, v16
v_mfma_f32_16x16x32_bf16 v[52:55], v[228:231], v[188:191], v[52:55]
v_add_f32 v14, v14, v17
v_cvt_pk_bf16_f32 v34, v16, v17
v_mfma_f32_16x16x32_bf16 v[60:63], v[228:231], v[192:195], v[60:63]
s_sub_u32 s39, s39, 1
s_cmp_lg_u32 s39, 0
s_cbranch_scc1 L_loop2
s_waitcnt vmcnt(12) lgkmcnt(0)
s_barrier
ds_read_b64_tr_b16 v[252:253], v1 offset:16512
ds_read_b64_tr_b16 v[254:255], v1 offset:17024
v_mfma_f32_16x16x32_bf16 v[56:59], v[232:235], v[164:167], v[20:23]
ds_read_b64_tr_b16 v[228:229], v1 offset:16520
ds_read_b64_tr_b16 v[230:231], v1 offset:17032
v_mfma_f32_16x16x32_bf16 v[64:67], v[232:235], v[168:171], v[24:27]
v_exp_f32 v18, v50
v_mfma_f32_16x16x32_bf16 v[56:59], v[236:239], v[172:175], v[56:59]
ds_read_b64_tr_b16 v[232:233], v2 offset:16512
ds_read_b64_tr_b16 v[234:235], v2 offset:17024
v_mfma_f32_16x16x32_bf16 v[64:67], v[236:239], v[176:179], v[64:67]
v_exp_f32 v19, v51
v_mfma_f32_16x16x32_bf16 v[56:59], v[240:243], v[180:183], v[56:59]
ds_read_b64_tr_b16 v[236:237], v2 offset:16520
ds_read_b64_tr_b16 v[238:239], v2 offset:17032
v_mfma_f32_16x16x32_bf16 v[64:67], v[240:243], v[184:187], v[64:67]
v_add_f32 v14, v14, v18
v_add_f32 v14, v14, v19
v_mfma_f32_16x16x32_bf16 v[56:59], v[244:247], v[188:191], v[56:59]
ds_read_b64_tr_b16 v[240:241], v1 offset:17536
ds_read_b64_tr_b16 v[242:243], v1 offset:18048
v_mfma_f32_16x16x32_bf16 v[64:67], v[244:247], v[192:195], v[64:67]
s_waitcnt lgkmcnt(8)
v_cvt_pk_bf16_f32 v35, v18, v19
v_add_f32 v15, v13, v14
v_cmp_nle_f32 s[70:71], v15, s73
s_cmp_lg_u64 s[70:71], 0
s_cbranch_scc1 L_tr_CB14
L_back_CB14:
v_add_f32 v11, v11, v13
v_add_f32 v12, v12, v14
v_mfma_f32_16x16x32_bf16 v[68:71], v[252:255], v[28:31], v[68:71]
ds_read_b64_tr_b16 v[244:245], v1 offset:17544
ds_read_b64_tr_b16 v[246:247], v1 offset:18056
ds_read_b64_tr_b16 v[248:249], v2 offset:17536
ds_read_b64_tr_b16 v[250:251], v2 offset:18048
v_mfma_f32_16x16x32_bf16 v[72:75], v[252:255], v[32:35], v[72:75]
s_waitcnt lgkmcnt(10)
v_mfma_f32_16x16x32_bf16 v[76:79], v[228:231], v[28:31], v[76:79]
ds_read_b64_tr_b16 v[252:253], v2 offset:17544
ds_read_b64_tr_b16 v[254:255], v2 offset:18056
v_mfma_f32_16x16x32_bf16 v[80:83], v[228:231], v[32:35], v[80:83]
s_waitcnt lgkmcnt(10)
v_exp_f32 v16, v52
v_exp_f32 v17, v53
v_mov_b32 v13, v16
v_add_f32 v13, v13, v17
v_mfma_f32_16x16x32_bf16 v[84:87], v[232:235], v[28:31], v[84:87]
ds_read_b64_tr_b16 v[228:229], v5 offset:34816
ds_read_b64_tr_b16 v[230:231], v5 offset:35328
v_mfma_f32_16x16x32_bf16 v[88:91], v[232:235], v[32:35], v[88:91]
s_waitcnt lgkmcnt(10)
v_mfma_f32_16x16x32_bf16 v[92:95], v[236:239], v[28:31], v[92:95]
ds_read_b64_tr_b16 v[232:233], v6 offset:34816
ds_read_b64_tr_b16 v[234:235], v6 offset:35328
v_mfma_f32_16x16x32_bf16 v[96:99], v[236:239], v[32:35], v[96:99]
s_waitcnt lgkmcnt(10)
s_add_u32 m0, s78, 118272
s_add_u32 s62, s62, 128
buffer_load_dwordx4 v4, s[48:51], s62 offen offset:0 nt lds
s_add_u32 m0, s78, 122624
s_add_u32 s62, s62, 128
buffer_load_dwordx4 v4, s[48:51], s62 offen offset:0 nt lds
s_add_u32 m0, s69, 57792
s_add_u32 s64, s64, 8192
s_add_u32 s66, s66, 8192
buffer_load_dwordx4 v7, s[80:83], s64 offen offset:0 nt lds
v_mfma_f32_16x16x32_bf16 v[100:103], v[240:243], v[28:31], v[100:103]
ds_read_b64_tr_b16 v[236:237], v5 offset:34880
ds_read_b64_tr_b16 v[238:239], v5 offset:35392
v_mfma_f32_16x16x32_bf16 v[104:107], v[240:243], v[32:35], v[104:107]
s_waitcnt lgkmcnt(10)
buffer_load_dwordx4 v7, s[80:83], s66 offen offset:1024 nt lds
s_add_u32 m0, s76, 8256
v_mfma_f32_16x16x32_bf16 v[108:111], v[244:247], v[28:31], v[108:111]
ds_read_b64_tr_b16 v[240:241], v6 offset:34880
ds_read_b64_tr_b16 v[242:243], v6 offset:35392
v_mfma_f32_16x16x32_bf16 v[112:115], v[244:247], v[32:35], v[112:115]
s_waitcnt lgkmcnt(10)
s_add_u32 s65, s65, 8192
s_add_u32 s67, s67, 8192
v_mfma_f32_16x16x32_bf16 v[116:119], v[248:251], v[28:31], v[116:119]
ds_read_b64_tr_b16 v[244:245], v5 offset:39168
ds_read_b64_tr_b16 v[246:247], v5 offset:39680
v_mfma_f32_16x16x32_bf16 v[120:123], v[248:251], v[32:35], v[120:123]
s_waitcnt lgkmcnt(10)
buffer_load_dwordx4 v8, s[92:95], s65 offen offset:0 nt lds
buffer_load_dwordx4 v8, s[92:95], s67 offen offset:1024 nt lds
v_mfma_f32_16x16x32_bf16 v[124:127], v[252:255], v[28:31], v[124:127]
ds_read_b64_tr_b16 v[248:249], v6 offset:39168
ds_read_b64_tr_b16 v[250:251], v6 offset:39680
v_mfma_f32_16x16x32_bf16 v[128:131], v[252:255], v[32:35], v[128:131]
s_waitcnt lgkmcnt(10)
buffer_load_dwordx4 v[164:167], v10, s[28:31], s38 offen offset:0
buffer_load_dwordx4 v[168:171], v10, s[28:31], s38 offen offset:1024
v_cvt_pk_bf16_f32 v28, v16, v17
v_exp_f32 v18, v54
v_exp_f32 v19, v55
v_add_f32 v13, v13, v18
v_add_f32 v13, v13, v19
v_cvt_pk_bf16_f32 v29, v18, v19
v_exp_f32 v16, v56
v_exp_f32 v17, v57
v_add_f32 v13, v13, v16
v_add_f32 v13, v13, v17
v_cvt_pk_bf16_f32 v30, v16, v17
v_exp_f32 v18, v58
v_exp_f32 v19, v59
v_add_f32 v13, v13, v18
v_add_f32 v13, v13, v19
v_cvt_pk_bf16_f32 v31, v18, v19
v_exp_f32 v16, v60
v_exp_f32 v17, v61
v_mfma_f32_16x16x32_bf16 a[192:195], v[228:231], v[196:199], a[192:195]
ds_read_b64_tr_b16 v[252:253], v5 offset:39232
ds_read_b64_tr_b16 v[254:255], v5 offset:39744
v_mfma_f32_16x16x32_bf16 a[196:199], v[228:231], v[200:203], a[196:199]
s_waitcnt lgkmcnt(10)
buffer_load_dwordx4 v[172:175], v10, s[28:31], s38 offen offset:2048
buffer_load_dwordx4 v[176:179], v10, s[28:31], s38 offen offset:3072
v_mov_b32 v14, v16
v_add_f32 v14, v14, v17
v_mfma_f32_16x16x32_bf16 a[200:203], v[232:235], v[196:199], a[200:203]
ds_read_b64_tr_b16 v[228:229], v6 offset:39232
ds_read_b64_tr_b16 v[230:231], v6 offset:39744
v_mfma_f32_16x16x32_bf16 a[204:207], v[232:235], v[200:203], a[204:207]
s_waitcnt lgkmcnt(10)
buffer_load_dwordx4 v[180:183], v10, s[28:31], s74 offen offset:0
buffer_load_dwordx4 v[184:187], v10, s[28:31], s74 offen offset:1024
v_cvt_pk_bf16_f32 v32, v16, v17
v_exp_f32 v18, v62
v_mfma_f32_16x16x32_bf16 a[208:211], v[236:239], v[196:199], a[208:211]
ds_read_b64_tr_b16 v[232:233], v5 offset:43520
ds_read_b64_tr_b16 v[234:235], v5 offset:44032
v_mfma_f32_16x16x32_bf16 a[212:215], v[236:239], v[200:203], a[212:215]
s_waitcnt lgkmcnt(10)
buffer_load_dwordx4 v[188:191], v10, s[28:31], s74 offen offset:2048
buffer_load_dwordx4 v[192:195], v10, s[28:31], s74 offen offset:3072
v_exp_f32 v19, v63
v_mfma_f32_16x16x32_bf16 a[216:219], v[240:243], v[196:199], a[216:219]
ds_read_b64_tr_b16 v[236:237], v6 offset:43520
ds_read_b64_tr_b16 v[238:239], v6 offset:44032
v_mfma_f32_16x16x32_bf16 a[220:223], v[240:243], v[200:203], a[220:223]
s_waitcnt lgkmcnt(10)
s_add_u32 s38, s38, 8192
s_add_u32 s74, s74, 8192
v_add_f32 v14, v14, v18
v_mfma_f32_16x16x32_bf16 a[224:227], v[244:247], v[196:199], a[224:227]
ds_read_b64_tr_b16 v[240:241], v5 offset:43584
ds_read_b64_tr_b16 v[242:243], v5 offset:44096
v_mfma_f32_16x16x32_bf16 a[228:231], v[244:247], v[200:203], a[228:231]
s_waitcnt lgkmcnt(10)
v_add_f32 v14, v14, v19
v_cvt_pk_bf16_f32 v33, v18, v19
v_mfma_f32_16x16x32_bf16 a[232:235], v[248:251], v[196:199], a[232:235]
ds_read_b64_tr_b16 v[244:245], v6 offset:43584
ds_read_b64_tr_b16 v[246:247], v6 offset:44096
v_mfma_f32_16x16x32_bf16 a[236:239], v[248:251], v[200:203], a[236:239]
s_waitcnt lgkmcnt(10)
v_exp_f32 v16, v64
v_mfma_f32_16x16x32_bf16 a[240:243], v[252:255], v[196:199], a[240:243]
v_exp_f32 v17, v65
v_mfma_f32_16x16x32_bf16 a[244:247], v[252:255], v[200:203], a[244:247]
s_waitcnt lgkmcnt(8)
v_add_f32 v14, v14, v16
v_mfma_f32_16x16x32_bf16 a[248:251], v[228:231], v[196:199], a[248:251]
v_add_f32 v14, v14, v17
v_cvt_pk_bf16_f32 v34, v16, v17
v_mfma_f32_16x16x32_bf16 a[252:255], v[228:231], v[200:203], a[252:255]
s_waitcnt vmcnt(20) lgkmcnt(0)
s_barrier
ds_read_b64_tr_b16 v[248:249], v1 offset:24768
ds_read_b64_tr_b16 v[250:251], v1 offset:25280
v_mfma_f32_16x16x32_bf16 v[132:135], v[232:235], v[196:199], v[132:135]
ds_read_b64_tr_b16 v[252:253], v1 offset:24776
ds_read_b64_tr_b16 v[254:255], v1 offset:25288
ds_read_b64_tr_b16 v[228:229], v2 offset:24768
ds_read_b64_tr_b16 v[230:231], v2 offset:25280
v_mfma_f32_16x16x32_bf16 v[136:139], v[232:235], v[200:203], v[136:139]
v_exp_f32 v18, v66
v_mfma_f32_16x16x32_bf16 v[140:143], v[236:239], v[196:199], v[140:143]
ds_read_b64_tr_b16 v[232:233], v2 offset:24776
ds_read_b64_tr_b16 v[234:235], v2 offset:25288
v_mfma_f32_16x16x32_bf16 v[144:147], v[236:239], v[200:203], v[144:147]
v_exp_f32 v19, v67
v_mfma_f32_16x16x32_bf16 v[148:151], v[240:243], v[196:199], v[148:151]
ds_read_b64_tr_b16 v[236:237], v1 offset:25792
ds_read_b64_tr_b16 v[238:239], v1 offset:26304
v_mfma_f32_16x16x32_bf16 v[152:155], v[240:243], v[200:203], v[152:155]
v_add_f32 v14, v14, v18
v_add_f32 v14, v14, v19
v_mfma_f32_16x16x32_bf16 v[156:159], v[244:247], v[196:199], v[156:159]
ds_read_b64_tr_b16 v[240:241], v1 offset:25800
ds_read_b64_tr_b16 v[242:243], v1 offset:26312
v_mfma_f32_16x16x32_bf16 v[160:163], v[244:247], v[200:203], v[160:163]
s_waitcnt lgkmcnt(10)
v_cvt_pk_bf16_f32 v35, v18, v19
v_add_f32 v15, v13, v14
v_cmp_nle_f32 s[70:71], v15, s73
s_cmp_lg_u64 s[70:71], 0
s_cbranch_scc1 L_tr_CB15
L_back_CB15:
v_add_f32 v11, v11, v13
v_add_f32 v12, v12, v14
v_mfma_f32_16x16x32_bf16 v[68:71], v[248:251], v[28:31], v[68:71]
ds_read_b64_tr_b16 v[244:245], v2 offset:25792
ds_read_b64_tr_b16 v[246:247], v2 offset:26304
v_mfma_f32_16x16x32_bf16 v[72:75], v[248:251], v[32:35], v[72:75]
s_waitcnt lgkmcnt(10)
v_mfma_f32_16x16x32_bf16 v[76:79], v[252:255], v[28:31], v[76:79]
ds_read_b64_tr_b16 v[248:249], v2 offset:25800
ds_read_b64_tr_b16 v[250:251], v2 offset:26312
v_mfma_f32_16x16x32_bf16 v[80:83], v[252:255], v[32:35], v[80:83]
s_waitcnt lgkmcnt(10)
v_mfma_f32_16x16x32_bf16 v[84:87], v[228:231], v[28:31], v[84:87]
v_mfma_f32_16x16x32_bf16 v[88:91], v[228:231], v[32:35], v[88:91]
s_waitcnt lgkmcnt(8)
v_mfma_f32_16x16x32_bf16 v[92:95], v[232:235], v[28:31], v[92:95]
v_mfma_f32_16x16x32_bf16 v[96:99], v[232:235], v[32:35], v[96:99]
s_waitcnt lgkmcnt(6)
v_mfma_f32_16x16x32_bf16 v[100:103], v[236:239], v[28:31], v[100:103]
v_mfma_f32_16x16x32_bf16 v[104:107], v[236:239], v[32:35], v[104:107]
s_waitcnt lgkmcnt(4)
v_mfma_f32_16x16x32_bf16 v[108:111], v[240:243], v[28:31], v[108:111]
v_mfma_f32_16x16x32_bf16 v[112:115], v[240:243], v[32:35], v[112:115]
s_waitcnt lgkmcnt(2)
v_mfma_f32_16x16x32_bf16 v[116:119], v[244:247], v[28:31], v[116:119]
v_mfma_f32_16x16x32_bf16 v[120:123], v[244:247], v[32:35], v[120:123]
s_waitcnt lgkmcnt(0)
v_mfma_f32_16x16x32_bf16 v[124:127], v[248:251], v[28:31], v[124:127]
v_mfma_f32_16x16x32_bf16 v[128:131], v[248:251], v[32:35], v[128:131]
s_nop 3
v_mov_b32 v15, v11
s_nop 1
v_permlane32_swap_b32 v11, v15
v_add_f32 v11, v11, v15
v_mov_b32 v15, v11
s_nop 1
v_permlane16_swap_b32 v11, v15
v_add_f32 v11, v11, v15
v_rcp_f32 v16, v11
v_mov_b32 v15, v12
s_nop 1
v_permlane32_swap_b32 v12, v15
v_add_f32 v12, v12, v15
v_mov_b32 v15, v12
s_nop 1
v_permlane16_swap_b32 v12, v15
v_add_f32 v12, v12, v15
v_rcp_f32 v17, v12
s_nop 3
v_mul_f32 v68, v68, v16
v_mul_f32 v69, v69, v16
v_mul_f32 v70, v70, v16
v_mul_f32 v71, v71, v16
v_cvt_pk_bf16_f32 v196, v68, v69
v_cvt_pk_bf16_f32 v197, v70, v71
v_mul_f32 v76, v76, v16
v_mul_f32 v77, v77, v16
v_mul_f32 v78, v78, v16
v_mul_f32 v79, v79, v16
v_cvt_pk_bf16_f32 v198, v76, v77
v_cvt_pk_bf16_f32 v199, v78, v79
v_mul_f32 v72, v72, v17
v_mul_f32 v73, v73, v17
v_mul_f32 v74, v74, v17
v_mul_f32 v75, v75, v17
v_cvt_pk_bf16_f32 v200, v72, v73
v_cvt_pk_bf16_f32 v201, v74, v75
v_mul_f32 v80, v80, v17
v_mul_f32 v81, v81, v17
v_mul_f32 v82, v82, v17
v_mul_f32 v83, v83, v17
v_cvt_pk_bf16_f32 v202, v80, v81
v_cvt_pk_bf16_f32 v203, v82, v83
v_mul_f32 v84, v84, v16
v_mul_f32 v85, v85, v16
v_mul_f32 v86, v86, v16
v_mul_f32 v87, v87, v16
v_cvt_pk_bf16_f32 v204, v84, v85
v_cvt_pk_bf16_f32 v205, v86, v87
v_mul_f32 v92, v92, v16
v_mul_f32 v93, v93, v16
v_mul_f32 v94, v94, v16
v_mul_f32 v95, v95, v16
v_cvt_pk_bf16_f32 v206, v92, v93
v_cvt_pk_bf16_f32 v207, v94, v95
v_mul_f32 v88, v88, v17
v_mul_f32 v89, v89, v17
v_mul_f32 v90, v90, v17
v_mul_f32 v91, v91, v17
v_cvt_pk_bf16_f32 v208, v88, v89
v_cvt_pk_bf16_f32 v209, v90, v91
v_mul_f32 v96, v96, v17
v_mul_f32 v97, v97, v17
v_mul_f32 v98, v98, v17
v_mul_f32 v99, v99, v17
v_cvt_pk_bf16_f32 v210, v96, v97
v_cvt_pk_bf16_f32 v211, v98, v99
v_mul_f32 v100, v100, v16
v_mul_f32 v101, v101, v16
v_mul_f32 v102, v102, v16
v_mul_f32 v103, v103, v16
v_cvt_pk_bf16_f32 v212, v100, v101
v_cvt_pk_bf16_f32 v213, v102, v103
v_mul_f32 v108, v108, v16
v_mul_f32 v109, v109, v16
v_mul_f32 v110, v110, v16
v_mul_f32 v111, v111, v16
v_cvt_pk_bf16_f32 v214, v108, v109
v_cvt_pk_bf16_f32 v215, v110, v111
v_mul_f32 v104, v104, v17
v_mul_f32 v105, v105, v17
v_mul_f32 v106, v106, v17
v_mul_f32 v107, v107, v17
v_cvt_pk_bf16_f32 v216, v104, v105
v_cvt_pk_bf16_f32 v217, v106, v107
v_mul_f32 v112, v112, v17
v_mul_f32 v113, v113, v17
v_mul_f32 v114, v114, v17
v_mul_f32 v115, v115, v17
v_cvt_pk_bf16_f32 v218, v112, v113
v_cvt_pk_bf16_f32 v219, v114, v115
v_mul_f32 v116, v116, v16
v_mul_f32 v117, v117, v16
v_mul_f32 v118, v118, v16
v_mul_f32 v119, v119, v16
v_cvt_pk_bf16_f32 v220, v116, v117
v_cvt_pk_bf16_f32 v221, v118, v119
v_mul_f32 v124, v124, v16
v_mul_f32 v125, v125, v16
v_mul_f32 v126, v126, v16
v_mul_f32 v127, v127, v16
v_cvt_pk_bf16_f32 v222, v124, v125
v_cvt_pk_bf16_f32 v223, v126, v127
v_mul_f32 v120, v120, v17
v_mul_f32 v121, v121, v17
v_mul_f32 v122, v122, v17
v_mul_f32 v123, v123, v17
v_cvt_pk_bf16_f32 v224, v120, v121
v_cvt_pk_bf16_f32 v225, v122, v123
v_mul_f32 v128, v128, v17
v_mul_f32 v129, v129, v17
v_mul_f32 v130, v130, v17
v_mul_f32 v131, v131, v17
v_cvt_pk_bf16_f32 v226, v128, v129
v_cvt_pk_bf16_f32 v227, v130, v131
s_nop 1
s_add_u32 s58, s58, 1
s_cmp_lt_u32 s58, 4
s_cbranch_scc1 L_head_C
s_waitcnt lgkmcnt(0)
s_barrier
ds_read_b64_tr_b16 v[228:229], v5 offset:0
ds_read_b64_tr_b16 v[230:231], v5 offset:512
ds_read_b64_tr_b16 v[232:233], v6 offset:0
ds_read_b64_tr_b16 v[234:235], v6 offset:512
ds_read_b64_tr_b16 v[236:237], v5 offset:64
ds_read_b64_tr_b16 v[238:239], v5 offset:576
ds_read_b64_tr_b16 v[240:241], v6 offset:64
ds_read_b64_tr_b16 v[242:243], v6 offset:576
ds_read_b64_tr_b16 v[244:245], v5 offset:4352
ds_read_b64_tr_b16 v[246:247], v5 offset:4864
ds_read_b64_tr_b16 v[248:249], v6 offset:4352
ds_read_b64_tr_b16 v[250:251], v6 offset:4864
ds_read_b64_tr_b16 v[252:253], v5 offset:4416
ds_read_b64_tr_b16 v[254:255], v5 offset:4928
s_add_u32 m0, s78, 100864
s_add_u32 s62, s62, 128
buffer_load_dwordx4 v4, s[48:51], s62 offen offset:0 nt lds
s_waitcnt lgkmcnt(12)
v_mfma_f32_16x16x32_bf16 a[0:3], v[228:231], v[196:199], a[0:3]
s_add_u32 m0, s78, 105216
s_add_u32 s62, s62, 128
v_mfma_f32_16x16x32_bf16 a[4:7], v[228:231], v[200:203], a[4:7]
s_waitcnt lgkmcnt(10)
buffer_load_dwordx4 v4, s[48:51], s62 offen offset:0 nt lds
v_mfma_f32_16x16x32_bf16 a[8:11], v[232:235], v[196:199], a[8:11]
ds_read_b64_tr_b16 v[228:229], v6 offset:4416
ds_read_b64_tr_b16 v[230:231], v6 offset:4928
v_mfma_f32_16x16x32_bf16 a[12:15], v[232:235], v[200:203], a[12:15]
s_waitcnt lgkmcnt(10)
s_add_u32 m0, s78, 109568
v_mfma_f32_16x16x32_bf16 a[16:19], v[236:239], v[196:199], a[16:19]
s_add_u32 s62, s62, 128
buffer_load_dwordx4 v4, s[48:51], s62 offen offset:0 nt lds
v_mfma_f32_16x16x32_bf16 a[20:23], v[236:239], v[200:203], a[20:23]
s_waitcnt lgkmcnt(8)
v_mfma_f32_16x16x32_bf16 a[24:27], v[240:243], v[196:199], a[24:27]
v_mfma_f32_16x16x32_bf16 a[28:31], v[240:243], v[200:203], a[28:31]
s_mov_b32 s39, 3
L_loop3:
s_waitcnt vmcnt(5) lgkmcnt(0)
s_barrier
ds_read_b64_tr_b16 v[240:241], v5 offset:17408
ds_read_b64_tr_b16 v[242:243], v5 offset:17920
v_mfma_f32_16x16x32_bf16 a[32:35], v[244:247], v[196:199], a[32:35]
s_add_u32 m0, s78, 66048
s_add_u32 s62, s62, 35840
v_mfma_f32_16x16x32_bf16 a[36:39], v[244:247], v[200:203], a[36:39]
ds_read_b64_tr_b16 v[244:245], v6 offset:17408
ds_read_b64_tr_b16 v[246:247], v6 offset:17920
v_mfma_f32_16x16x32_bf16 a[40:43], v[248:251], v[196:199], a[40:43]
buffer_load_dwordx4 v4, s[48:51], s62 offen offset:0 nt lds
s_add_u32 m0, s78, 70400
v_mfma_f32_16x16x32_bf16 a[44:47], v[248:251], v[200:203], a[44:47]
ds_read_b64_tr_b16 v[248:249], v5 offset:17472
ds_read_b64_tr_b16 v[250:251], v5 offset:17984
v_mfma_f32_16x16x32_bf16 a[48:51], v[252:255], v[196:199], a[48:51]
s_add_u32 s62, s62, 128
buffer_load_dwordx4 v4, s[48:51], s62 offen offset:0 nt lds
v_mfma_f32_16x16x32_bf16 a[52:55], v[252:255], v[200:203], a[52:55]
ds_read_b64_tr_b16 v[252:253], v6 offset:17472
ds_read_b64_tr_b16 v[254:255], v6 offset:17984
v_mfma_f32_16x16x32_bf16 a[56:59], v[228:231], v[196:199], a[56:59]
v_mfma_f32_16x16x32_bf16 a[60:63], v[228:231], v[200:203], a[60:63]
s_waitcnt lgkmcnt(6)
ds_read_b64_tr_b16 v[228:229], v5 offset:21760
ds_read_b64_tr_b16 v[230:231], v5 offset:22272
v_mfma_f32_16x16x32_bf16 a[64:67], v[240:243], v[196:199], a[64:67]
ds_read_b64_tr_b16 v[232:233], v6 offset:21760
ds_read_b64_tr_b16 v[234:235], v6 offset:22272
ds_read_b64_tr_b16 v[236:237], v5 offset:21824
ds_read_b64_tr_b16 v[238:239], v5 offset:22336
v_mfma_f32_16x16x32_bf16 a[68:71], v[240:243], v[200:203], a[68:71]
s_waitcnt lgkmcnt(10)
v_mfma_f32_16x16x32_bf16 a[72:75], v[244:247], v[196:199], a[72:75]
ds_read_b64_tr_b16 v[240:241], v6 offset:21824
ds_read_b64_tr_b16 v[242:243], v6 offset:22336
v_mfma_f32_16x16x32_bf16 a[76:79], v[244:247], v[200:203], a[76:79]
s_waitcnt lgkmcnt(10)
v_mfma_f32_16x16x32_bf16 a[80:83], v[248:251], v[196:199], a[80:83]
v_mfma_f32_16x16x32_bf16 a[84:87], v[248:251], v[200:203], a[84:87]
s_waitcnt lgkmcnt(8)
v_mfma_f32_16x16x32_bf16 a[88:91], v[252:255], v[196:199], a[88:91]
v_mfma_f32_16x16x32_bf16 a[92:95], v[252:255], v[200:203], a[92:95]
s_waitcnt vmcnt(5) lgkmcnt(0)
s_barrier
ds_read_b64_tr_b16 v[252:253], v5 offset:52224
ds_read_b64_tr_b16 v[254:255], v5 offset:52736
v_mfma_f32_16x16x32_bf16 a[96:99], v[228:231], v[196:199], a[96:99]
s_add_u32 m0, s78, 83456
s_add_u32 s62, s62, 128
v_mfma_f32_16x16x32_bf16 a[100:103], v[228:231], v[200:203], a[100:103]
ds_read_b64_tr_b16 v[228:229], v6 offset:52224
ds_read_b64_tr_b16 v[230:231], v6 offset:52736
v_mfma_f32_16x16x32_bf16 a[104:107], v[232:235], v[196:199], a[104:107]
buffer_load_dwordx4 v4, s[48:51], s62 offen offset:0 nt lds
s_add_u32 m0, s78, 87808
v_mfma_f32_16x16x32_bf16 a[108:111], v[232:235], v[200:203], a[108:111]
ds_read_b64_tr_b16 v[232:233], v5 offset:52288
ds_read_b64_tr_b16 v[234:235], v5 offset:52800
v_mfma_f32_16x16x32_bf16 a[112:115], v[236:239], v[196:199], a[112:115]
s_add_u32 s62, s62, 128
buffer_load_dwordx4 v4, s[48:51], s62 offen offset:0 nt lds
v_mfma_f32_16x16x32_bf16 a[116:119], v[236:239], v[200:203], a[116:119]
ds_read_b64_tr_b16 v[236:237], v6 offset:52288
ds_read_b64_tr_b16 v[238:239], v6 offset:52800
v_mfma_f32_16x16x32_bf16 a[120:123], v[240:243], v[196:199], a[120:123]
v_mfma_f32_16x16x32_bf16 a[124:127], v[240:243], v[200:203], a[124:127]
s_waitcnt lgkmcnt(6)
ds_read_b64_tr_b16 v[240:241], v5 offset:56576
ds_read_b64_tr_b16 v[242:243], v5 offset:57088
v_mfma_f32_16x16x32_bf16 a[128:131], v[252:255], v[196:199], a[128:131]
ds_read_b64_tr_b16 v[244:245], v6 offset:56576
ds_read_b64_tr_b16 v[246:247], v6 offset:57088
ds_read_b64_tr_b16 v[248:249], v5 offset:56640
ds_read_b64_tr_b16 v[250:251], v5 offset:57152
v_mfma_f32_16x16x32_bf16 a[132:135], v[252:255], v[200:203], a[132:135]
s_waitcnt lgkmcnt(10)
v_mfma_f32_16x16x32_bf16 a[136:139], v[228:231], v[196:199], a[136:139]
ds_read_b64_tr_b16 v[252:253], v6 offset:56640
ds_read_b64_tr_b16 v[254:255], v6 offset:57152
v_mfma_f32_16x16x32_bf16 a[140:143], v[228:231], v[200:203], a[140:143]
s_waitcnt lgkmcnt(10)
v_mfma_f32_16x16x32_bf16 a[144:147], v[232:235], v[196:199], a[144:147]
v_mfma_f32_16x16x32_bf16 a[148:151], v[232:235], v[200:203], a[148:151]
s_waitcnt lgkmcnt(8)
v_mfma_f32_16x16x32_bf16 a[152:155], v[236:239], v[196:199], a[152:155]
v_mfma_f32_16x16x32_bf16 a[156:159], v[236:239], v[200:203], a[156:159]
s_waitcnt vmcnt(4) lgkmcnt(0)
s_barrier
ds_read_b64_tr_b16 v[236:237], v5 offset:34816
ds_read_b64_tr_b16 v[238:239], v5 offset:35328
v_mfma_f32_16x16x32_bf16 a[160:163], v[240:243], v[196:199], a[160:163]
s_add_u32 m0, s78, 118272
s_add_u32 s62, s62, 128
v_mfma_f32_16x16x32_bf16 a[164:167], v[240:243], v[200:203], a[164:167]
ds_read_b64_tr_b16 v[240:241], v6 offset:34816
ds_read_b64_tr_b16 v[242:243], v6 offset:35328
v_mfma_f32_16x16x32_bf16 a[168:171], v[244:247], v[196:199], a[168:171]
buffer_load_dwordx4 v4, s[48:51], s62 offen offset:0 nt lds
s_add_u32 m0, s78, 122624
v_mfma_f32_16x16x32_bf16 a[172:175], v[244:247], v[200:203], a[172:175]
ds_read_b64_tr_b16 v[244:245], v5 offset:34880
ds_read_b64_tr_b16 v[246:247], v5 offset:35392
v_mfma_f32_16x16x32_bf16 a[176:179], v[248:251], v[196:199], a[176:179]
s_add_u32 s62, s62, 128
buffer_load_dwordx4 v4, s[48:51], s62 offen offset:0 nt lds
v_mfma_f32_16x16x32_bf16 a[180:183], v[248:251], v[200:203], a[180:183]
ds_read_b64_tr_b16 v[248:249], v6 offset:34880
ds_read_b64_tr_b16 v[250:251], v6 offset:35392
v_mfma_f32_16x16x32_bf16 a[184:187], v[252:255], v[196:199], a[184:187]
v_mfma_f32_16x16x32_bf16 a[188:191], v[252:255], v[200:203], a[188:191]
s_waitcnt lgkmcnt(6)
ds_read_b64_tr_b16 v[252:253], v5 offset:39168
ds_read_b64_tr_b16 v[254:255], v5 offset:39680
v_mfma_f32_16x16x32_bf16 a[192:195], v[236:239], v[196:199], a[192:195]
ds_read_b64_tr_b16 v[228:229], v6 offset:39168
ds_read_b64_tr_b16 v[230:231], v6 offset:39680
ds_read_b64_tr_b16 v[232:233], v5 offset:39232
ds_read_b64_tr_b16 v[234:235], v5 offset:39744
v_mfma_f32_16x16x32_bf16 a[196:199], v[236:239], v[200:203], a[196:199]
s_waitcnt lgkmcnt(10)
v_mfma_f32_16x16x32_bf16 a[200:203], v[240:243], v[196:199], a[200:203]
ds_read_b64_tr_b16 v[236:237], v6 offset:39232
ds_read_b64_tr_b16 v[238:239], v6 offset:39744
v_mfma_f32_16x16x32_bf16 a[204:207], v[240:243], v[200:203], a[204:207]
s_waitcnt lgkmcnt(10)
v_mfma_f32_16x16x32_bf16 a[208:211], v[244:247], v[196:199], a[208:211]
ds_read_b64_tr_b16 v[240:241], v5 offset:43520
ds_read_b64_tr_b16 v[242:243], v5 offset:44032
v_mfma_f32_16x16x32_bf16 a[212:215], v[244:247], v[200:203], a[212:215]
s_waitcnt lgkmcnt(10)
v_mfma_f32_16x16x32_bf16 a[216:219], v[248:251], v[196:199], a[216:219]
ds_read_b64_tr_b16 v[244:245], v6 offset:43520
ds_read_b64_tr_b16 v[246:247], v6 offset:44032
v_mfma_f32_16x16x32_bf16 a[220:223], v[248:251], v[200:203], a[220:223]
s_waitcnt lgkmcnt(10)
v_mfma_f32_16x16x32_bf16 a[224:227], v[252:255], v[196:199], a[224:227]
ds_read_b64_tr_b16 v[248:249], v5 offset:43584
ds_read_b64_tr_b16 v[250:251], v5 offset:44096
v_mfma_f32_16x16x32_bf16 a[228:231], v[252:255], v[200:203], a[228:231]
s_waitcnt lgkmcnt(10)
v_mfma_f32_16x16x32_bf16 a[232:235], v[228:231], v[196:199], a[232:235]
ds_read_b64_tr_b16 v[252:253], v6 offset:43584
ds_read_b64_tr_b16 v[254:255], v6 offset:44096
v_mfma_f32_16x16x32_bf16 a[236:239], v[228:231], v[200:203], a[236:239]
s_waitcnt lgkmcnt(10)
v_mfma_f32_16x16x32_bf16 a[240:243], v[232:235], v[196:199], a[240:243]
v_mfma_f32_16x16x32_bf16 a[244:247], v[232:235], v[200:203], a[244:247]
s_waitcnt lgkmcnt(8)
v_mfma_f32_16x16x32_bf16 a[248:251], v[236:239], v[196:199], a[248:251]
v_mfma_f32_16x16x32_bf16 a[252:255], v[236:239], v[200:203], a[252:255]
s_waitcnt vmcnt(4) lgkmcnt(0)
s_barrier
ds_read_b64_tr_b16 v[228:229], v5 offset:0
ds_read_b64_tr_b16 v[230:231], v5 offset:512
v_mfma_f32_16x16x32_bf16 v[132:135], v[240:243], v[196:199], v[132:135]
ds_read_b64_tr_b16 v[232:233], v6 offset:0
ds_read_b64_tr_b16 v[234:235], v6 offset:512
ds_read_b64_tr_b16 v[236:237], v5 offset:64
ds_read_b64_tr_b16 v[238:239], v5 offset:576
v_mfma_f32_16x16x32_bf16 v[136:139], v[240:243], v[200:203], v[136:139]
s_add_u32 m0, s78, 100864
s_add_u32 s62, s62, 128
v_mfma_f32_16x16x32_bf16 v[140:143], v[244:247], v[196:199], v[140:143]
ds_read_b64_tr_b16 v[240:241], v6 offset:64
ds_read_b64_tr_b16 v[242:243], v6 offset:576
v_mfma_f32_16x16x32_bf16 v[144:147], v[244:247], v[200:203], v[144:147]
buffer_load_dwordx4 v4, s[48:51], s62 offen offset:0 nt lds
s_add_u32 m0, s78, 105216
v_mfma_f32_16x16x32_bf16 v[148:151], v[248:251], v[196:199], v[148:151]
ds_read_b64_tr_b16 v[244:245], v5 offset:4352
ds_read_b64_tr_b16 v[246:247], v5 offset:4864
v_mfma_f32_16x16x32_bf16 v[152:155], v[248:251], v[200:203], v[152:155]
s_add_u32 s62, s62, 128
buffer_load_dwordx4 v4, s[48:51], s62 offen offset:0 nt lds
v_mfma_f32_16x16x32_bf16 v[156:159], v[252:255], v[196:199], v[156:159]
ds_read_b64_tr_b16 v[248:249], v6 offset:4352
ds_read_b64_tr_b16 v[250:251], v6 offset:4864
v_mfma_f32_16x16x32_bf16 v[160:163], v[252:255], v[200:203], v[160:163]
s_waitcnt lgkmcnt(10)
s_add_u32 m0, s78, 109568
v_mov_b32 v196, v204
v_mov_b32 v197, v205
v_mov_b32 v198, v206
v_mov_b32 v199, v207
v_mov_b32 v200, v208
v_mov_b32 v201, v209
v_mov_b32 v202, v210
v_mov_b32 v203, v211
v_mov_b32 v204, v212
v_mov_b32 v205, v213
v_mov_b32 v206, v214
v_mov_b32 v207, v215
v_mov_b32 v208, v216
v_mov_b32 v209, v217
v_mov_b32 v210, v218
v_mov_b32 v211, v219
v_mov_b32 v212, v220
v_mov_b32 v213, v221
v_mov_b32 v214, v222
v_mov_b32 v215, v223
v_mov_b32 v216, v224
v_mov_b32 v217, v225
v_mov_b32 v218, v226
v_mov_b32 v219, v227
s_nop 1
v_mfma_f32_16x16x32_bf16 a[0:3], v[228:231], v[196:199], a[0:3]
ds_read_b64_tr_b16 v[252:253], v5 offset:4416
ds_read_b64_tr_b16 v[254:255], v5 offset:4928
v_mfma_f32_16x16x32_bf16 a[4:7], v[228:231], v[200:203], a[4:7]
s_waitcnt lgkmcnt(10)
s_add_u32 s62, s62, 128
v_mfma_f32_16x16x32_bf16 a[8:11], v[232:235], v[196:199], a[8:11]
ds_read_b64_tr_b16 v[228:229], v6 offset:4416
ds_read_b64_tr_b16 v[230:231], v6 offset:4928
v_mfma_f32_16x16x32_bf16 a[12:15], v[232:235], v[200:203], a[12:15]
s_waitcnt lgkmcnt(10)
buffer_load_dwordx4 v4, s[48:51], s62 offen offset:0 nt lds
v_mfma_f32_16x16x32_bf16 a[16:19], v[236:239], v[196:199], a[16:19]
v_mfma_f32_16x16x32_bf16 a[20:23], v[236:239], v[200:203], a[20:23]
s_waitcnt lgkmcnt(8)
v_mfma_f32_16x16x32_bf16 a[24:27], v[240:243], v[196:199], a[24:27]
v_mfma_f32_16x16x32_bf16 a[28:31], v[240:243], v[200:203], a[28:31]
s_sub_u32 s39, s39, 1
s_cmp_lg_u32 s39, 0
s_cbranch_scc1 L_loop3
s_waitcnt vmcnt(5) lgkmcnt(0)
s_barrier
ds_read_b64_tr_b16 v[240:241], v5 offset:17408
ds_read_b64_tr_b16 v[242:243], v5 offset:17920
v_mfma_f32_16x16x32_bf16 a[32:35], v[244:247], v[196:199], a[32:35]
s_add_u32 m0, s78, 66048
s_add_u32 s62, s62, 35840
v_mfma_f32_16x16x32_bf16 a[36:39], v[244:247], v[200:203], a[36:39]
ds_read_b64_tr_b16 v[244:245], v6 offset:17408
ds_read_b64_tr_b16 v[246:247], v6 offset:17920
v_mfma_f32_16x16x32_bf16 a[40:43], v[248:251], v[196:199], a[40:43]
buffer_load_dwordx4 v4, s[48:51], s62 offen offset:0 nt lds
s_add_u32 m0, s78, 70400
v_mfma_f32_16x16x32_bf16 a[44:47], v[248:251], v[200:203], a[44:47]
ds_read_b64_tr_b16 v[248:249], v5 offset:17472
ds_read_b64_tr_b16 v[250:251], v5 offset:17984
v_mfma_f32_16x16x32_bf16 a[48:51], v[252:255], v[196:199], a[48:51]
s_add_u32 s62, s62, 128
buffer_load_dwordx4 v4, s[48:51], s62 offen offset:0 nt lds
v_mfma_f32_16x16x32_bf16 a[52:55], v[252:255], v[200:203], a[52:55]
ds_read_b64_tr_b16 v[252:253], v6 offset:17472
ds_read_b64_tr_b16 v[254:255], v6 offset:17984
v_mfma_f32_16x16x32_bf16 a[56:59], v[228:231], v[196:199], a[56:59]
v_mfma_f32_16x16x32_bf16 a[60:63], v[228:231], v[200:203], a[60:63]
s_waitcnt lgkmcnt(6)
ds_read_b64_tr_b16 v[228:229], v5 offset:21760
ds_read_b64_tr_b16 v[230:231], v5 offset:22272
v_mfma_f32_16x16x32_bf16 a[64:67], v[240:243], v[196:199], a[64:67]
ds_read_b64_tr_b16 v[232:233], v6 offset:21760
ds_read_b64_tr_b16 v[234:235], v6 offset:22272
ds_read_b64_tr_b16 v[236:237], v5 offset:21824
ds_read_b64_tr_b16 v[238:239], v5 offset:22336
v_mfma_f32_16x16x32_bf16 a[68:71], v[240:243], v[200:203], a[68:71]
s_waitcnt lgkmcnt(10)
v_mfma_f32_16x16x32_bf16 a[72:75], v[244:247], v[196:199], a[72:75]
ds_read_b64_tr_b16 v[240:241], v6 offset:21824
ds_read_b64_tr_b16 v[242:243], v6 offset:22336
v_mfma_f32_16x16x32_bf16 a[76:79], v[244:247], v[200:203], a[76:79]
s_waitcnt lgkmcnt(10)
v_mfma_f32_16x16x32_bf16 a[80:83], v[248:251], v[196:199], a[80:83]
v_mfma_f32_16x16x32_bf16 a[84:87], v[248:251], v[200:203], a[84:87]
s_waitcnt lgkmcnt(8)
v_mfma_f32_16x16x32_bf16 a[88:91], v[252:255], v[196:199], a[88:91]
v_mfma_f32_16x16x32_bf16 a[92:95], v[252:255], v[200:203], a[92:95]
s_waitcnt vmcnt(5) lgkmcnt(0)
s_barrier
ds_read_b64_tr_b16 v[252:253], v5 offset:52224
ds_read_b64_tr_b16 v[254:255], v5 offset:52736
v_mfma_f32_16x16x32_bf16 a[96:99], v[228:231], v[196:199], a[96:99]
s_add_u32 m0, s78, 83456
s_add_u32 s62, s62, 128
v_mfma_f32_16x16x32_bf16 a[100:103], v[228:231], v[200:203], a[100:103]
ds_read_b64_tr_b16 v[228:229], v6 offset:52224
ds_read_b64_tr_b16 v[230:231], v6 offset:52736
v_mfma_f32_16x16x32_bf16 a[104:107], v[232:235], v[196:199], a[104:107]
buffer_load_dwordx4 v4, s[48:51], s62 offen offset:0 nt lds
s_add_u32 m0, s78, 87808
v_mfma_f32_16x16x32_bf16 a[108:111], v[232:235], v[200:203], a[108:111]
ds_read_b64_tr_b16 v[232:233], v5 offset:52288
ds_read_b64_tr_b16 v[234:235], v5 offset:52800
v_mfma_f32_16x16x32_bf16 a[112:115], v[236:239], v[196:199], a[112:115]
s_add_u32 s62, s62, 128
buffer_load_dwordx4 v4, s[48:51], s62 offen offset:0 nt lds
v_mfma_f32_16x16x32_bf16 a[116:119], v[236:239], v[200:203], a[116:119]
ds_read_b64_tr_b16 v[236:237], v6 offset:52288
ds_read_b64_tr_b16 v[238:239], v6 offset:52800
v_mfma_f32_16x16x32_bf16 a[120:123], v[240:243], v[196:199], a[120:123]
v_mfma_f32_16x16x32_bf16 a[124:127], v[240:243], v[200:203], a[124:127]
s_waitcnt lgkmcnt(6)
ds_read_b64_tr_b16 v[240:241], v5 offset:56576
ds_read_b64_tr_b16 v[242:243], v5 offset:57088
v_mfma_f32_16x16x32_bf16 a[128:131], v[252:255], v[196:199], a[128:131]
ds_read_b64_tr_b16 v[244:245], v6 offset:56576
ds_read_b64_tr_b16 v[246:247], v6 offset:57088
ds_read_b64_tr_b16 v[248:249], v5 offset:56640
ds_read_b64_tr_b16 v[250:251], v5 offset:57152
v_mfma_f32_16x16x32_bf16 a[132:135], v[252:255], v[200:203], a[132:135]
s_waitcnt lgkmcnt(10)
v_mfma_f32_16x16x32_bf16 a[136:139], v[228:231], v[196:199], a[136:139]
ds_read_b64_tr_b16 v[252:253], v6 offset:56640
ds_read_b64_tr_b16 v[254:255], v6 offset:57152
v_mfma_f32_16x16x32_bf16 a[140:143], v[228:231], v[200:203], a[140:143]
s_waitcnt lgkmcnt(10)
v_mfma_f32_16x16x32_bf16 a[144:147], v[232:235], v[196:199], a[144:147]
v_mfma_f32_16x16x32_bf16 a[148:151], v[232:235], v[200:203], a[148:151]
s_waitcnt lgkmcnt(8)
v_mfma_f32_16x16x32_bf16 a[152:155], v[236:239], v[196:199], a[152:155]
v_mfma_f32_16x16x32_bf16 a[156:159], v[236:239], v[200:203], a[156:159]
s_waitcnt vmcnt(4) lgkmcnt(0)
s_barrier
ds_read_b64_tr_b16 v[236:237], v5 offset:34816
ds_read_b64_tr_b16 v[238:239], v5 offset:35328
v_mfma_f32_16x16x32_bf16 a[160:163], v[240:243], v[196:199], a[160:163]
s_add_u32 m0, s78, 118272
s_add_u32 s62, s62, 128
v_mfma_f32_16x16x32_bf16 a[164:167], v[240:243], v[200:203], a[164:167]
ds_read_b64_tr_b16 v[240:241], v6 offset:34816
ds_read_b64_tr_b16 v[242:243], v6 offset:35328
v_mfma_f32_16x16x32_bf16 a[168:171], v[244:247], v[196:199], a[168:171]
buffer_load_dwordx4 v4, s[48:51], s62 offen offset:0 nt lds
s_add_u32 m0, s78, 122624
v_mfma_f32_16x16x32_bf16 a[172:175], v[244:247], v[200:203], a[172:175]
ds_read_b64_tr_b16 v[244:245], v5 offset:34880
ds_read_b64_tr_b16 v[246:247], v5 offset:35392
v_mfma_f32_16x16x32_bf16 a[176:179], v[248:251], v[196:199], a[176:179]
s_add_u32 s62, s62, 128
buffer_load_dwordx4 v4, s[48:51], s62 offen offset:0 nt lds
v_mfma_f32_16x16x32_bf16 a[180:183], v[248:251], v[200:203], a[180:183]
ds_read_b64_tr_b16 v[248:249], v6 offset:34880
ds_read_b64_tr_b16 v[250:251], v6 offset:35392
v_mfma_f32_16x16x32_bf16 a[184:187], v[252:255], v[196:199], a[184:187]
v_mfma_f32_16x16x32_bf16 a[188:191], v[252:255], v[200:203], a[188:191]
s_waitcnt lgkmcnt(6)
ds_read_b64_tr_b16 v[252:253], v5 offset:39168
ds_read_b64_tr_b16 v[254:255], v5 offset:39680
v_mfma_f32_16x16x32_bf16 a[192:195], v[236:239], v[196:199], a[192:195]
ds_read_b64_tr_b16 v[228:229], v6 offset:39168
ds_read_b64_tr_b16 v[230:231], v6 offset:39680
ds_read_b64_tr_b16 v[232:233], v5 offset:39232
ds_read_b64_tr_b16 v[234:235], v5 offset:39744
v_mfma_f32_16x16x32_bf16 a[196:199], v[236:239], v[200:203], a[196:199]
s_waitcnt lgkmcnt(10)
v_mfma_f32_16x16x32_bf16 a[200:203], v[240:243], v[196:199], a[200:203]
ds_read_b64_tr_b16 v[236:237], v6 offset:39232
ds_read_b64_tr_b16 v[238:239], v6 offset:39744
v_mfma_f32_16x16x32_bf16 a[204:207], v[240:243], v[200:203], a[204:207]
s_waitcnt lgkmcnt(10)
v_mfma_f32_16x16x32_bf16 a[208:211], v[244:247], v[196:199], a[208:211]
ds_read_b64_tr_b16 v[240:241], v5 offset:43520
ds_read_b64_tr_b16 v[242:243], v5 offset:44032
v_mfma_f32_16x16x32_bf16 a[212:215], v[244:247], v[200:203], a[212:215]
s_waitcnt lgkmcnt(10)
v_mfma_f32_16x16x32_bf16 a[216:219], v[248:251], v[196:199], a[216:219]
ds_read_b64_tr_b16 v[244:245], v6 offset:43520
ds_read_b64_tr_b16 v[246:247], v6 offset:44032
v_mfma_f32_16x16x32_bf16 a[220:223], v[248:251], v[200:203], a[220:223]
s_waitcnt lgkmcnt(10)
v_mfma_f32_16x16x32_bf16 a[224:227], v[252:255], v[196:199], a[224:227]
ds_read_b64_tr_b16 v[248:249], v5 offset:43584
ds_read_b64_tr_b16 v[250:251], v5 offset:44096
v_mfma_f32_16x16x32_bf16 a[228:231], v[252:255], v[200:203], a[228:231]
s_waitcnt lgkmcnt(10)
v_mfma_f32_16x16x32_bf16 a[232:235], v[228:231], v[196:199], a[232:235]
ds_read_b64_tr_b16 v[252:253], v6 offset:43584
ds_read_b64_tr_b16 v[254:255], v6 offset:44096
v_mfma_f32_16x16x32_bf16 a[236:239], v[228:231], v[200:203], a[236:239]
s_waitcnt lgkmcnt(10)
v_mfma_f32_16x16x32_bf16 a[240:243], v[232:235], v[196:199], a[240:243]
v_mfma_f32_16x16x32_bf16 a[244:247], v[232:235], v[200:203], a[244:247]
s_waitcnt lgkmcnt(8)
v_mfma_f32_16x16x32_bf16 a[248:251], v[236:239], v[196:199], a[248:251]
v_mfma_f32_16x16x32_bf16 a[252:255], v[236:239], v[200:203], a[252:255]
s_waitcnt lgkmcnt(6)
v_mfma_f32_16x16x32_bf16 v[132:135], v[240:243], v[196:199], v[132:135]
v_mfma_f32_16x16x32_bf16 v[136:139], v[240:243], v[200:203], v[136:139]
s_waitcnt lgkmcnt(4)
v_mfma_f32_16x16x32_bf16 v[140:143], v[244:247], v[196:199], v[140:143]
v_mfma_f32_16x16x32_bf16 v[144:147], v[244:247], v[200:203], v[144:147]
s_waitcnt lgkmcnt(2)
v_mfma_f32_16x16x32_bf16 v[148:151], v[248:251], v[196:199], v[148:151]
v_mfma_f32_16x16x32_bf16 v[152:155], v[248:251], v[200:203], v[152:155]
s_waitcnt lgkmcnt(0)
v_mfma_f32_16x16x32_bf16 v[156:159], v[252:255], v[196:199], v[156:159]
v_mfma_f32_16x16x32_bf16 v[160:163], v[252:255], v[200:203], v[160:163]
s_nop 7
v_mbcnt_lo_u32_b32 v15, -1, 0
v_mbcnt_hi_u32_b32 v15, -1, v15
v_lshlrev_b32 v15, 4, v15
s_mul_i32 s74, s56, 36864
v_accvgpr_read_b32 v36, a0
v_accvgpr_read_b32 v37, a1
v_accvgpr_read_b32 v38, a2
v_accvgpr_read_b32 v39, a3
v_accvgpr_read_b32 v40, a8
v_accvgpr_read_b32 v41, a9
v_accvgpr_read_b32 v42, a10
v_accvgpr_read_b32 v43, a11
v_cvt_pk_bf16_f32 v44, v36, v37
v_cvt_pk_bf16_f32 v45, v38, v39
v_cvt_pk_bf16_f32 v46, v40, v41
v_cvt_pk_bf16_f32 v47, v42, v43
buffer_store_dwordx4 v[44:47], v15, s[52:55], s74 offen offset:0
v_accvgpr_read_b32 v52, a16
v_accvgpr_read_b32 v53, a17
v_accvgpr_read_b32 v54, a18
v_accvgpr_read_b32 v55, a19
v_accvgpr_read_b32 v56, a24
v_accvgpr_read_b32 v57, a25
v_accvgpr_read_b32 v58, a26
v_accvgpr_read_b32 v59, a27
v_cvt_pk_bf16_f32 v60, v52, v53
v_cvt_pk_bf16_f32 v61, v54, v55
v_cvt_pk_bf16_f32 v62, v56, v57
v_cvt_pk_bf16_f32 v63, v58, v59
buffer_store_dwordx4 v[60:63], v15, s[52:55], s74 offen offset:1024
v_accvgpr_read_b32 v36, a32
v_accvgpr_read_b32 v37, a33
v_accvgpr_read_b32 v38, a34
v_accvgpr_read_b32 v39, a35
v_accvgpr_read_b32 v40, a40
v_accvgpr_read_b32 v41, a41
v_accvgpr_read_b32 v42, a42
v_accvgpr_read_b32 v43, a43
v_cvt_pk_bf16_f32 v44, v36, v37
v_cvt_pk_bf16_f32 v45, v38, v39
v_cvt_pk_bf16_f32 v46, v40, v41
v_cvt_pk_bf16_f32 v47, v42, v43
buffer_store_dwordx4 v[44:47], v15, s[52:55], s74 offen offset:2048
v_accvgpr_read_b32 v52, a48
v_accvgpr_read_b32 v53, a49
v_accvgpr_read_b32 v54, a50
v_accvgpr_read_b32 v55, a51
v_accvgpr_read_b32 v56, a56
v_accvgpr_read_b32 v57, a57
v_accvgpr_read_b32 v58, a58
v_accvgpr_read_b32 v59, a59
v_cvt_pk_bf16_f32 v60, v52, v53
v_cvt_pk_bf16_f32 v61, v54, v55
v_cvt_pk_bf16_f32 v62, v56, v57
v_cvt_pk_bf16_f32 v63, v58, v59
buffer_store_dwordx4 v[60:63], v15, s[52:55], s74 offen offset:3072
v_accvgpr_read_b32 v36, a64
v_accvgpr_read_b32 v37, a65
v_accvgpr_read_b32 v38, a66
v_accvgpr_read_b32 v39, a67
v_accvgpr_read_b32 v40, a72
v_accvgpr_read_b32 v41, a73
v_accvgpr_read_b32 v42, a74
v_accvgpr_read_b32 v43, a75
v_cvt_pk_bf16_f32 v44, v36, v37
v_cvt_pk_bf16_f32 v45, v38, v39
v_cvt_pk_bf16_f32 v46, v40, v41
v_cvt_pk_bf16_f32 v47, v42, v43
s_add_u32 s74, s74, 4096
buffer_store_dwordx4 v[44:47], v15, s[52:55], s74 offen offset:0
v_accvgpr_read_b32 v52, a80
v_accvgpr_read_b32 v53, a81
v_accvgpr_read_b32 v54, a82
v_accvgpr_read_b32 v55, a83
v_accvgpr_read_b32 v56, a88
v_accvgpr_read_b32 v57, a89
v_accvgpr_read_b32 v58, a90
v_accvgpr_read_b32 v59, a91
v_cvt_pk_bf16_f32 v60, v52, v53
v_cvt_pk_bf16_f32 v61, v54, v55
v_cvt_pk_bf16_f32 v62, v56, v57
v_cvt_pk_bf16_f32 v63, v58, v59
buffer_store_dwordx4 v[60:63], v15, s[52:55], s74 offen offset:1024
v_accvgpr_read_b32 v36, a96
v_accvgpr_read_b32 v37, a97
v_accvgpr_read_b32 v38, a98
v_accvgpr_read_b32 v39, a99
v_accvgpr_read_b32 v40, a104
v_accvgpr_read_b32 v41, a105
v_accvgpr_read_b32 v42, a106
v_accvgpr_read_b32 v43, a107
v_cvt_pk_bf16_f32 v44, v36, v37
v_cvt_pk_bf16_f32 v45, v38, v39
v_cvt_pk_bf16_f32 v46, v40, v41
v_cvt_pk_bf16_f32 v47, v42, v43
buffer_store_dwordx4 v[44:47], v15, s[52:55], s74 offen offset:2048
v_accvgpr_read_b32 v52, a112
v_accvgpr_read_b32 v53, a113
v_accvgpr_read_b32 v54, a114
v_accvgpr_read_b32 v55, a115
v_accvgpr_read_b32 v56, a120
v_accvgpr_read_b32 v57, a121
v_accvgpr_read_b32 v58, a122
v_accvgpr_read_b32 v59, a123
v_cvt_pk_bf16_f32 v60, v52, v53
v_cvt_pk_bf16_f32 v61, v54, v55
v_cvt_pk_bf16_f32 v62, v56, v57
v_cvt_pk_bf16_f32 v63, v58, v59
buffer_store_dwordx4 v[60:63], v15, s[52:55], s74 offen offset:3072
v_accvgpr_read_b32 v36, a128
v_accvgpr_read_b32 v37, a129
v_accvgpr_read_b32 v38, a130
v_accvgpr_read_b32 v39, a131
v_accvgpr_read_b32 v40, a136
v_accvgpr_read_b32 v41, a137
v_accvgpr_read_b32 v42, a138
v_accvgpr_read_b32 v43, a139
v_cvt_pk_bf16_f32 v44, v36, v37
v_cvt_pk_bf16_f32 v45, v38, v39
v_cvt_pk_bf16_f32 v46, v40, v41
v_cvt_pk_bf16_f32 v47, v42, v43
s_add_u32 s74, s74, 4096
buffer_store_dwordx4 v[44:47], v15, s[52:55], s74 offen offset:0
v_accvgpr_read_b32 v52, a144
v_accvgpr_read_b32 v53, a145
v_accvgpr_read_b32 v54, a146
v_accvgpr_read_b32 v55, a147
v_accvgpr_read_b32 v56, a152
v_accvgpr_read_b32 v57, a153
v_accvgpr_read_b32 v58, a154
v_accvgpr_read_b32 v59, a155
v_cvt_pk_bf16_f32 v60, v52, v53
v_cvt_pk_bf16_f32 v61, v54, v55
v_cvt_pk_bf16_f32 v62, v56, v57
v_cvt_pk_bf16_f32 v63, v58, v59
buffer_store_dwordx4 v[60:63], v15, s[52:55], s74 offen offset:1024
v_accvgpr_read_b32 v36, a160
v_accvgpr_read_b32 v37, a161
v_accvgpr_read_b32 v38, a162
v_accvgpr_read_b32 v39, a163
v_accvgpr_read_b32 v40, a168
v_accvgpr_read_b32 v41, a169
v_accvgpr_read_b32 v42, a170
v_accvgpr_read_b32 v43, a171
v_cvt_pk_bf16_f32 v44, v36, v37
v_cvt_pk_bf16_f32 v45, v38, v39
v_cvt_pk_bf16_f32 v46, v40, v41
v_cvt_pk_bf16_f32 v47, v42, v43
buffer_store_dwordx4 v[44:47], v15, s[52:55], s74 offen offset:2048
v_accvgpr_read_b32 v52, a176
v_accvgpr_read_b32 v53, a177
v_accvgpr_read_b32 v54, a178
v_accvgpr_read_b32 v55, a179
v_accvgpr_read_b32 v56, a184
v_accvgpr_read_b32 v57, a185
v_accvgpr_read_b32 v58, a186
v_accvgpr_read_b32 v59, a187
v_cvt_pk_bf16_f32 v60, v52, v53
v_cvt_pk_bf16_f32 v61, v54, v55
v_cvt_pk_bf16_f32 v62, v56, v57
v_cvt_pk_bf16_f32 v63, v58, v59
buffer_store_dwordx4 v[60:63], v15, s[52:55], s74 offen offset:3072
v_accvgpr_read_b32 v36, a192
v_accvgpr_read_b32 v37, a193
v_accvgpr_read_b32 v38, a194
v_accvgpr_read_b32 v39, a195
v_accvgpr_read_b32 v40, a200
v_accvgpr_read_b32 v41, a201
v_accvgpr_read_b32 v42, a202
v_accvgpr_read_b32 v43, a203
v_cvt_pk_bf16_f32 v44, v36, v37
v_cvt_pk_bf16_f32 v45, v38, v39
v_cvt_pk_bf16_f32 v46, v40, v41
v_cvt_pk_bf16_f32 v47, v42, v43
s_add_u32 s74, s74, 4096
buffer_store_dwordx4 v[44:47], v15, s[52:55], s74 offen offset:0
v_accvgpr_read_b32 v52, a208
v_accvgpr_read_b32 v53, a209
v_accvgpr_read_b32 v54, a210
v_accvgpr_read_b32 v55, a211
v_accvgpr_read_b32 v56, a216
v_accvgpr_read_b32 v57, a217
v_accvgpr_read_b32 v58, a218
v_accvgpr_read_b32 v59, a219
v_cvt_pk_bf16_f32 v60, v52, v53
v_cvt_pk_bf16_f32 v61, v54, v55
v_cvt_pk_bf16_f32 v62, v56, v57
v_cvt_pk_bf16_f32 v63, v58, v59
buffer_store_dwordx4 v[60:63], v15, s[52:55], s74 offen offset:1024
v_accvgpr_read_b32 v36, a224
v_accvgpr_read_b32 v37, a225
v_accvgpr_read_b32 v38, a226
v_accvgpr_read_b32 v39, a227
v_accvgpr_read_b32 v40, a232
v_accvgpr_read_b32 v41, a233
v_accvgpr_read_b32 v42, a234
v_accvgpr_read_b32 v43, a235
v_cvt_pk_bf16_f32 v44, v36, v37
v_cvt_pk_bf16_f32 v45, v38, v39
v_cvt_pk_bf16_f32 v46, v40, v41
v_cvt_pk_bf16_f32 v47, v42, v43
buffer_store_dwordx4 v[44:47], v15, s[52:55], s74 offen offset:2048
v_accvgpr_read_b32 v52, a240
v_accvgpr_read_b32 v53, a241
v_accvgpr_read_b32 v54, a242
v_accvgpr_read_b32 v55, a243
v_accvgpr_read_b32 v56, a248
v_accvgpr_read_b32 v57, a249
v_accvgpr_read_b32 v58, a250
v_accvgpr_read_b32 v59, a251
v_cvt_pk_bf16_f32 v60, v52, v53
v_cvt_pk_bf16_f32 v61, v54, v55
v_cvt_pk_bf16_f32 v62, v56, v57
v_cvt_pk_bf16_f32 v63, v58, v59
buffer_store_dwordx4 v[60:63], v15, s[52:55], s74 offen offset:3072
v_cvt_pk_bf16_f32 v44, v132, v133
v_cvt_pk_bf16_f32 v45, v134, v135
v_cvt_pk_bf16_f32 v46, v140, v141
v_cvt_pk_bf16_f32 v47, v142, v143
s_add_u32 s74, s74, 4096
buffer_store_dwordx4 v[44:47], v15, s[52:55], s74 offen offset:0
v_cvt_pk_bf16_f32 v60, v148, v149
v_cvt_pk_bf16_f32 v61, v150, v151
v_cvt_pk_bf16_f32 v62, v156, v157
v_cvt_pk_bf16_f32 v63, v158, v159
buffer_store_dwordx4 v[60:63], v15, s[52:55], s74 offen offset:1024
v_accvgpr_read_b32 v36, a4
v_accvgpr_read_b32 v37, a5
v_accvgpr_read_b32 v38, a6
v_accvgpr_read_b32 v39, a7
v_accvgpr_read_b32 v40, a12
v_accvgpr_read_b32 v41, a13
v_accvgpr_read_b32 v42, a14
v_accvgpr_read_b32 v43, a15
v_cvt_pk_bf16_f32 v44, v36, v37
v_cvt_pk_bf16_f32 v45, v38, v39
v_cvt_pk_bf16_f32 v46, v40, v41
v_cvt_pk_bf16_f32 v47, v42, v43
buffer_store_dwordx4 v[44:47], v15, s[52:55], s74 offen offset:2048
v_accvgpr_read_b32 v52, a20
v_accvgpr_read_b32 v53, a21
v_accvgpr_read_b32 v54, a22
v_accvgpr_read_b32 v55, a23
v_accvgpr_read_b32 v56, a28
v_accvgpr_read_b32 v57, a29
v_accvgpr_read_b32 v58, a30
v_accvgpr_read_b32 v59, a31
v_cvt_pk_bf16_f32 v60, v52, v53
v_cvt_pk_bf16_f32 v61, v54, v55
v_cvt_pk_bf16_f32 v62, v56, v57
v_cvt_pk_bf16_f32 v63, v58, v59
buffer_store_dwordx4 v[60:63], v15, s[52:55], s74 offen offset:3072
v_accvgpr_read_b32 v36, a36
v_accvgpr_read_b32 v37, a37
v_accvgpr_read_b32 v38, a38
v_accvgpr_read_b32 v39, a39
v_accvgpr_read_b32 v40, a44
v_accvgpr_read_b32 v41, a45
v_accvgpr_read_b32 v42, a46
v_accvgpr_read_b32 v43, a47
v_cvt_pk_bf16_f32 v44, v36, v37
v_cvt_pk_bf16_f32 v45, v38, v39
v_cvt_pk_bf16_f32 v46, v40, v41
v_cvt_pk_bf16_f32 v47, v42, v43
s_add_u32 s74, s74, 4096
buffer_store_dwordx4 v[44:47], v15, s[52:55], s74 offen offset:0
v_accvgpr_read_b32 v52, a52
v_accvgpr_read_b32 v53, a53
v_accvgpr_read_b32 v54, a54
v_accvgpr_read_b32 v55, a55
v_accvgpr_read_b32 v56, a60
v_accvgpr_read_b32 v57, a61
v_accvgpr_read_b32 v58, a62
v_accvgpr_read_b32 v59, a63
v_cvt_pk_bf16_f32 v60, v52, v53
v_cvt_pk_bf16_f32 v61, v54, v55
v_cvt_pk_bf16_f32 v62, v56, v57
v_cvt_pk_bf16_f32 v63, v58, v59
buffer_store_dwordx4 v[60:63], v15, s[52:55], s74 offen offset:1024
v_accvgpr_read_b32 v36, a68
v_accvgpr_read_b32 v37, a69
v_accvgpr_read_b32 v38, a70
v_accvgpr_read_b32 v39, a71
v_accvgpr_read_b32 v40, a76
v_accvgpr_read_b32 v41, a77
v_accvgpr_read_b32 v42, a78
v_accvgpr_read_b32 v43, a79
v_cvt_pk_bf16_f32 v44, v36, v37
v_cvt_pk_bf16_f32 v45, v38, v39
v_cvt_pk_bf16_f32 v46, v40, v41
v_cvt_pk_bf16_f32 v47, v42, v43
buffer_store_dwordx4 v[44:47], v15, s[52:55], s74 offen offset:2048
v_accvgpr_read_b32 v52, a84
v_accvgpr_read_b32 v53, a85
v_accvgpr_read_b32 v54, a86
v_accvgpr_read_b32 v55, a87
v_accvgpr_read_b32 v56, a92
v_accvgpr_read_b32 v57, a93
v_accvgpr_read_b32 v58, a94
v_accvgpr_read_b32 v59, a95
v_cvt_pk_bf16_f32 v60, v52, v53
v_cvt_pk_bf16_f32 v61, v54, v55
v_cvt_pk_bf16_f32 v62, v56, v57
v_cvt_pk_bf16_f32 v63, v58, v59
buffer_store_dwordx4 v[60:63], v15, s[52:55], s74 offen offset:3072
v_accvgpr_read_b32 v36, a100
v_accvgpr_read_b32 v37, a101
v_accvgpr_read_b32 v38, a102
v_accvgpr_read_b32 v39, a103
v_accvgpr_read_b32 v40, a108
v_accvgpr_read_b32 v41, a109
v_accvgpr_read_b32 v42, a110
v_accvgpr_read_b32 v43, a111
v_cvt_pk_bf16_f32 v44, v36, v37
v_cvt_pk_bf16_f32 v45, v38, v39
v_cvt_pk_bf16_f32 v46, v40, v41
v_cvt_pk_bf16_f32 v47, v42, v43
s_add_u32 s74, s74, 4096
buffer_store_dwordx4 v[44:47], v15, s[52:55], s74 offen offset:0
v_accvgpr_read_b32 v52, a116
v_accvgpr_read_b32 v53, a117
v_accvgpr_read_b32 v54, a118
v_accvgpr_read_b32 v55, a119
v_accvgpr_read_b32 v56, a124
v_accvgpr_read_b32 v57, a125
v_accvgpr_read_b32 v58, a126
v_accvgpr_read_b32 v59, a127
v_cvt_pk_bf16_f32 v60, v52, v53
v_cvt_pk_bf16_f32 v61, v54, v55
v_cvt_pk_bf16_f32 v62, v56, v57
v_cvt_pk_bf16_f32 v63, v58, v59
buffer_store_dwordx4 v[60:63], v15, s[52:55], s74 offen offset:1024
v_accvgpr_read_b32 v36, a132
v_accvgpr_read_b32 v37, a133
v_accvgpr_read_b32 v38, a134
v_accvgpr_read_b32 v39, a135
v_accvgpr_read_b32 v40, a140
v_accvgpr_read_b32 v41, a141
v_accvgpr_read_b32 v42, a142
v_accvgpr_read_b32 v43, a143
v_cvt_pk_bf16_f32 v44, v36, v37
v_cvt_pk_bf16_f32 v45, v38, v39
v_cvt_pk_bf16_f32 v46, v40, v41
v_cvt_pk_bf16_f32 v47, v42, v43
buffer_store_dwordx4 v[44:47], v15, s[52:55], s74 offen offset:2048
v_accvgpr_read_b32 v52, a148
v_accvgpr_read_b32 v53, a149
v_accvgpr_read_b32 v54, a150
v_accvgpr_read_b32 v55, a151
v_accvgpr_read_b32 v56, a156
v_accvgpr_read_b32 v57, a157
v_accvgpr_read_b32 v58, a158
v_accvgpr_read_b32 v59, a159
v_cvt_pk_bf16_f32 v60, v52, v53
v_cvt_pk_bf16_f32 v61, v54, v55
v_cvt_pk_bf16_f32 v62, v56, v57
v_cvt_pk_bf16_f32 v63, v58, v59
buffer_store_dwordx4 v[60:63], v15, s[52:55], s74 offen offset:3072
v_accvgpr_read_b32 v36, a164
v_accvgpr_read_b32 v37, a165
v_accvgpr_read_b32 v38, a166
v_accvgpr_read_b32 v39, a167
v_accvgpr_read_b32 v40, a172
v_accvgpr_read_b32 v41, a173
v_accvgpr_read_b32 v42, a174
v_accvgpr_read_b32 v43, a175
v_cvt_pk_bf16_f32 v44, v36, v37
v_cvt_pk_bf16_f32 v45, v38, v39
v_cvt_pk_bf16_f32 v46, v40, v41
v_cvt_pk_bf16_f32 v47, v42, v43
s_add_u32 s74, s74, 4096
buffer_store_dwordx4 v[44:47], v15, s[52:55], s74 offen offset:0
v_accvgpr_read_b32 v52, a180
v_accvgpr_read_b32 v53, a181
v_accvgpr_read_b32 v54, a182
v_accvgpr_read_b32 v55, a183
v_accvgpr_read_b32 v56, a188
v_accvgpr_read_b32 v57, a189
v_accvgpr_read_b32 v58, a190
v_accvgpr_read_b32 v59, a191
v_cvt_pk_bf16_f32 v60, v52, v53
v_cvt_pk_bf16_f32 v61, v54, v55
v_cvt_pk_bf16_f32 v62, v56, v57
v_cvt_pk_bf16_f32 v63, v58, v59
buffer_store_dwordx4 v[60:63], v15, s[52:55], s74 offen offset:1024
v_accvgpr_read_b32 v36, a196
v_accvgpr_read_b32 v37, a197
v_accvgpr_read_b32 v38, a198
v_accvgpr_read_b32 v39, a199
v_accvgpr_read_b32 v40, a204
v_accvgpr_read_b32 v41, a205
v_accvgpr_read_b32 v42, a206
v_accvgpr_read_b32 v43, a207
v_cvt_pk_bf16_f32 v44, v36, v37
v_cvt_pk_bf16_f32 v45, v38, v39
v_cvt_pk_bf16_f32 v46, v40, v41
v_cvt_pk_bf16_f32 v47, v42, v43
buffer_store_dwordx4 v[44:47], v15, s[52:55], s74 offen offset:2048
v_accvgpr_read_b32 v52, a212
v_accvgpr_read_b32 v53, a213
v_accvgpr_read_b32 v54, a214
v_accvgpr_read_b32 v55, a215
v_accvgpr_read_b32 v56, a220
v_accvgpr_read_b32 v57, a221
v_accvgpr_read_b32 v58, a222
v_accvgpr_read_b32 v59, a223
v_cvt_pk_bf16_f32 v60, v52, v53
v_cvt_pk_bf16_f32 v61, v54, v55
v_cvt_pk_bf16_f32 v62, v56, v57
v_cvt_pk_bf16_f32 v63, v58, v59
buffer_store_dwordx4 v[60:63], v15, s[52:55], s74 offen offset:3072
v_accvgpr_read_b32 v36, a228
v_accvgpr_read_b32 v37, a229
v_accvgpr_read_b32 v38, a230
v_accvgpr_read_b32 v39, a231
v_accvgpr_read_b32 v40, a236
v_accvgpr_read_b32 v41, a237
v_accvgpr_read_b32 v42, a238
v_accvgpr_read_b32 v43, a239
v_cvt_pk_bf16_f32 v44, v36, v37
v_cvt_pk_bf16_f32 v45, v38, v39
v_cvt_pk_bf16_f32 v46, v40, v41
v_cvt_pk_bf16_f32 v47, v42, v43
s_add_u32 s74, s74, 4096
buffer_store_dwordx4 v[44:47], v15, s[52:55], s74 offen offset:0
v_accvgpr_read_b32 v52, a244
v_accvgpr_read_b32 v53, a245
v_accvgpr_read_b32 v54, a246
v_accvgpr_read_b32 v55, a247
v_accvgpr_read_b32 v56, a252
v_accvgpr_read_b32 v57, a253
v_accvgpr_read_b32 v58, a254
v_accvgpr_read_b32 v59, a255
v_cvt_pk_bf16_f32 v60, v52, v53
v_cvt_pk_bf16_f32 v61, v54, v55
v_cvt_pk_bf16_f32 v62, v56, v57
v_cvt_pk_bf16_f32 v63, v58, v59
buffer_store_dwordx4 v[60:63], v15, s[52:55], s74 offen offset:1024
v_cvt_pk_bf16_f32 v44, v136, v137
v_cvt_pk_bf16_f32 v45, v138, v139
v_cvt_pk_bf16_f32 v46, v144, v145
v_cvt_pk_bf16_f32 v47, v146, v147
buffer_store_dwordx4 v[44:47], v15, s[52:55], s74 offen offset:2048
v_cvt_pk_bf16_f32 v60, v152, v153
v_cvt_pk_bf16_f32 v61, v154, v155
v_cvt_pk_bf16_f32 v62, v160, v161
v_cvt_pk_bf16_f32 v63, v162, v163
buffer_store_dwordx4 v[60:63], v15, s[52:55], s74 offen offset:3072
s_waitcnt vmcnt(0)
s_endpgm
L_tr_CB1:
s_getpc_b64 s[90:91]
L_pc_CB1:
s_add_u32 s90, s90, L_back_CB1-L_pc_CB1
s_addc_u32 s91, s91, -1
s_branch L_slow_C1
L_tr_CB2:
s_getpc_b64 s[90:91]
L_pc_CB2:
s_add_u32 s90, s90, L_back_CB2-L_pc_CB2
s_addc_u32 s91, s91, -1
s_branch L_slow_C0
L_tr_CB3:
s_getpc_b64 s[90:91]
L_pc_CB3:
s_add_u32 s90, s90, L_back_CB3-L_pc_CB3
s_addc_u32 s91, s91, -1
s_branch L_slow_C1
L_tr_CB4:
s_getpc_b64 s[90:91]
L_pc_CB4:
s_add_u32 s90, s90, L_back_CB4-L_pc_CB4
s_addc_u32 s91, s91, -1
s_branch L_slow_C0
L_tr_CB5:
s_getpc_b64 s[90:91]
L_pc_CB5:
s_add_u32 s90, s90, L_back_CB5-L_pc_CB5
s_addc_u32 s91, s91, -1
s_branch L_slow_C1
L_tr_CB14:
s_getpc_b64 s[90:91]
L_pc_CB14:
s_add_u32 s90, s90, L_back_CB14-L_pc_CB14
s_addc_u32 s91, s91, -1
s_branch L_slow_C0
L_tr_CB15:
s_getpc_b64 s[90:91]
L_pc_CB15:
s_add_u32 s90, s90, L_back_CB15-L_pc_CB15
s_addc_u32 s91, s91, -1
s_branch L_slow_C1
L_slow_C0:
s_nop 7
s_nop 7
v_max3_f32 v15, v36, v37, v38
v_max3_f32 v16, v39, v40, v41
v_max3_f32 v15, v15, v42, v43
v_max_f32 v15, v15, v16
v_mov_b32 v16, v15
s_nop 1
v_permlane32_swap_b32 v15, v16
v_max_f32 v15, v15, v16
v_mov_b32 v16, v15
s_nop 1
v_permlane16_swap_b32 v15, v16
v_max_f32 v15, v15, v16
v_max_f32 v15, 0, v15
v_sub_f32 v16, 0, v15
v_exp_f32 v16, v16
v_sub_f32 v20, v20, v15
v_sub_f32 v21, v21, v15
v_sub_f32 v22, v22, v15
v_sub_f32 v23, v23, v15
v_mul_f32 v11, v11, v16
v_mul_f32 v68, v68, v16
v_mul_f32 v69, v69, v16
v_mul_f32 v70, v70, v16
v_mul_f32 v71, v71, v16
v_mul_f32 v76, v76, v16
v_mul_f32 v77, v77, v16
v_mul_f32 v78, v78, v16
v_mul_f32 v79, v79, v16
v_mul_f32 v84, v84, v16
v_mul_f32 v85, v85, v16
v_mul_f32 v86, v86, v16
v_mul_f32 v87, v87, v16
v_mul_f32 v92, v92, v16
v_mul_f32 v93, v93, v16
v_mul_f32 v94, v94, v16
v_mul_f32 v95, v95, v16
v_mul_f32 v100, v100, v16
v_mul_f32 v101, v101, v16
v_mul_f32 v102, v102, v16
v_mul_f32 v103, v103, v16
v_mul_f32 v108, v108, v16
v_mul_f32 v109, v109, v16
v_mul_f32 v110, v110, v16
v_mul_f32 v111, v111, v16
v_mul_f32 v116, v116, v16
v_mul_f32 v117, v117, v16
v_mul_f32 v118, v118, v16
v_mul_f32 v119, v119, v16
v_mul_f32 v124, v124, v16
v_mul_f32 v125, v125, v16
v_mul_f32 v126, v126, v16
v_mul_f32 v127, v127, v16
v_sub_f32 v36, v36, v15
v_sub_f32 v52, v52, v15
v_sub_f32 v37, v37, v15
v_sub_f32 v53, v53, v15
v_sub_f32 v38, v38, v15
v_sub_f32 v54, v54, v15
v_sub_f32 v39, v39, v15
v_sub_f32 v55, v55, v15
v_sub_f32 v40, v40, v15
v_sub_f32 v56, v56, v15
v_sub_f32 v41, v41, v15
v_sub_f32 v57, v57, v15
v_sub_f32 v42, v42, v15
v_sub_f32 v58, v58, v15
v_sub_f32 v43, v43, v15
v_sub_f32 v59, v59, v15
v_max3_f32 v15, v44, v45, v46
v_max3_f32 v16, v47, v48, v49
v_max3_f32 v15, v15, v50, v51
v_max_f32 v15, v15, v16
v_mov_b32 v16, v15
s_nop 1
v_permlane32_swap_b32 v15, v16
v_max_f32 v15, v15, v16
v_mov_b32 v16, v15
s_nop 1
v_permlane16_swap_b32 v15, v16
v_max_f32 v15, v15, v16
v_max_f32 v15, 0, v15
v_sub_f32 v16, 0, v15
v_exp_f32 v16, v16
v_sub_f32 v24, v24, v15
v_sub_f32 v25, v25, v15
v_sub_f32 v26, v26, v15
v_sub_f32 v27, v27, v15
v_mul_f32 v12, v12, v16
v_mul_f32 v72, v72, v16
v_mul_f32 v73, v73, v16
v_mul_f32 v74, v74, v16
v_mul_f32 v75, v75, v16
v_mul_f32 v80, v80, v16
v_mul_f32 v81, v81, v16
v_mul_f32 v82, v82, v16
v_mul_f32 v83, v83, v16
v_mul_f32 v88, v88, v16
v_mul_f32 v89, v89, v16
v_mul_f32 v90, v90, v16
v_mul_f32 v91, v91, v16
v_mul_f32 v96, v96, v16
v_mul_f32 v97, v97, v16
v_mul_f32 v98, v98, v16
v_mul_f32 v99, v99, v16
v_mul_f32 v104, v104, v16
v_mul_f32 v105, v105, v16
v_mul_f32 v106, v106, v16
v_mul_f32 v107, v107, v16
v_mul_f32 v112, v112, v16
v_mul_f32 v113, v113, v16
v_mul_f32 v114, v114, v16
v_mul_f32 v115, v115, v16
v_mul_f32 v120, v120, v16
v_mul_f32 v121, v121, v16
v_mul_f32 v122, v122, v16
v_mul_f32 v123, v123, v16
v_mul_f32 v128, v128, v16
v_mul_f32 v129, v129, v16
v_mul_f32 v130, v130, v16
v_mul_f32 v131, v131, v16
v_sub_f32 v44, v44, v15
v_sub_f32 v60, v60, v15
v_sub_f32 v45, v45, v15
v_sub_f32 v61, v61, v15
v_sub_f32 v46, v46, v15
v_sub_f32 v62, v62, v15
v_sub_f32 v47, v47, v15
v_sub_f32 v63, v63, v15
v_sub_f32 v48, v48, v15
v_sub_f32 v64, v64, v15
v_sub_f32 v49, v49, v15
v_sub_f32 v65, v65, v15
v_sub_f32 v50, v50, v15
v_sub_f32 v66, v66, v15
v_sub_f32 v51, v51, v15
v_sub_f32 v67, v67, v15
v_exp_f32 v16, v36
v_exp_f32 v17, v37
v_mov_b32 v13, v16
v_add_f32 v13, v13, v17
v_cvt_pk_bf16_f32 v28, v16, v17
v_exp_f32 v18, v38
v_exp_f32 v19, v39
v_add_f32 v13, v13, v18
v_add_f32 v13, v13, v19
v_cvt_pk_bf16_f32 v29, v18, v19
v_exp_f32 v16, v40
v_exp_f32 v17, v41
v_add_f32 v13, v13, v16
v_add_f32 v13, v13, v17
v_cvt_pk_bf16_f32 v30, v16, v17
v_exp_f32 v18, v42
v_exp_f32 v19, v43
v_add_f32 v13, v13, v18
v_add_f32 v13, v13, v19
v_cvt_pk_bf16_f32 v31, v18, v19
v_exp_f32 v16, v44
v_exp_f32 v17, v45
v_mov_b32 v14, v16
v_add_f32 v14, v14, v17
v_cvt_pk_bf16_f32 v32, v16, v17
v_exp_f32 v18, v46
v_exp_f32 v19, v47
v_add_f32 v14, v14, v18
v_add_f32 v14, v14, v19
v_cvt_pk_bf16_f32 v33, v18, v19
v_exp_f32 v16, v48
v_exp_f32 v17, v49
v_add_f32 v14, v14, v16
v_add_f32 v14, v14, v17
v_cvt_pk_bf16_f32 v34, v16, v17
v_exp_f32 v18, v50
v_exp_f32 v19, v51
v_add_f32 v14, v14, v18
v_add_f32 v14, v14, v19
v_cvt_pk_bf16_f32 v35, v18, v19
s_nop 1
s_setpc_b64 s[90:91]
L_slow_C1:
s_nop 7
s_nop 7
v_max3_f32 v15, v52, v53, v54
v_max3_f32 v16, v55, v56, v57
v_max3_f32 v15, v15, v58, v59
v_max_f32 v15, v15, v16
v_mov_b32 v16, v15
s_nop 1
v_permlane32_swap_b32 v15, v16
v_max_f32 v15, v15, v16
v_mov_b32 v16, v15
s_nop 1
v_permlane16_swap_b32 v15, v16
v_max_f32 v15, v15, v16
v_max_f32 v15, 0, v15
v_sub_f32 v16, 0, v15
v_exp_f32 v16, v16
v_sub_f32 v20, v20, v15
v_sub_f32 v21, v21, v15
v_sub_f32 v22, v22, v15
v_sub_f32 v23, v23, v15
v_mul_f32 v11, v11, v16
v_mul_f32 v68, v68, v16
v_mul_f32 v69, v69, v16
v_mul_f32 v70, v70, v16
v_mul_f32 v71, v71, v16
v_mul_f32 v76, v76, v16
v_mul_f32 v77, v77, v16
v_mul_f32 v78, v78, v16
v_mul_f32 v79, v79, v16
v_mul_f32 v84, v84, v16
v_mul_f32 v85, v85, v16
v_mul_f32 v86, v86, v16
v_mul_f32 v87, v87, v16
v_mul_f32 v92, v92, v16
v_mul_f32 v93, v93, v16
v_mul_f32 v94, v94, v16
v_mul_f32 v95, v95, v16
v_mul_f32 v100, v100, v16
v_mul_f32 v101, v101, v16
v_mul_f32 v102, v102, v16
v_mul_f32 v103, v103, v16
v_mul_f32 v108, v108, v16
v_mul_f32 v109, v109, v16
v_mul_f32 v110, v110, v16
v_mul_f32 v111, v111, v16
v_mul_f32 v116, v116, v16
v_mul_f32 v117, v117, v16
v_mul_f32 v118, v118, v16
v_mul_f32 v119, v119, v16
v_mul_f32 v124, v124, v16
v_mul_f32 v125, v125, v16
v_mul_f32 v126, v126, v16
v_mul_f32 v127, v127, v16
v_sub_f32 v52, v52, v15
v_sub_f32 v36, v36, v15
v_sub_f32 v53, v53, v15
v_sub_f32 v37, v37, v15
v_sub_f32 v54, v54, v15
v_sub_f32 v38, v38, v15
v_sub_f32 v55, v55, v15
v_sub_f32 v39, v39, v15
v_sub_f32 v56, v56, v15
v_sub_f32 v40, v40, v15
v_sub_f32 v57, v57, v15
v_sub_f32 v41, v41, v15
v_sub_f32 v58, v58, v15
v_sub_f32 v42, v42, v15
v_sub_f32 v59, v59, v15
v_sub_f32 v43, v43, v15
v_max3_f32 v15, v60, v61, v62
v_max3_f32 v16, v63, v64, v65
v_max3_f32 v15, v15, v66, v67
v_max_f32 v15, v15, v16
v_mov_b32 v16, v15
s_nop 1
v_permlane32_swap_b32 v15, v16
v_max_f32 v15, v15, v16
v_mov_b32 v16, v15
s_nop 1
v_permlane16_swap_b32 v15, v16
v_max_f32 v15, v15, v16
v_max_f32 v15, 0, v15
v_sub_f32 v16, 0, v15
v_exp_f32 v16, v16
v_sub_f32 v24, v24, v15
v_sub_f32 v25, v25, v15
v_sub_f32 v26, v26, v15
v_sub_f32 v27, v27, v15
v_mul_f32 v12, v12, v16
v_mul_f32 v72, v72, v16
v_mul_f32 v73, v73, v16
v_mul_f32 v74, v74, v16
v_mul_f32 v75, v75, v16
v_mul_f32 v80, v80, v16
v_mul_f32 v81, v81, v16
v_mul_f32 v82, v82, v16
v_mul_f32 v83, v83, v16
v_mul_f32 v88, v88, v16
v_mul_f32 v89, v89, v16
v_mul_f32 v90, v90, v16
v_mul_f32 v91, v91, v16
v_mul_f32 v96, v96, v16
v_mul_f32 v97, v97, v16
v_mul_f32 v98, v98, v16
v_mul_f32 v99, v99, v16
v_mul_f32 v104, v104, v16
v_mul_f32 v105, v105, v16
v_mul_f32 v106, v106, v16
v_mul_f32 v107, v107, v16
v_mul_f32 v112, v112, v16
v_mul_f32 v113, v113, v16
v_mul_f32 v114, v114, v16
v_mul_f32 v115, v115, v16
v_mul_f32 v120, v120, v16
v_mul_f32 v121, v121, v16
v_mul_f32 v122, v122, v16
v_mul_f32 v123, v123, v16
v_mul_f32 v128, v128, v16
v_mul_f32 v129, v129, v16
v_mul_f32 v130, v130, v16
v_mul_f32 v131, v131, v16
v_sub_f32 v60, v60, v15
v_sub_f32 v44, v44, v15
v_sub_f32 v61, v61, v15
v_sub_f32 v45, v45, v15
v_sub_f32 v62, v62, v15
v_sub_f32 v46, v46, v15
v_sub_f32 v63, v63, v15
v_sub_f32 v47, v47, v15
v_sub_f32 v64, v64, v15
v_sub_f32 v48, v48, v15
v_sub_f32 v65, v65, v15
v_sub_f32 v49, v49, v15
v_sub_f32 v66, v66, v15
v_sub_f32 v50, v50, v15
v_sub_f32 v67, v67, v15
v_sub_f32 v51, v51, v15
v_exp_f32 v16, v52
v_exp_f32 v17, v53
v_mov_b32 v13, v16
v_add_f32 v13, v13, v17
v_cvt_pk_bf16_f32 v28, v16, v17
v_exp_f32 v18, v54
v_exp_f32 v19, v55
v_add_f32 v13, v13, v18
v_add_f32 v13, v13, v19
v_cvt_pk_bf16_f32 v29, v18, v19
v_exp_f32 v16, v56
v_exp_f32 v17, v57
v_add_f32 v13, v13, v16
v_add_f32 v13, v13, v17
v_cvt_pk_bf16_f32 v30, v16, v17
v_exp_f32 v18, v58
v_exp_f32 v19, v59
v_add_f32 v13, v13, v18
v_add_f32 v13, v13, v19
v_cvt_pk_bf16_f32 v31, v18, v19
v_exp_f32 v16, v60
v_exp_f32 v17, v61
v_mov_b32 v14, v16
v_add_f32 v14, v14, v17
v_cvt_pk_bf16_f32 v32, v16, v17
v_exp_f32 v18, v62
v_exp_f32 v19, v63
v_add_f32 v14, v14, v18
v_add_f32 v14, v14, v19
v_cvt_pk_bf16_f32 v33, v18, v19
v_exp_f32 v16, v64
v_exp_f32 v17, v65
v_add_f32 v14, v14, v16
v_add_f32 v14, v14, v17
v_cvt_pk_bf16_f32 v34, v16, v17
v_exp_f32 v18, v66
v_exp_f32 v19, v67
v_add_f32 v14, v14, v18
v_add_f32 v14, v14, v19
v_cvt_pk_bf16_f32 v35, v18, v19
s_nop 1
s_setpc_b64 s[90:91]
L_role_W:
v_lshrrev_b32 v17, 3, v15
v_and_b32 v18, 7, v15
s_lshl_b32 s35, s33, 10
s_add_u32 s40, s10, s35
s_addc_u32 s41, s11, 0
s_sub_u32 s40, s40, 4096
s_subb_u32 s41, s41, 0
s_sub_u32 s42, 4722688, s35
s_mov_b32 s43, 0x00020000
s_mul_i32 s35, s34, 129024
s_add_u32 s44, s4, s35
s_addc_u32 s45, s5, 0
s_mov_b32 s46, 129024
s_mov_b32 s47, 0x00020000
v_bfe_u32 v19, v17, 1, 1
v_lshlrev_b32 v16, 2, v19
v_xor_b32 v16, v16, v18
v_lshlrev_b32 v16, 4, v16
v_lshlrev_b32 v19, 1, v19
v_xor_b32 v19, v19, v18
v_lshlrev_b32 v19, 4, v19
v_lshl_add_u32 v54, v17, 13, v16
s_lshl_b32 s35, s56, 16
v_add_u32 v54, s35, v54
s_lshl_b32 s35, s56, 11
v_lshl_add_u32 v8, v17, 8, v16
v_add_u32 v8, s35, v8
v_lshl_add_u32 v7, v17, 8, v19
v_add_u32 v7, s35, v7
s_movk_i32 s35, 1152
v_mul_lo_u32 v16, s35, v17
v_add_u32 v16, v16, v19
s_mul_i32 s35, s56, 36864
s_add_u32 s36, s35, 0
v_add_u32 v55, s36, v16
s_add_u32 s36, s35, 8128
v_add_u32 v56, s36, v16
s_add_u32 s36, s35, 16256
v_add_u32 v57, s36, v16
s_add_u32 s36, s35, 24384
v_add_u32 v58, s36, v16
s_mul_i32 s35, s56, 9216
v_add_u32 v63, s35, v16
s_mul_i32 s76, s56, 2056
s_lshl_b32 s69, s56, 11
s_lshr_b32 s35, s56, 1
s_lshl_b32 s35, s35, 6
s_add_u32 s69, s69, s35
s_mul_i32 s77, s56, 4352
s_mul_i32 s78, s56, 1088
s_movk_i32 s60, 4096
s_movk_i32 s68, 3200
s_mov_b32 s61, 0
s_add_u32 m0, s77, 66048
s_nop 0
buffer_load_dwordx4 v55, s[44:47], s61 offen offset:0 lds
buffer_load_dwordx4 v56, s[44:47], s61 offen offset:1088 lds
buffer_load_dwordx4 v57, s[44:47], s61 offen offset:2176 lds
buffer_load_dwordx4 v58, s[44:47], s61 offen offset:3264 lds
s_add_u32 m0, s76, 0
s_nop 0
buffer_load_dwordx4 v54, s[40:43], s60 offen offset:0 lds
buffer_load_dwordx4 v54, s[40:43], s68 offen offset:1024 lds
s_add_u32 m0, s76, 8256
s_add_u32 s60, s60, 256
s_add_u32 s68, s68, 256
buffer_load_dwordx4 v54, s[40:43], s60 offen offset:0 lds
buffer_load_dwordx4 v54, s[40:43], s68 offen offset:1024 lds
s_add_u32 m0, s76, 16512
s_add_u32 s60, s60, 256
s_add_u32 s68, s68, 256
buffer_load_dwordx4 v54, s[40:43], s60 offen offset:0 lds
buffer_load_dwordx4 v54, s[40:43], s68 offen offset:1024 lds
s_add_u32 m0, s76, 24768
s_add_u32 s60, s60, 256
s_add_u32 s68, s68, 256
buffer_load_dwordx4 v54, s[40:43], s60 offen offset:0 lds
buffer_load_dwordx4 v54, s[40:43], s68 offen offset:1024 lds
s_add_u32 m0, s76, 33024
s_add_u32 s60, s60, 261376
s_add_u32 s68, s68, 261376
buffer_load_dwordx4 v54, s[40:43], s60 offen offset:0 lds
buffer_load_dwordx4 v54, s[40:43], s68 offen offset:1024 lds
s_add_u32 m0, s76, 41280
s_add_u32 s60, s60, 256
s_add_u32 s68, s68, 256
buffer_load_dwordx4 v54, s[40:43], s60 offen offset:0 lds
buffer_load_dwordx4 v54, s[40:43], s68 offen offset:1024 lds
s_add_u32 m0, s76, 49536
s_add_u32 s60, s60, 256
s_add_u32 s68, s68, 256
buffer_load_dwordx4 v54, s[40:43], s60 offen offset:0 lds
buffer_load_dwordx4 v54, s[40:43], s68 offen offset:1024 lds
s_add_u32 m0, s76, 57792
s_add_u32 s60, s60, 256
s_add_u32 s68, s68, 256
buffer_load_dwordx4 v54, s[40:43], s60 offen offset:0 lds
buffer_load_dwordx4 v54, s[40:43], s68 offen offset:1024 lds
s_add_u32 m0, s77, 83456
s_add_u32 s61, s61, 128
buffer_load_dwordx4 v55, s[44:47], s61 offen offset:0 lds
buffer_load_dwordx4 v56, s[44:47], s61 offen offset:1088 lds
buffer_load_dwordx4 v57, s[44:47], s61 offen offset:2176 lds
buffer_load_dwordx4 v58, s[44:47], s61 offen offset:3264 lds
s_mul_i32 s35, s34, 288
s_mul_i32 s36, s56, 72
s_add_u32 s35, s35, s36
v_min_u32 v19, 63, v15
v_add_u32 v19, s35, v19
v_lshrrev_b32 v16, 3, v19
v_lshlrev_b32 v16, 13, v16
v_and_b32 v19, 7, v19
v_lshl_add_u32 v16, v19, 7, v16
v_add_u32 v16, 4096, v16
buffer_load_dword v0, v16, s[40:43], 0 offen offset:0
s_add_u32 s35, s35, 64
v_min_u32 v19, 7, v15
v_add_u32 v19, s35, v19
v_lshrrev_b32 v16, 3, v19
v_lshlrev_b32 v16, 13, v16
v_and_b32 v19, 7, v19
v_lshl_add_u32 v16, v19, 7, v16
v_add_u32 v16, 4096, v16
buffer_load_dword v0, v16, s[40:43], 0 offen offset:0
s_add_u32 s35, s35, 64
s_and_b32 s35, s33, 1
s_lshl_b32 s35, s35, 2
s_add_u32 s35, s35, s56
s_mul_i32 s35, s35, 16128
v_lshlrev_b32 v16, 7, v15
buffer_load_dword v0, v16, s[44:47], s35 offen offset:0
s_add_u32 s35, s35, 7936
buffer_load_dword v0, v16, s[44:47], s35 offen offset:0
s_add_u32 s35, s35, 7936
s_getpc_b64 s[36:37]
L_cpf_W:
s_sub_u32 s36, s36, L_cpf_W-L_code_start
s_subb_u32 s37, s37, 0
s_lshr_b32 s35, s2, 3
s_lshl_b32 s35, s35, 2
s_add_u32 s35, s35, s56
s_and_b32 s35, s35, 15
s_lshl_b32 s35, s35, 13
v_lshlrev_b32 v16, 7, v15
v_add_u32 v16, s35, v16
s_mov_b32 s35, L_code_end-L_code_start-4
v_min_u32 v16, s35, v16
global_load_dword v0, v16, s[36:37]
s_lshl_b32 s35, s34, 5
s_lshl_b32 s36, s33, 2
s_add_u32 s35, s35, s36
s_lshl_b32 s36, s35, 17
s_lshr_b32 s37, s35, 15
s_add_u32 s80, s6, s36
s_addc_u32 s81, s7, s37
s_sub_u32 s80, s80, 4096
s_subb_u32 s81, s81, 0
s_mov_b32 s82, 528384
s_mov_b32 s83, 0x00020000
s_add_u32 s92, s8, s36
s_addc_u32 s93, s9, s37
s_sub_u32 s92, s92, 4096
s_subb_u32 s93, s93, 0
s_mov_b32 s94, 528384
s_mov_b32 s95, 0x00020000
s_movk_i32 s64, 4096
s_movk_i32 s66, 3200
s_movk_i32 s65, 4096
s_movk_i32 s67, 3200
s_mul_i32 s35, s33, 589824
s_add_u32 s48, s12, s35
s_addc_u32 s49, s13, 0
s_mov_b32 s50, 589824
s_mov_b32 s51, 0x00020000
s_mul_i32 s35, s34, 72
s_mul_i32 s36, s56, 18
s_add_u32 s35, s35, s36
v_min_u32 v19, 17, v15
v_add_u32 v19, s35, v19
v_lshlrev_b32 v9, 7, v19
s_mov_b32 s89, 0
s_mov_b32 s62, 4294819840
v_lshlrev_b32 v10, 4, v15
s_mov_b32 s72, 0x3e0293ee
s_mov_b32 s73, 0x45800000
s_mul_i32 s35, s2, 129024
s_add_u32 s52, s24, s35
s_addc_u32 s53, s25, 0
s_mov_b32 s54, 129024
s_mov_b32 s55, 0x00020000
s_mov_b32 s26, 0x3e0293ee
s_mov_b32 s27, 0x3e0293ee
s_lshl_b32 s35, s2, 2
s_add_u32 s35, s35, s56
s_mul_i32 s35, s35, 24576
s_add_u32 s35, s35, 50331648
s_add_u32 s28, s24, s35
s_addc_u32 s29, s25, 0
s_movk_i32 s30, 24576
s_mov_b32 s31, 0x00020000
s_mov_b32 s38, 0
s_movk_i32 s74, 4096
v_lshrrev_b32 v16, 4, v15
v_bfe_u32 v17, v15, 2, 2
v_and_b32 v18, 3, v15
s_movk_i32 s35, 2056
v_mul_lo_u32 v1, s35, v16
v_lshl_add_u32 v1, v17, 7, v1
v_lshrrev_b32 v19, 1, v17
v_lshl_add_u32 v1, v19, 6, v1
v_lshl_add_u32 v1, v18, 4, v1
v_xor_b32 v19, 1, v19
v_mul_lo_u32 v2, s35, v16
v_lshl_add_u32 v2, v17, 7, v2
v_lshl_add_u32 v2, v19, 6, v2
v_lshl_add_u32 v2, v18, 4, v2
s_movk_i32 s35, 1088
v_mul_lo_u32 v5, s35, v16
v_lshl_add_u32 v5, v17, 7, v5
v_lshrrev_b32 v19, 1, v17
v_lshl_add_u32 v5, v19, 5, v5
v_lshl_add_u32 v5, v18, 3, v5
v_add_u32 v5, 66048, v5
v_xor_b32 v6, 32, v5
v_lshlrev_b32 v3, 11, v17
v_lshrrev_b32 v19, 1, v17
v_lshl_add_u32 v3, v19, 6, v3
v_lshl_add_u32 v3, v18, 7, v3
v_and_b32 v19, 2, v18
v_xor_b32 v19, v19, v16
v_lshl_add_u32 v3, v19, 4, v3
v_add_u32 v3, 33024, v3
v_and_b32 v18, 15, v15
v_lshrrev_b32 v17, 3, v18
s_lshl_b32 s36, s56, 2
v_add_u32 v17, s36, v17
v_mul_lo_u32 v4, s35, v17
v_and_b32 v19, 7, v18
v_lshl_add_u32 v4, v19, 7, v4
v_and_b32 v19, 2, v18
v_xor_b32 v19, v19, v16
v_lshl_add_u32 v4, v19, 4, v4
v_add_u32 v4, 66048, v4
v_accvgpr_write_b32 a0, 0
v_accvgpr_write_b32 a1, 0
v_accvgpr_write_b32 a2, 0
v_accvgpr_write_b32 a3, 0
v_accvgpr_write_b32 a4, 0
v_accvgpr_write_b32 a5, 0
v_accvgpr_write_b32 a6, 0
v_accvgpr_write_b32 a7, 0
v_accvgpr_write_b32 a8, 0
v_accvgpr_write_b32 a9, 0
v_accvgpr_write_b32 a10, 0
v_accvgpr_write_b32 a11, 0
v_accvgpr_write_b32 a12, 0
v_accvgpr_write_b32 a13, 0
v_accvgpr_write_b32 a14, 0
v_accvgpr_write_b32 a15, 0
v_accvgpr_write_b32 a16, 0
v_accvgpr_write_b32 a17, 0
v_accvgpr_write_b32 a18, 0
v_accvgpr_write_b32 a19, 0
v_accvgpr_write_b32 a20, 0
v_accvgpr_write_b32 a21, 0
v_accvgpr_write_b32 a22, 0
v_accvgpr_write_b32 a23, 0
v_accvgpr_write_b32 a24, 0
v_accvgpr_write_b32 a25, 0
v_accvgpr_write_b32 a26, 0
v_accvgpr_write_b32 a27, 0
v_accvgpr_write_b32 a28, 0
v_accvgpr_write_b32 a29, 0
v_accvgpr_write_b32 a30, 0
v_accvgpr_write_b32 a31, 0
v_accvgpr_write_b32 a32, 0
v_accvgpr_write_b32 a33, 0
v_accvgpr_write_b32 a34, 0
v_accvgpr_write_b32 a35, 0
v_accvgpr_write_b32 a36, 0
v_accvgpr_write_b32 a37, 0
v_accvgpr_write_b32 a38, 0
v_accvgpr_write_b32 a39, 0
v_accvgpr_write_b32 a40, 0
v_accvgpr_write_b32 a41, 0
v_accvgpr_write_b32 a42, 0
v_accvgpr_write_b32 a43, 0
v_accvgpr_write_b32 a44, 0
v_accvgpr_write_b32 a45, 0
v_accvgpr_write_b32 a46, 0
v_accvgpr_write_b32 a47, 0
v_accvgpr_write_b32 a48, 0
v_accvgpr_write_b32 a49, 0
v_accvgpr_write_b32 a50, 0
v_accvgpr_write_b32 a51, 0
v_accvgpr_write_b32 a52, 0
v_accvgpr_write_b32 a53, 0
v_accvgpr_write_b32 a54, 0
v_accvgpr_write_b32 a55, 0
v_accvgpr_write_b32 a56, 0
v_accvgpr_write_b32 a57, 0
v_accvgpr_write_b32 a58, 0
v_accvgpr_write_b32 a59, 0
v_accvgpr_write_b32 a60, 0
v_accvgpr_write_b32 a61, 0
v_accvgpr_write_b32 a62, 0
v_accvgpr_write_b32 a63, 0
v_accvgpr_write_b32 a64, 0
v_accvgpr_write_b32 a65, 0
v_accvgpr_write_b32 a66, 0
v_accvgpr_write_b32 a67, 0
v_accvgpr_write_b32 a68, 0
v_accvgpr_write_b32 a69, 0
v_accvgpr_write_b32 a70, 0
v_accvgpr_write_b32 a71, 0
v_accvgpr_write_b32 a72, 0
v_accvgpr_write_b32 a73, 0
v_accvgpr_write_b32 a74, 0
v_accvgpr_write_b32 a75, 0
v_accvgpr_write_b32 a76, 0
v_accvgpr_write_b32 a77, 0
v_accvgpr_write_b32 a78, 0
v_accvgpr_write_b32 a79, 0
v_accvgpr_write_b32 a80, 0
v_accvgpr_write_b32 a81, 0
v_accvgpr_write_b32 a82, 0
v_accvgpr_write_b32 a83, 0
v_accvgpr_write_b32 a84, 0
v_accvgpr_write_b32 a85, 0
v_accvgpr_write_b32 a86, 0
v_accvgpr_write_b32 a87, 0
v_accvgpr_write_b32 a88, 0
v_accvgpr_write_b32 a89, 0
v_accvgpr_write_b32 a90, 0
v_accvgpr_write_b32 a91, 0
v_accvgpr_write_b32 a92, 0
v_accvgpr_write_b32 a93, 0
v_accvgpr_write_b32 a94, 0
v_accvgpr_write_b32 a95, 0
v_accvgpr_write_b32 a96, 0
v_accvgpr_write_b32 a97, 0
v_accvgpr_write_b32 a98, 0
v_accvgpr_write_b32 a99, 0
v_accvgpr_write_b32 a100, 0
v_accvgpr_write_b32 a101, 0
v_accvgpr_write_b32 a102, 0
v_accvgpr_write_b32 a103, 0
v_accvgpr_write_b32 a104, 0
v_accvgpr_write_b32 a105, 0
v_accvgpr_write_b32 a106, 0
v_accvgpr_write_b32 a107, 0
v_accvgpr_write_b32 a108, 0
v_accvgpr_write_b32 a109, 0
v_accvgpr_write_b32 a110, 0
v_accvgpr_write_b32 a111, 0
v_accvgpr_write_b32 a112, 0
v_accvgpr_write_b32 a113, 0
v_accvgpr_write_b32 a114, 0
v_accvgpr_write_b32 a115, 0
v_accvgpr_write_b32 a116, 0
v_accvgpr_write_b32 a117, 0
v_accvgpr_write_b32 a118, 0
v_accvgpr_write_b32 a119, 0
v_accvgpr_write_b32 a120, 0
v_accvgpr_write_b32 a121, 0
v_accvgpr_write_b32 a122, 0
v_accvgpr_write_b32 a123, 0
v_accvgpr_write_b32 a124, 0
v_accvgpr_write_b32 a125, 0
v_accvgpr_write_b32 a126, 0
v_accvgpr_write_b32 a127, 0
s_waitcnt vmcnt(17) lgkmcnt(0)
s_barrier
ds_read_b128 v[36:39], v4 offset:0
ds_read_b64_tr_b16 v[68:69], v1 offset:0
ds_read_b64_tr_b16 v[70:71], v1 offset:512
ds_read_b64_tr_b16 v[72:73], v1 offset:8
ds_read_b64_tr_b16 v[74:75], v1 offset:520
ds_read_b64_tr_b16 v[76:77], v2 offset:0
ds_read_b64_tr_b16 v[78:79], v2 offset:512
ds_read_b64_tr_b16 v[80:81], v2 offset:8
ds_read_b64_tr_b16 v[82:83], v2 offset:520
ds_read_b64_tr_b16 v[84:85], v1 offset:1024
ds_read_b64_tr_b16 v[86:87], v1 offset:1536
ds_read_b64_tr_b16 v[88:89], v1 offset:1032
ds_read_b64_tr_b16 v[90:91], v1 offset:1544
ds_read_b64_tr_b16 v[92:93], v2 offset:1024
ds_read_b64_tr_b16 v[94:95], v2 offset:1536
ds_read_b64_tr_b16 v[96:97], v2 offset:1032
ds_read_b64_tr_b16 v[98:99], v2 offset:1544
s_waitcnt lgkmcnt(14)
v_mfma_f32_16x16x32_bf16 a[0:3], v[68:71], v[36:39], a[0:3]
s_waitcnt lgkmcnt(12)
ds_read_b64_tr_b16 v[68:69], v1 offset:8256
ds_read_b64_tr_b16 v[70:71], v1 offset:8768
v_mfma_f32_16x16x32_bf16 a[4:7], v[72:75], v[36:39], a[4:7]
s_waitcnt lgkmcnt(12)
ds_read_b64_tr_b16 v[72:73], v1 offset:8264
ds_read_b64_tr_b16 v[74:75], v1 offset:8776
v_mfma_f32_16x16x32_bf16 a[8:11], v[76:79], v[36:39], a[8:11]
s_waitcnt lgkmcnt(12)
ds_read_b64_tr_b16 v[76:77], v2 offset:8256
ds_read_b64_tr_b16 v[78:79], v2 offset:8768
v_mfma_f32_16x16x32_bf16 a[12:15], v[80:83], v[36:39], a[12:15]
s_waitcnt lgkmcnt(12)
ds_read_b64_tr_b16 v[80:81], v2 offset:8264
ds_read_b64_tr_b16 v[82:83], v2 offset:8776
v_mfma_f32_16x16x32_bf16 a[16:19], v[84:87], v[36:39], a[16:19]
s_waitcnt lgkmcnt(12)
ds_read_b64_tr_b16 v[84:85], v1 offset:9280
ds_read_b64_tr_b16 v[86:87], v1 offset:9792
v_mfma_f32_16x16x32_bf16 a[20:23], v[88:91], v[36:39], a[20:23]
s_waitcnt lgkmcnt(12)
ds_read_b64_tr_b16 v[88:89], v1 offset:9288
ds_read_b64_tr_b16 v[90:91], v1 offset:9800
v_mfma_f32_16x16x32_bf16 a[24:27], v[92:95], v[36:39], a[24:27]
s_waitcnt lgkmcnt(12)
ds_read_b64_tr_b16 v[92:93], v2 offset:9280
ds_read_b64_tr_b16 v[94:95], v2 offset:9792
v_mfma_f32_16x16x32_bf16 a[28:31], v[96:99], v[36:39], a[28:31]
s_waitcnt lgkmcnt(12)
ds_read_b64_tr_b16 v[96:97], v2 offset:9288
ds_read_b64_tr_b16 v[98:99], v2 offset:9800
v_mfma_f32_16x16x32_bf16 a[32:35], v[68:71], v[36:39], a[32:35]
s_waitcnt lgkmcnt(12)
ds_read_b64_tr_b16 v[68:69], v1 offset:16512
ds_read_b64_tr_b16 v[70:71], v1 offset:17024
v_mfma_f32_16x16x32_bf16 a[36:39], v[72:75], v[36:39], a[36:39]
s_waitcnt lgkmcnt(12)
ds_read_b64_tr_b16 v[72:73], v1 offset:16520
ds_read_b64_tr_b16 v[74:75], v1 offset:17032
v_mfma_f32_16x16x32_bf16 a[40:43], v[76:79], v[36:39], a[40:43]
s_waitcnt lgkmcnt(12)
ds_read_b64_tr_b16 v[76:77], v2 offset:16512
ds_read_b64_tr_b16 v[78:79], v2 offset:17024
v_mfma_f32_16x16x32_bf16 a[44:47], v[80:83], v[36:39], a[44:47]
s_waitcnt lgkmcnt(12)
ds_read_b64_tr_b16 v[80:81], v2 offset:16520
ds_read_b64_tr_b16 v[82:83], v2 offset:17032
v_mfma_f32_16x16x32_bf16 a[48:51], v[84:87], v[36:39], a[48:51]
s_waitcnt lgkmcnt(12)
ds_read_b64_tr_b16 v[84:85], v1 offset:17536
ds_read_b64_tr_b16 v[86:87], v1 offset:18048
v_mfma_f32_16x16x32_bf16 a[52:55], v[88:91], v[36:39], a[52:55]
s_waitcnt lgkmcnt(12)
ds_read_b64_tr_b16 v[88:89], v1 offset:17544
ds_read_b64_tr_b16 v[90:91], v1 offset:18056
v_mfma_f32_16x16x32_bf16 a[56:59], v[92:95], v[36:39], a[56:59]
s_waitcnt lgkmcnt(12)
ds_read_b64_tr_b16 v[92:93], v2 offset:17536
ds_read_b64_tr_b16 v[94:95], v2 offset:18048
v_mfma_f32_16x16x32_bf16 a[60:63], v[96:99], v[36:39], a[60:63]
s_mov_b32 s39, 4
L_loop4:
s_waitcnt vmcnt(8)
s_barrier
s_waitcnt lgkmcnt(12)
ds_read_b64_tr_b16 v[96:97], v2 offset:17544
ds_read_b64_tr_b16 v[98:99], v2 offset:18056
v_mfma_f32_16x16x32_bf16 a[64:67], v[68:71], v[36:39], a[64:67]
s_waitcnt lgkmcnt(12)
ds_read_b64_tr_b16 v[68:69], v1 offset:24768
ds_read_b64_tr_b16 v[70:71], v1 offset:25280
s_add_u32 m0, s76, 0
s_add_u32 s60, s60, 261376
v_mfma_f32_16x16x32_bf16 a[68:71], v[72:75], v[36:39], a[68:71]
s_waitcnt lgkmcnt(12)
ds_read_b64_tr_b16 v[72:73], v1 offset:24776
ds_read_b64_tr_b16 v[74:75], v1 offset:25288
s_add_u32 s68, s68, 261376
buffer_load_dwordx4 v54, s[40:43], s60 offen offset:0 lds
v_mfma_f32_16x16x32_bf16 a[72:75], v[76:79], v[36:39], a[72:75]
s_waitcnt lgkmcnt(12)
ds_read_b64_tr_b16 v[76:77], v2 offset:24768
ds_read_b64_tr_b16 v[78:79], v2 offset:25280
buffer_load_dwordx4 v54, s[40:43], s68 offen offset:1024 lds
s_add_u32 m0, s76, 8256
v_mfma_f32_16x16x32_bf16 a[76:79], v[80:83], v[36:39], a[76:79]
s_waitcnt lgkmcnt(12)
ds_read_b64_tr_b16 v[80:81], v2 offset:24776
ds_read_b64_tr_b16 v[82:83], v2 offset:25288
s_add_u32 s60, s60, 256
s_add_u32 s68, s68, 256
v_mfma_f32_16x16x32_bf16 a[80:83], v[84:87], v[36:39], a[80:83]
s_waitcnt lgkmcnt(12)
ds_read_b64_tr_b16 v[84:85], v1 offset:25792
ds_read_b64_tr_b16 v[86:87], v1 offset:26304
buffer_load_dwordx4 v54, s[40:43], s60 offen offset:0 lds
buffer_load_dwordx4 v54, s[40:43], s68 offen offset:1024 lds
v_mfma_f32_16x16x32_bf16 a[84:87], v[88:91], v[36:39], a[84:87]
s_waitcnt lgkmcnt(12)
ds_read_b64_tr_b16 v[88:89], v1 offset:25800
ds_read_b64_tr_b16 v[90:91], v1 offset:26312
v_mfma_f32_16x16x32_bf16 a[88:91], v[92:95], v[36:39], a[88:91]
s_waitcnt lgkmcnt(12)
ds_read_b64_tr_b16 v[92:93], v2 offset:25792
ds_read_b64_tr_b16 v[94:95], v2 offset:26304
v_mfma_f32_16x16x32_bf16 a[92:95], v[96:99], v[36:39], a[92:95]
s_waitcnt lgkmcnt(12)
ds_read_b64_tr_b16 v[96:97], v2 offset:25800
ds_read_b64_tr_b16 v[98:99], v2 offset:26312
v_mfma_f32_16x16x32_bf16 a[96:99], v[68:71], v[36:39], a[96:99]
s_waitcnt lgkmcnt(12)
ds_read_b128 v[44:47], v4 offset:64
ds_read_b64_tr_b16 v[68:69], v1 offset:33024
ds_read_b64_tr_b16 v[70:71], v1 offset:33536
v_mfma_f32_16x16x32_bf16 a[100:103], v[72:75], v[36:39], a[100:103]
s_waitcnt lgkmcnt(13)
ds_read_b64_tr_b16 v[72:73], v1 offset:33032
ds_read_b64_tr_b16 v[74:75], v1 offset:33544
v_mfma_f32_16x16x32_bf16 a[104:107], v[76:79], v[36:39], a[104:107]
s_waitcnt lgkmcnt(13)
ds_read_b64_tr_b16 v[76:77], v2 offset:33024
ds_read_b64_tr_b16 v[78:79], v2 offset:33536
v_mfma_f32_16x16x32_bf16 a[108:111], v[80:83], v[36:39], a[108:111]
s_waitcnt lgkmcnt(13)
ds_read_b64_tr_b16 v[80:81], v2 offset:33032
ds_read_b64_tr_b16 v[82:83], v2 offset:33544
v_mfma_f32_16x16x32_bf16 a[112:115], v[84:87], v[36:39], a[112:115]
s_waitcnt lgkmcnt(13)
ds_read_b64_tr_b16 v[84:85], v1 offset:34048
ds_read_b64_tr_b16 v[86:87], v1 offset:34560
v_mfma_f32_16x16x32_bf16 a[116:119], v[88:91], v[36:39], a[116:119]
s_waitcnt lgkmcnt(13)
ds_read_b64_tr_b16 v[88:89], v1 offset:34056
ds_read_b64_tr_b16 v[90:91], v1 offset:34568
v_mfma_f32_16x16x32_bf16 a[120:123], v[92:95], v[36:39], a[120:123]
s_waitcnt lgkmcnt(13)
ds_read_b64_tr_b16 v[92:93], v2 offset:34048
ds_read_b64_tr_b16 v[94:95], v2 offset:34560
v_mfma_f32_16x16x32_bf16 a[124:127], v[96:99], v[36:39], a[124:127]
s_waitcnt vmcnt(8)
s_barrier
s_waitcnt lgkmcnt(12)
ds_read_b64_tr_b16 v[96:97], v2 offset:34056
ds_read_b64_tr_b16 v[98:99], v2 offset:34568
v_mfma_f32_16x16x32_bf16 a[0:3], v[68:71], v[44:47], a[0:3]
s_waitcnt lgkmcnt(12)
ds_read_b64_tr_b16 v[68:69], v1 offset:41280
ds_read_b64_tr_b16 v[70:71], v1 offset:41792
s_add_u32 m0, s76, 16512
s_add_u32 s60, s60, 256
v_mfma_f32_16x16x32_bf16 a[4:7], v[72:75], v[44:47], a[4:7]
s_waitcnt lgkmcnt(12)
ds_read_b64_tr_b16 v[72:73], v1 offset:41288
ds_read_b64_tr_b16 v[74:75], v1 offset:41800
s_add_u32 s68, s68, 256
buffer_load_dwordx4 v54, s[40:43], s60 offen offset:0 lds
v_mfma_f32_16x16x32_bf16 a[8:11], v[76:79], v[44:47], a[8:11]
s_waitcnt lgkmcnt(12)
ds_read_b64_tr_b16 v[76:77], v2 offset:41280
ds_read_b64_tr_b16 v[78:79], v2 offset:41792
buffer_load_dwordx4 v54, s[40:43], s68 offen offset:1024 lds
s_add_u32 m0, s76, 24768
v_mfma_f32_16x16x32_bf16 a[12:15], v[80:83], v[44:47], a[12:15]
s_waitcnt lgkmcnt(12)
ds_read_b64_tr_b16 v[80:81], v2 offset:41288
ds_read_b64_tr_b16 v[82:83], v2 offset:41800
s_add_u32 s60, s60, 256
s_add_u32 s68, s68, 256
v_mfma_f32_16x16x32_bf16 a[16:19], v[84:87], v[44:47], a[16:19]
s_waitcnt lgkmcnt(12)
ds_read_b64_tr_b16 v[84:85], v1 offset:42304
ds_read_b64_tr_b16 v[86:87], v1 offset:42816
buffer_load_dwordx4 v54, s[40:43], s60 offen offset:0 lds
buffer_load_dwordx4 v54, s[40:43], s68 offen offset:1024 lds
v_mfma_f32_16x16x32_bf16 a[20:23], v[88:91], v[44:47], a[20:23]
s_waitcnt lgkmcnt(12)
ds_read_b64_tr_b16 v[88:89], v1 offset:42312
ds_read_b64_tr_b16 v[90:91], v1 offset:42824
v_mfma_f32_16x16x32_bf16 a[24:27], v[92:95], v[44:47], a[24:27]
s_waitcnt lgkmcnt(12)
ds_read_b64_tr_b16 v[92:93], v2 offset:42304
ds_read_b64_tr_b16 v[94:95], v2 offset:42816
v_mfma_f32_16x16x32_bf16 a[28:31], v[96:99], v[44:47], a[28:31]
s_waitcnt lgkmcnt(12)
ds_read_b64_tr_b16 v[96:97], v2 offset:42312
ds_read_b64_tr_b16 v[98:99], v2 offset:42824
v_mfma_f32_16x16x32_bf16 a[32:35], v[68:71], v[44:47], a[32:35]
s_waitcnt lgkmcnt(12)
ds_read_b64_tr_b16 v[68:69], v1 offset:49536
ds_read_b64_tr_b16 v[70:71], v1 offset:50048
v_mfma_f32_16x16x32_bf16 a[36:39], v[72:75], v[44:47], a[36:39]
s_waitcnt lgkmcnt(12)
ds_read_b64_tr_b16 v[72:73], v1 offset:49544
ds_read_b64_tr_b16 v[74:75], v1 offset:50056
v_mfma_f32_16x16x32_bf16 a[40:43], v[76:79], v[44:47], a[40:43]
s_waitcnt lgkmcnt(12)
ds_read_b64_tr_b16 v[76:77], v2 offset:49536
ds_read_b64_tr_b16 v[78:79], v2 offset:50048
v_mfma_f32_16x16x32_bf16 a[44:47], v[80:83], v[44:47], a[44:47]
s_waitcnt lgkmcnt(12)
ds_read_b64_tr_b16 v[80:81], v2 offset:49544
ds_read_b64_tr_b16 v[82:83], v2 offset:50056
v_mfma_f32_16x16x32_bf16 a[48:51], v[84:87], v[44:47], a[48:51]
s_waitcnt lgkmcnt(12)
ds_read_b64_tr_b16 v[84:85], v1 offset:50560
ds_read_b64_tr_b16 v[86:87], v1 offset:51072
v_mfma_f32_16x16x32_bf16 a[52:55], v[88:91], v[44:47], a[52:55]
s_waitcnt lgkmcnt(12)
ds_read_b64_tr_b16 v[88:89], v1 offset:50568
ds_read_b64_tr_b16 v[90:91], v1 offset:51080
v_mfma_f32_16x16x32_bf16 a[56:59], v[92:95], v[44:47], a[56:59]
s_waitcnt lgkmcnt(12)
ds_read_b64_tr_b16 v[92:93], v2 offset:50560
ds_read_b64_tr_b16 v[94:95], v2 offset:51072
v_mfma_f32_16x16x32_bf16 a[60:63], v[96:99], v[44:47], a[60:63]
s_waitcnt vmcnt(4)
s_barrier
s_waitcnt lgkmcnt(12)
ds_read_b64_tr_b16 v[96:97], v2 offset:50568
ds_read_b64_tr_b16 v[98:99], v2 offset:51080
v_mfma_f32_16x16x32_bf16 a[64:67], v[68:71], v[44:47], a[64:67]
s_waitcnt lgkmcnt(12)
ds_read_b64_tr_b16 v[68:69], v1 offset:57792
ds_read_b64_tr_b16 v[70:71], v1 offset:58304
s_add_u32 m0, s76, 33024
s_add_u32 s60, s60, 261376
v_mfma_f32_16x16x32_bf16 a[68:71], v[72:75], v[44:47], a[68:71]
s_waitcnt lgkmcnt(12)
ds_read_b64_tr_b16 v[72:73], v1 offset:57800
ds_read_b64_tr_b16 v[74:75], v1 offset:58312
s_add_u32 s68, s68, 261376
buffer_load_dwordx4 v54, s[40:43], s60 offen offset:0 lds
v_mfma_f32_16x16x32_bf16 a[72:75], v[76:79], v[44:47], a[72:75]
s_waitcnt lgkmcnt(12)
ds_read_b64_tr_b16 v[76:77], v2 offset:57792
ds_read_b64_tr_b16 v[78:79], v2 offset:58304
buffer_load_dwordx4 v54, s[40:43], s68 offen offset:1024 lds
s_add_u32 m0, s76, 41280
v_mfma_f32_16x16x32_bf16 a[76:79], v[80:83], v[44:47], a[76:79]
s_waitcnt lgkmcnt(12)
ds_read_b64_tr_b16 v[80:81], v2 offset:57800
ds_read_b64_tr_b16 v[82:83], v2 offset:58312
s_add_u32 s60, s60, 256
s_add_u32 s68, s68, 256
v_mfma_f32_16x16x32_bf16 a[80:83], v[84:87], v[44:47], a[80:83]
s_waitcnt lgkmcnt(12)
ds_read_b64_tr_b16 v[84:85], v1 offset:58816
ds_read_b64_tr_b16 v[86:87], v1 offset:59328
buffer_load_dwordx4 v54, s[40:43], s60 offen offset:0 lds
buffer_load_dwordx4 v54, s[40:43], s68 offen offset:1024 lds
v_mfma_f32_16x16x32_bf16 a[84:87], v[88:91], v[44:47], a[84:87]
s_waitcnt lgkmcnt(12)
ds_read_b64_tr_b16 v[88:89], v1 offset:58824
ds_read_b64_tr_b16 v[90:91], v1 offset:59336
v_mfma_f32_16x16x32_bf16 a[88:91], v[92:95], v[44:47], a[88:91]
s_waitcnt lgkmcnt(12)
ds_read_b64_tr_b16 v[92:93], v2 offset:58816
ds_read_b64_tr_b16 v[94:95], v2 offset:59328
v_mfma_f32_16x16x32_bf16 a[92:95], v[96:99], v[44:47], a[92:95]
s_waitcnt lgkmcnt(12)
ds_read_b64_tr_b16 v[96:97], v2 offset:58824
ds_read_b64_tr_b16 v[98:99], v2 offset:59336
v_mfma_f32_16x16x32_bf16 a[96:99], v[68:71], v[44:47], a[96:99]
s_waitcnt lgkmcnt(12)
ds_read_b128 v[36:39], v4 offset:17408
ds_read_b64_tr_b16 v[68:69], v1 offset:0
ds_read_b64_tr_b16 v[70:71], v1 offset:512
v_mfma_f32_16x16x32_bf16 a[100:103], v[72:75], v[44:47], a[100:103]
s_waitcnt lgkmcnt(13)
ds_read_b64_tr_b16 v[72:73], v1 offset:8
ds_read_b64_tr_b16 v[74:75], v1 offset:520
v_mfma_f32_16x16x32_bf16 a[104:107], v[76:79], v[44:47], a[104:107]
s_waitcnt lgkmcnt(13)
ds_read_b64_tr_b16 v[76:77], v2 offset:0
ds_read_b64_tr_b16 v[78:79], v2 offset:512
v_mfma_f32_16x16x32_bf16 a[108:111], v[80:83], v[44:47], a[108:111]
s_waitcnt lgkmcnt(13)
ds_read_b64_tr_b16 v[80:81], v2 offset:8
ds_read_b64_tr_b16 v[82:83], v2 offset:520
v_mfma_f32_16x16x32_bf16 a[112:115], v[84:87], v[44:47], a[112:115]
s_waitcnt lgkmcnt(13)
ds_read_b64_tr_b16 v[84:85], v1 offset:1024
ds_read_b64_tr_b16 v[86:87], v1 offset:1536
v_mfma_f32_16x16x32_bf16 a[116:119], v[88:91], v[44:47], a[116:119]
s_waitcnt lgkmcnt(13)
ds_read_b64_tr_b16 v[88:89], v1 offset:1032
ds_read_b64_tr_b16 v[90:91], v1 offset:1544
v_mfma_f32_16x16x32_bf16 a[120:123], v[92:95], v[44:47], a[120:123]
s_waitcnt lgkmcnt(13)
ds_read_b64_tr_b16 v[92:93], v2 offset:1024
ds_read_b64_tr_b16 v[94:95], v2 offset:1536
v_mfma_f32_16x16x32_bf16 a[124:127], v[96:99], v[44:47], a[124:127]
s_waitcnt vmcnt(4)
s_barrier
s_waitcnt lgkmcnt(12)
ds_read_b64_tr_b16 v[96:97], v2 offset:1032
ds_read_b64_tr_b16 v[98:99], v2 offset:1544
v_mfma_f32_16x16x32_bf16 a[0:3], v[68:71], v[36:39], a[0:3]
s_waitcnt lgkmcnt(12)
ds_read_b64_tr_b16 v[68:69], v1 offset:8256
ds_read_b64_tr_b16 v[70:71], v1 offset:8768
s_add_u32 m0, s76, 49536
s_add_u32 s60, s60, 256
v_mfma_f32_16x16x32_bf16 a[4:7], v[72:75], v[36:39], a[4:7]
s_waitcnt lgkmcnt(12)
ds_read_b64_tr_b16 v[72:73], v1 offset:8264
ds_read_b64_tr_b16 v[74:75], v1 offset:8776
s_add_u32 s68, s68, 256
buffer_load_dwordx4 v54, s[40:43], s60 offen offset:0 lds
v_mfma_f32_16x16x32_bf16 a[8:11], v[76:79], v[36:39], a[8:11]
s_waitcnt lgkmcnt(12)
ds_read_b64_tr_b16 v[76:77], v2 offset:8256
ds_read_b64_tr_b16 v[78:79], v2 offset:8768
buffer_load_dwordx4 v54, s[40:43], s68 offen offset:1024 lds
s_add_u32 m0, s76, 57792
v_mfma_f32_16x16x32_bf16 a[12:15], v[80:83], v[36:39], a[12:15]
s_waitcnt lgkmcnt(12)
ds_read_b64_tr_b16 v[80:81], v2 offset:8264
ds_read_b64_tr_b16 v[82:83], v2 offset:8776
s_add_u32 s60, s60, 256
s_add_u32 s68, s68, 256
v_mfma_f32_16x16x32_bf16 a[16:19], v[84:87], v[36:39], a[16:19]
s_waitcnt lgkmcnt(12)
ds_read_b64_tr_b16 v[84:85], v1 offset:9280
ds_read_b64_tr_b16 v[86:87], v1 offset:9792
buffer_load_dwordx4 v54, s[40:43], s60 offen offset:0 lds
buffer_load_dwordx4 v54, s[40:43], s68 offen offset:1024 lds
v_mfma_f32_16x16x32_bf16 a[20:23], v[88:91], v[36:39], a[20:23]
s_waitcnt lgkmcnt(12)
ds_read_b64_tr_b16 v[88:89], v1 offset:9288
ds_read_b64_tr_b16 v[90:91], v1 offset:9800
s_add_u32 m0, s77, 66048
s_add_u32 s61, s61, 128
v_mfma_f32_16x16x32_bf16 a[24:27], v[92:95], v[36:39], a[24:27]
s_waitcnt lgkmcnt(12)
ds_read_b64_tr_b16 v[92:93], v2 offset:9280
ds_read_b64_tr_b16 v[94:95], v2 offset:9792
buffer_load_dwordx4 v55, s[44:47], s61 offen offset:0 lds
buffer_load_dwordx4 v56, s[44:47], s61 offen offset:1088 lds
v_mfma_f32_16x16x32_bf16 a[28:31], v[96:99], v[36:39], a[28:31]
s_waitcnt lgkmcnt(12)
ds_read_b64_tr_b16 v[96:97], v2 offset:9288
ds_read_b64_tr_b16 v[98:99], v2 offset:9800
buffer_load_dwordx4 v57, s[44:47], s61 offen offset:2176 lds
buffer_load_dwordx4 v58, s[44:47], s61 offen offset:3264 lds
v_mfma_f32_16x16x32_bf16 a[32:35], v[68:71], v[36:39], a[32:35]
s_waitcnt lgkmcnt(12)
ds_read_b64_tr_b16 v[68:69], v1 offset:16512
ds_read_b64_tr_b16 v[70:71], v1 offset:17024
v_mfma_f32_16x16x32_bf16 a[36:39], v[72:75], v[36:39], a[36:39]
s_waitcnt lgkmcnt(12)
ds_read_b64_tr_b16 v[72:73], v1 offset:16520
ds_read_b64_tr_b16 v[74:75], v1 offset:17032
v_mfma_f32_16x16x32_bf16 a[40:43], v[76:79], v[36:39], a[40:43]
s_waitcnt lgkmcnt(12)
ds_read_b64_tr_b16 v[76:77], v2 offset:16512
ds_read_b64_tr_b16 v[78:79], v2 offset:17024
v_mfma_f32_16x16x32_bf16 a[44:47], v[80:83], v[36:39], a[44:47]
s_waitcnt lgkmcnt(12)
ds_read_b64_tr_b16 v[80:81], v2 offset:16520
ds_read_b64_tr_b16 v[82:83], v2 offset:17032
v_mfma_f32_16x16x32_bf16 a[48:51], v[84:87], v[36:39], a[48:51]
s_waitcnt lgkmcnt(12)
ds_read_b64_tr_b16 v[84:85], v1 offset:17536
ds_read_b64_tr_b16 v[86:87], v1 offset:18048
v_mfma_f32_16x16x32_bf16 a[52:55], v[88:91], v[36:39], a[52:55]
s_waitcnt lgkmcnt(12)
ds_read_b64_tr_b16 v[88:89], v1 offset:17544
ds_read_b64_tr_b16 v[90:91], v1 offset:18056
v_mfma_f32_16x16x32_bf16 a[56:59], v[92:95], v[36:39], a[56:59]
s_waitcnt lgkmcnt(12)
ds_read_b64_tr_b16 v[92:93], v2 offset:17536
ds_read_b64_tr_b16 v[94:95], v2 offset:18048
v_mfma_f32_16x16x32_bf16 a[60:63], v[96:99], v[36:39], a[60:63]
s_waitcnt vmcnt(8)
s_barrier
s_waitcnt lgkmcnt(12)
ds_read_b64_tr_b16 v[96:97], v2 offset:17544
ds_read_b64_tr_b16 v[98:99], v2 offset:18056
v_mfma_f32_16x16x32_bf16 a[64:67], v[68:71], v[36:39], a[64:67]
s_waitcnt lgkmcnt(12)
ds_read_b64_tr_b16 v[68:69], v1 offset:24768
ds_read_b64_tr_b16 v[70:71], v1 offset:25280
s_add_u32 m0, s76, 0
s_add_u32 s60, s60, 261376
v_mfma_f32_16x16x32_bf16 a[68:71], v[72:75], v[36:39], a[68:71]
s_waitcnt lgkmcnt(12)
ds_read_b64_tr_b16 v[72:73], v1 offset:24776
ds_read_b64_tr_b16 v[74:75], v1 offset:25288
s_add_u32 s68, s68, 261376
buffer_load_dwordx4 v54, s[40:43], s60 offen offset:0 lds
v_mfma_f32_16x16x32_bf16 a[72:75], v[76:79], v[36:39], a[72:75]
s_waitcnt lgkmcnt(12)
ds_read_b64_tr_b16 v[76:77], v2 offset:24768
ds_read_b64_tr_b16 v[78:79], v2 offset:25280
buffer_load_dwordx4 v54, s[40:43], s68 offen offset:1024 lds
s_add_u32 m0, s76, 8256
v_mfma_f32_16x16x32_bf16 a[76:79], v[80:83], v[36:39], a[76:79]
s_waitcnt lgkmcnt(12)
ds_read_b64_tr_b16 v[80:81], v2 offset:24776
ds_read_b64_tr_b16 v[82:83], v2 offset:25288
s_add_u32 s60, s60, 256
s_add_u32 s68, s68, 256
v_mfma_f32_16x16x32_bf16 a[80:83], v[84:87], v[36:39], a[80:83]
s_waitcnt lgkmcnt(12)
ds_read_b64_tr_b16 v[84:85], v1 offset:25792
ds_read_b64_tr_b16 v[86:87], v1 offset:26304
buffer_load_dwordx4 v54, s[40:43], s60 offen offset:0 lds
buffer_load_dwordx4 v54, s[40:43], s68 offen offset:1024 lds
v_mfma_f32_16x16x32_bf16 a[84:87], v[88:91], v[36:39], a[84:87]
s_waitcnt lgkmcnt(12)
ds_read_b64_tr_b16 v[88:89], v1 offset:25800
ds_read_b64_tr_b16 v[90:91], v1 offset:26312
v_mfma_f32_16x16x32_bf16 a[88:91], v[92:95], v[36:39], a[88:91]
s_waitcnt lgkmcnt(12)
ds_read_b64_tr_b16 v[92:93], v2 offset:25792
ds_read_b64_tr_b16 v[94:95], v2 offset:26304
v_mfma_f32_16x16x32_bf16 a[92:95], v[96:99], v[36:39], a[92:95]
s_waitcnt lgkmcnt(12)
ds_read_b64_tr_b16 v[96:97], v2 offset:25800
ds_read_b64_tr_b16 v[98:99], v2 offset:26312
v_mfma_f32_16x16x32_bf16 a[96:99], v[68:71], v[36:39], a[96:99]
s_waitcnt lgkmcnt(12)
ds_read_b128 v[44:47], v4 offset:17472
ds_read_b64_tr_b16 v[68:69], v1 offset:33024
ds_read_b64_tr_b16 v[70:71], v1 offset:33536
v_mfma_f32_16x16x32_bf16 a[100:103], v[72:75], v[36:39], a[100:103]
s_waitcnt lgkmcnt(13)
ds_read_b64_tr_b16 v[72:73], v1 offset:33032
ds_read_b64_tr_b16 v[74:75], v1 offset:33544
v_mfma_f32_16x16x32_bf16 a[104:107], v[76:79], v[36:39], a[104:107]
s_waitcnt lgkmcnt(13)
ds_read_b64_tr_b16 v[76:77], v2 offset:33024
ds_read_b64_tr_b16 v[78:79], v2 offset:33536
v_mfma_f32_16x16x32_bf16 a[108:111], v[80:83], v[36:39], a[108:111]
s_waitcnt lgkmcnt(13)
ds_read_b64_tr_b16 v[80:81], v2 offset:33032
ds_read_b64_tr_b16 v[82:83], v2 offset:33544
v_mfma_f32_16x16x32_bf16 a[112:115], v[84:87], v[36:39], a[112:115]
s_waitcnt lgkmcnt(13)
ds_read_b64_tr_b16 v[84:85], v1 offset:34048
ds_read_b64_tr_b16 v[86:87], v1 offset:34560
v_mfma_f32_16x16x32_bf16 a[116:119], v[88:91], v[36:39], a[116:119]
s_waitcnt lgkmcnt(13)
ds_read_b64_tr_b16 v[88:89], v1 offset:34056
ds_read_b64_tr_b16 v[90:91], v1 offset:34568
v_mfma_f32_16x16x32_bf16 a[120:123], v[92:95], v[36:39], a[120:123]
s_waitcnt lgkmcnt(13)
ds_read_b64_tr_b16 v[92:93], v2 offset:34048
ds_read_b64_tr_b16 v[94:95], v2 offset:34560
v_mfma_f32_16x16x32_bf16 a[124:127], v[96:99], v[36:39], a[124:127]
s_waitcnt vmcnt(8)
s_barrier
s_waitcnt lgkmcnt(12)
ds_read_b64_tr_b16 v[96:97], v2 offset:34056
ds_read_b64_tr_b16 v[98:99], v2 offset:34568
v_mfma_f32_16x16x32_bf16 a[0:3], v[68:71], v[44:47], a[0:3]
s_waitcnt lgkmcnt(12)
ds_read_b64_tr_b16 v[68:69], v1 offset:41280
ds_read_b64_tr_b16 v[70:71], v1 offset:41792
s_add_u32 m0, s76, 16512
s_add_u32 s60, s60, 256
v_mfma_f32_16x16x32_bf16 a[4:7], v[72:75], v[44:47], a[4:7]
s_waitcnt lgkmcnt(12)
ds_read_b64_tr_b16 v[72:73], v1 offset:41288
ds_read_b64_tr_b16 v[74:75], v1 offset:41800
s_add_u32 s68, s68, 256
buffer_load_dwordx4 v54, s[40:43], s60 offen offset:0 lds
v_mfma_f32_16x16x32_bf16 a[8:11], v[76:79], v[44:47], a[8:11]
s_waitcnt lgkmcnt(12)
ds_read_b64_tr_b16 v[76:77], v2 offset:41280
ds_read_b64_tr_b16 v[78:79], v2 offset:41792
buffer_load_dwordx4 v54, s[40:43], s68 offen offset:1024 lds
s_add_u32 m0, s76, 24768
v_mfma_f32_16x16x32_bf16 a[12:15], v[80:83], v[44:47], a[12:15]
s_waitcnt lgkmcnt(12)
ds_read_b64_tr_b16 v[80:81], v2 offset:41288
ds_read_b64_tr_b16 v[82:83], v2 offset:41800
s_add_u32 s60, s60, 256
s_add_u32 s68, s68, 256
v_mfma_f32_16x16x32_bf16 a[16:19], v[84:87], v[44:47], a[16:19]
s_waitcnt lgkmcnt(12)
ds_read_b64_tr_b16 v[84:85], v1 offset:42304
ds_read_b64_tr_b16 v[86:87], v1 offset:42816
buffer_load_dwordx4 v54, s[40:43], s60 offen offset:0 lds
buffer_load_dwordx4 v54, s[40:43], s68 offen offset:1024 lds
v_mfma_f32_16x16x32_bf16 a[20:23], v[88:91], v[44:47], a[20:23]
s_waitcnt lgkmcnt(12)
ds_read_b64_tr_b16 v[88:89], v1 offset:42312
ds_read_b64_tr_b16 v[90:91], v1 offset:42824
v_mfma_f32_16x16x32_bf16 a[24:27], v[92:95], v[44:47], a[24:27]
s_waitcnt lgkmcnt(12)
ds_read_b64_tr_b16 v[92:93], v2 offset:42304
ds_read_b64_tr_b16 v[94:95], v2 offset:42816
v_mfma_f32_16x16x32_bf16 a[28:31], v[96:99], v[44:47], a[28:31]
s_waitcnt lgkmcnt(12)
ds_read_b64_tr_b16 v[96:97], v2 offset:42312
ds_read_b64_tr_b16 v[98:99], v2 offset:42824
v_mfma_f32_16x16x32_bf16 a[32:35], v[68:71], v[44:47], a[32:35]
s_waitcnt lgkmcnt(12)
ds_read_b64_tr_b16 v[68:69], v1 offset:49536
ds_read_b64_tr_b16 v[70:71], v1 offset:50048
v_mfma_f32_16x16x32_bf16 a[36:39], v[72:75], v[44:47], a[36:39]
s_waitcnt lgkmcnt(12)
ds_read_b64_tr_b16 v[72:73], v1 offset:49544
ds_read_b64_tr_b16 v[74:75], v1 offset:50056
v_mfma_f32_16x16x32_bf16 a[40:43], v[76:79], v[44:47], a[40:43]
s_waitcnt lgkmcnt(12)
ds_read_b64_tr_b16 v[76:77], v2 offset:49536
ds_read_b64_tr_b16 v[78:79], v2 offset:50048
v_mfma_f32_16x16x32_bf16 a[44:47], v[80:83], v[44:47], a[44:47]
s_waitcnt lgkmcnt(12)
ds_read_b64_tr_b16 v[80:81], v2 offset:49544
ds_read_b64_tr_b16 v[82:83], v2 offset:50056
v_mfma_f32_16x16x32_bf16 a[48:51], v[84:87], v[44:47], a[48:51]
s_waitcnt lgkmcnt(12)
ds_read_b64_tr_b16 v[84:85], v1 offset:50560
ds_read_b64_tr_b16 v[86:87], v1 offset:51072
v_mfma_f32_16x16x32_bf16 a[52:55], v[88:91], v[44:47], a[52:55]
s_waitcnt lgkmcnt(12)
ds_read_b64_tr_b16 v[88:89], v1 offset:50568
ds_read_b64_tr_b16 v[90:91], v1 offset:51080
v_mfma_f32_16x16x32_bf16 a[56:59], v[92:95], v[44:47], a[56:59]
s_waitcnt lgkmcnt(12)
ds_read_b64_tr_b16 v[92:93], v2 offset:50560
ds_read_b64_tr_b16 v[94:95], v2 offset:51072
v_mfma_f32_16x16x32_bf16 a[60:63], v[96:99], v[44:47], a[60:63]
s_waitcnt vmcnt(4)
s_barrier
s_waitcnt lgkmcnt(12)
ds_read_b64_tr_b16 v[96:97], v2 offset:50568
ds_read_b64_tr_b16 v[98:99], v2 offset:51080
v_mfma_f32_16x16x32_bf16 a[64:67], v[68:71], v[44:47], a[64:67]
s_waitcnt lgkmcnt(12)
ds_read_b64_tr_b16 v[68:69], v1 offset:57792
ds_read_b64_tr_b16 v[70:71], v1 offset:58304
s_add_u32 m0, s76, 33024
s_add_u32 s60, s60, 261376
v_mfma_f32_16x16x32_bf16 a[68:71], v[72:75], v[44:47], a[68:71]
s_waitcnt lgkmcnt(12)
ds_read_b64_tr_b16 v[72:73], v1 offset:57800
ds_read_b64_tr_b16 v[74:75], v1 offset:58312
s_add_u32 s68, s68, 261376
buffer_load_dwordx4 v54, s[40:43], s60 offen offset:0 lds
v_mfma_f32_16x16x32_bf16 a[72:75], v[76:79], v[44:47], a[72:75]
s_waitcnt lgkmcnt(12)
ds_read_b64_tr_b16 v[76:77], v2 offset:57792
ds_read_b64_tr_b16 v[78:79], v2 offset:58304
buffer_load_dwordx4 v54, s[40:43], s68 offen offset:1024 lds
s_add_u32 m0, s76, 41280
v_mfma_f32_16x16x32_bf16 a[76:79], v[80:83], v[44:47], a[76:79]
s_waitcnt lgkmcnt(12)
ds_read_b64_tr_b16 v[80:81], v2 offset:57800
ds_read_b64_tr_b16 v[82:83], v2 offset:58312
s_add_u32 s60, s60, 256
s_add_u32 s68, s68, 256
v_mfma_f32_16x16x32_bf16 a[80:83], v[84:87], v[44:47], a[80:83]
s_waitcnt lgkmcnt(12)
ds_read_b64_tr_b16 v[84:85], v1 offset:58816
ds_read_b64_tr_b16 v[86:87], v1 offset:59328
buffer_load_dwordx4 v54, s[40:43], s60 offen offset:0 lds
buffer_load_dwordx4 v54, s[40:43], s68 offen offset:1024 lds
v_mfma_f32_16x16x32_bf16 a[84:87], v[88:91], v[44:47], a[84:87]
s_waitcnt lgkmcnt(12)
ds_read_b64_tr_b16 v[88:89], v1 offset:58824
ds_read_b64_tr_b16 v[90:91], v1 offset:59336
v_mfma_f32_16x16x32_bf16 a[88:91], v[92:95], v[44:47], a[88:91]
s_waitcnt lgkmcnt(12)
ds_read_b64_tr_b16 v[92:93], v2 offset:58816
ds_read_b64_tr_b16 v[94:95], v2 offset:59328
v_mfma_f32_16x16x32_bf16 a[92:95], v[96:99], v[44:47], a[92:95]
s_waitcnt lgkmcnt(12)
ds_read_b64_tr_b16 v[96:97], v2 offset:58824
ds_read_b64_tr_b16 v[98:99], v2 offset:59336
v_mfma_f32_16x16x32_bf16 a[96:99], v[68:71], v[44:47], a[96:99]
s_waitcnt lgkmcnt(12)
ds_read_b128 v[36:39], v4 offset:0
ds_read_b64_tr_b16 v[68:69], v1 offset:0
ds_read_b64_tr_b16 v[70:71], v1 offset:512
v_mfma_f32_16x16x32_bf16 a[100:103], v[72:75], v[44:47], a[100:103]
s_waitcnt lgkmcnt(13)
ds_read_b64_tr_b16 v[72:73], v1 offset:8
ds_read_b64_tr_b16 v[74:75], v1 offset:520
v_mfma_f32_16x16x32_bf16 a[104:107], v[76:79], v[44:47], a[104:107]
s_waitcnt lgkmcnt(13)
ds_read_b64_tr_b16 v[76:77], v2 offset:0
ds_read_b64_tr_b16 v[78:79], v2 offset:512
v_mfma_f32_16x16x32_bf16 a[108:111], v[80:83], v[44:47], a[108:111]
s_waitcnt lgkmcnt(13)
ds_read_b64_tr_b16 v[80:81], v2 offset:8
ds_read_b64_tr_b16 v[82:83], v2 offset:520
v_mfma_f32_16x16x32_bf16 a[112:115], v[84:87], v[44:47], a[112:115]
s_waitcnt lgkmcnt(13)
ds_read_b64_tr_b16 v[84:85], v1 offset:1024
ds_read_b64_tr_b16 v[86:87], v1 offset:1536
v_mfma_f32_16x16x32_bf16 a[116:119], v[88:91], v[44:47], a[116:119]
s_waitcnt lgkmcnt(13)
ds_read_b64_tr_b16 v[88:89], v1 offset:1032
ds_read_b64_tr_b16 v[90:91], v1 offset:1544
v_mfma_f32_16x16x32_bf16 a[120:123], v[92:95], v[44:47], a[120:123]
s_waitcnt lgkmcnt(13)
ds_read_b64_tr_b16 v[92:93], v2 offset:1024
ds_read_b64_tr_b16 v[94:95], v2 offset:1536
v_mfma_f32_16x16x32_bf16 a[124:127], v[96:99], v[44:47], a[124:127]
s_waitcnt vmcnt(4)
s_barrier
s_waitcnt lgkmcnt(12)
ds_read_b64_tr_b16 v[96:97], v2 offset:1032
ds_read_b64_tr_b16 v[98:99], v2 offset:1544
v_mfma_f32_16x16x32_bf16 a[0:3], v[68:71], v[36:39], a[0:3]
s_waitcnt lgkmcnt(12)
ds_read_b64_tr_b16 v[68:69], v1 offset:8256
ds_read_b64_tr_b16 v[70:71], v1 offset:8768
s_add_u32 m0, s76, 49536
s_add_u32 s60, s60, 256
v_mfma_f32_16x16x32_bf16 a[4:7], v[72:75], v[36:39], a[4:7]
s_waitcnt lgkmcnt(12)
ds_read_b64_tr_b16 v[72:73], v1 offset:8264
ds_read_b64_tr_b16 v[74:75], v1 offset:8776
s_add_u32 s68, s68, 256
buffer_load_dwordx4 v54, s[40:43], s60 offen offset:0 lds
v_mfma_f32_16x16x32_bf16 a[8:11], v[76:79], v[36:39], a[8:11]
s_waitcnt lgkmcnt(12)
ds_read_b64_tr_b16 v[76:77], v2 offset:8256
ds_read_b64_tr_b16 v[78:79], v2 offset:8768
buffer_load_dwordx4 v54, s[40:43], s68 offen offset:1024 lds
s_add_u32 m0, s76, 57792
v_mfma_f32_16x16x32_bf16 a[12:15], v[80:83], v[36:39], a[12:15]
s_waitcnt lgkmcnt(12)
ds_read_b64_tr_b16 v[80:81], v2 offset:8264
ds_read_b64_tr_b16 v[82:83], v2 offset:8776
s_add_u32 s60, s60, 256
s_add_u32 s68, s68, 256
v_mfma_f32_16x16x32_bf16 a[16:19], v[84:87], v[36:39], a[16:19]
s_waitcnt lgkmcnt(12)
ds_read_b64_tr_b16 v[84:85], v1 offset:9280
ds_read_b64_tr_b16 v[86:87], v1 offset:9792
buffer_load_dwordx4 v54, s[40:43], s60 offen offset:0 lds
buffer_load_dwordx4 v54, s[40:43], s68 offen offset:1024 lds
v_mfma_f32_16x16x32_bf16 a[20:23], v[88:91], v[36:39], a[20:23]
s_waitcnt lgkmcnt(12)
ds_read_b64_tr_b16 v[88:89], v1 offset:9288
ds_read_b64_tr_b16 v[90:91], v1 offset:9800
s_add_u32 m0, s77, 83456
s_add_u32 s61, s61, 128
v_mfma_f32_16x16x32_bf16 a[24:27], v[92:95], v[36:39], a[24:27]
s_waitcnt lgkmcnt(12)
ds_read_b64_tr_b16 v[92:93], v2 offset:9280
ds_read_b64_tr_b16 v[94:95], v2 offset:9792
buffer_load_dwordx4 v55, s[44:47], s61 offen offset:0 lds
buffer_load_dwordx4 v56, s[44:47], s61 offen offset:1088 lds
v_mfma_f32_16x16x32_bf16 a[28:31], v[96:99], v[36:39], a[28:31]
s_waitcnt lgkmcnt(12)
ds_read_b64_tr_b16 v[96:97], v2 offset:9288
ds_read_b64_tr_b16 v[98:99], v2 offset:9800
buffer_load_dwordx4 v57, s[44:47], s61 offen offset:2176 lds
buffer_load_dwordx4 v58, s[44:47], s61 offen offset:3264 lds
v_mfma_f32_16x16x32_bf16 a[32:35], v[68:71], v[36:39], a[32:35]
s_waitcnt lgkmcnt(12)
ds_read_b64_tr_b16 v[68:69], v1 offset:16512
ds_read_b64_tr_b16 v[70:71], v1 offset:17024
v_mfma_f32_16x16x32_bf16 a[36:39], v[72:75], v[36:39], a[36:39]
s_waitcnt lgkmcnt(12)
ds_read_b64_tr_b16 v[72:73], v1 offset:16520
ds_read_b64_tr_b16 v[74:75], v1 offset:17032
v_mfma_f32_16x16x32_bf16 a[40:43], v[76:79], v[36:39], a[40:43]
s_waitcnt lgkmcnt(12)
ds_read_b64_tr_b16 v[76:77], v2 offset:16512
ds_read_b64_tr_b16 v[78:79], v2 offset:17024
v_mfma_f32_16x16x32_bf16 a[44:47], v[80:83], v[36:39], a[44:47]
s_waitcnt lgkmcnt(12)
ds_read_b64_tr_b16 v[80:81], v2 offset:16520
ds_read_b64_tr_b16 v[82:83], v2 offset:17032
v_mfma_f32_16x16x32_bf16 a[48:51], v[84:87], v[36:39], a[48:51]
s_waitcnt lgkmcnt(12)
ds_read_b64_tr_b16 v[84:85], v1 offset:17536
ds_read_b64_tr_b16 v[86:87], v1 offset:18048
v_mfma_f32_16x16x32_bf16 a[52:55], v[88:91], v[36:39], a[52:55]
s_waitcnt lgkmcnt(12)
ds_read_b64_tr_b16 v[88:89], v1 offset:17544
ds_read_b64_tr_b16 v[90:91], v1 offset:18056
v_mfma_f32_16x16x32_bf16 a[56:59], v[92:95], v[36:39], a[56:59]
s_waitcnt lgkmcnt(12)
ds_read_b64_tr_b16 v[92:93], v2 offset:17536
ds_read_b64_tr_b16 v[94:95], v2 offset:18048
v_mfma_f32_16x16x32_bf16 a[60:63], v[96:99], v[36:39], a[60:63]
s_sub_u32 s39, s39, 1
s_cmp_lg_u32 s39, 0
s_cbranch_scc1 L_loop4
s_waitcnt vmcnt(8)
s_barrier
s_waitcnt lgkmcnt(12)
ds_read_b64_tr_b16 v[96:97], v2 offset:17544
ds_read_b64_tr_b16 v[98:99], v2 offset:18056
v_mfma_f32_16x16x32_bf16 a[64:67], v[68:71], v[36:39], a[64:67]
s_waitcnt lgkmcnt(12)
ds_read_b64_tr_b16 v[68:69], v1 offset:24768
ds_read_b64_tr_b16 v[70:71], v1 offset:25280
s_add_u32 m0, s76, 0
s_add_u32 s60, s60, 261376
v_mfma_f32_16x16x32_bf16 a[68:71], v[72:75], v[36:39], a[68:71]
s_waitcnt lgkmcnt(12)
ds_read_b64_tr_b16 v[72:73], v1 offset:24776
ds_read_b64_tr_b16 v[74:75], v1 offset:25288
s_add_u32 s68, s68, 261376
buffer_load_dwordx4 v54, s[40:43], s60 offen offset:0 lds
v_mfma_f32_16x16x32_bf16 a[72:75], v[76:79], v[36:39], a[72:75]
s_waitcnt lgkmcnt(12)
ds_read_b64_tr_b16 v[76:77], v2 offset:24768
ds_read_b64_tr_b16 v[78:79], v2 offset:25280
buffer_load_dwordx4 v54, s[40:43], s68 offen offset:1024 lds
s_add_u32 m0, s76, 8256
v_mfma_f32_16x16x32_bf16 a[76:79], v[80:83], v[36:39], a[76:79]
s_waitcnt lgkmcnt(12)
ds_read_b64_tr_b16 v[80:81], v2 offset:24776
ds_read_b64_tr_b16 v[82:83], v2 offset:25288
s_add_u32 s60, s60, 256
s_add_u32 s68, s68, 256
v_mfma_f32_16x16x32_bf16 a[80:83], v[84:87], v[36:39], a[80:83]
s_waitcnt lgkmcnt(12)
ds_read_b64_tr_b16 v[84:85], v1 offset:25792
ds_read_b64_tr_b16 v[86:87], v1 offset:26304
buffer_load_dwordx4 v54, s[40:43], s60 offen offset:0 lds
buffer_load_dwordx4 v54, s[40:43], s68 offen offset:1024 lds
v_mfma_f32_16x16x32_bf16 a[84:87], v[88:91], v[36:39], a[84:87]
s_waitcnt lgkmcnt(12)
ds_read_b64_tr_b16 v[88:89], v1 offset:25800
ds_read_b64_tr_b16 v[90:91], v1 offset:26312
v_mfma_f32_16x16x32_bf16 a[88:91], v[92:95], v[36:39], a[88:91]
s_waitcnt lgkmcnt(12)
ds_read_b64_tr_b16 v[92:93], v2 offset:25792
ds_read_b64_tr_b16 v[94:95], v2 offset:26304
v_mfma_f32_16x16x32_bf16 a[92:95], v[96:99], v[36:39], a[92:95]
s_waitcnt lgkmcnt(12)
ds_read_b64_tr_b16 v[96:97], v2 offset:25800
ds_read_b64_tr_b16 v[98:99], v2 offset:26312
v_mfma_f32_16x16x32_bf16 a[96:99], v[68:71], v[36:39], a[96:99]
s_waitcnt lgkmcnt(12)
ds_read_b128 v[44:47], v4 offset:64
ds_read_b64_tr_b16 v[68:69], v1 offset:33024
ds_read_b64_tr_b16 v[70:71], v1 offset:33536
v_mfma_f32_16x16x32_bf16 a[100:103], v[72:75], v[36:39], a[100:103]
s_waitcnt lgkmcnt(13)
ds_read_b64_tr_b16 v[72:73], v1 offset:33032
ds_read_b64_tr_b16 v[74:75], v1 offset:33544
v_mfma_f32_16x16x32_bf16 a[104:107], v[76:79], v[36:39], a[104:107]
s_waitcnt lgkmcnt(13)
ds_read_b64_tr_b16 v[76:77], v2 offset:33024
ds_read_b64_tr_b16 v[78:79], v2 offset:33536
v_mfma_f32_16x16x32_bf16 a[108:111], v[80:83], v[36:39], a[108:111]
s_waitcnt lgkmcnt(13)
ds_read_b64_tr_b16 v[80:81], v2 offset:33032
ds_read_b64_tr_b16 v[82:83], v2 offset:33544
v_mfma_f32_16x16x32_bf16 a[112:115], v[84:87], v[36:39], a[112:115]
s_waitcnt lgkmcnt(13)
ds_read_b64_tr_b16 v[84:85], v1 offset:34048
ds_read_b64_tr_b16 v[86:87], v1 offset:34560
v_mfma_f32_16x16x32_bf16 a[116:119], v[88:91], v[36:39], a[116:119]
s_waitcnt lgkmcnt(13)
ds_read_b64_tr_b16 v[88:89], v1 offset:34056
ds_read_b64_tr_b16 v[90:91], v1 offset:34568
v_mfma_f32_16x16x32_bf16 a[120:123], v[92:95], v[36:39], a[120:123]
s_waitcnt lgkmcnt(13)
ds_read_b64_tr_b16 v[92:93], v2 offset:34048
ds_read_b64_tr_b16 v[94:95], v2 offset:34560
v_mfma_f32_16x16x32_bf16 a[124:127], v[96:99], v[36:39], a[124:127]
s_waitcnt vmcnt(8)
s_barrier
s_waitcnt lgkmcnt(12)
ds_read_b64_tr_b16 v[96:97], v2 offset:34056
ds_read_b64_tr_b16 v[98:99], v2 offset:34568
v_mfma_f32_16x16x32_bf16 a[0:3], v[68:71], v[44:47], a[0:3]
s_waitcnt lgkmcnt(12)
ds_read_b64_tr_b16 v[68:69], v1 offset:41280
ds_read_b64_tr_b16 v[70:71], v1 offset:41792
s_add_u32 m0, s76, 16512
s_add_u32 s60, s60, 256
v_mfma_f32_16x16x32_bf16 a[4:7], v[72:75], v[44:47], a[4:7]
s_waitcnt lgkmcnt(12)
ds_read_b64_tr_b16 v[72:73], v1 offset:41288
ds_read_b64_tr_b16 v[74:75], v1 offset:41800
s_add_u32 s68, s68, 256
buffer_load_dwordx4 v54, s[40:43], s60 offen offset:0 lds
v_mfma_f32_16x16x32_bf16 a[8:11], v[76:79], v[44:47], a[8:11]
s_waitcnt lgkmcnt(12)
ds_read_b64_tr_b16 v[76:77], v2 offset:41280
ds_read_b64_tr_b16 v[78:79], v2 offset:41792
buffer_load_dwordx4 v54, s[40:43], s68 offen offset:1024 lds
s_add_u32 m0, s76, 24768
v_mfma_f32_16x16x32_bf16 a[12:15], v[80:83], v[44:47], a[12:15]
s_waitcnt lgkmcnt(12)
ds_read_b64_tr_b16 v[80:81], v2 offset:41288
ds_read_b64_tr_b16 v[82:83], v2 offset:41800
s_add_u32 s60, s60, 256
s_add_u32 s68, s68, 256
v_mfma_f32_16x16x32_bf16 a[16:19], v[84:87], v[44:47], a[16:19]
s_waitcnt lgkmcnt(12)
ds_read_b64_tr_b16 v[84:85], v1 offset:42304
ds_read_b64_tr_b16 v[86:87], v1 offset:42816
buffer_load_dwordx4 v54, s[40:43], s60 offen offset:0 lds
buffer_load_dwordx4 v54, s[40:43], s68 offen offset:1024 lds
v_mfma_f32_16x16x32_bf16 a[20:23], v[88:91], v[44:47], a[20:23]
s_waitcnt lgkmcnt(12)
ds_read_b64_tr_b16 v[88:89], v1 offset:42312
ds_read_b64_tr_b16 v[90:91], v1 offset:42824
v_mfma_f32_16x16x32_bf16 a[24:27], v[92:95], v[44:47], a[24:27]
s_waitcnt lgkmcnt(12)
ds_read_b64_tr_b16 v[92:93], v2 offset:42304
ds_read_b64_tr_b16 v[94:95], v2 offset:42816
v_mfma_f32_16x16x32_bf16 a[28:31], v[96:99], v[44:47], a[28:31]
s_waitcnt lgkmcnt(12)
ds_read_b64_tr_b16 v[96:97], v2 offset:42312
ds_read_b64_tr_b16 v[98:99], v2 offset:42824
v_mfma_f32_16x16x32_bf16 a[32:35], v[68:71], v[44:47], a[32:35]
s_waitcnt lgkmcnt(12)
ds_read_b64_tr_b16 v[68:69], v1 offset:49536
ds_read_b64_tr_b16 v[70:71], v1 offset:50048
v_mfma_f32_16x16x32_bf16 a[36:39], v[72:75], v[44:47], a[36:39]
s_waitcnt lgkmcnt(12)
ds_read_b64_tr_b16 v[72:73], v1 offset:49544
ds_read_b64_tr_b16 v[74:75], v1 offset:50056
v_mfma_f32_16x16x32_bf16 a[40:43], v[76:79], v[44:47], a[40:43]
s_waitcnt lgkmcnt(12)
ds_read_b64_tr_b16 v[76:77], v2 offset:49536
ds_read_b64_tr_b16 v[78:79], v2 offset:50048
v_mfma_f32_16x16x32_bf16 a[44:47], v[80:83], v[44:47], a[44:47]
s_waitcnt lgkmcnt(12)
ds_read_b64_tr_b16 v[80:81], v2 offset:49544
ds_read_b64_tr_b16 v[82:83], v2 offset:50056
v_mfma_f32_16x16x32_bf16 a[48:51], v[84:87], v[44:47], a[48:51]
s_waitcnt lgkmcnt(12)
ds_read_b64_tr_b16 v[84:85], v1 offset:50560
ds_read_b64_tr_b16 v[86:87], v1 offset:51072
v_mfma_f32_16x16x32_bf16 a[52:55], v[88:91], v[44:47], a[52:55]
s_waitcnt lgkmcnt(12)
ds_read_b64_tr_b16 v[88:89], v1 offset:50568
ds_read_b64_tr_b16 v[90:91], v1 offset:51080
v_mfma_f32_16x16x32_bf16 a[56:59], v[92:95], v[44:47], a[56:59]
s_waitcnt lgkmcnt(12)
ds_read_b64_tr_b16 v[92:93], v2 offset:50560
ds_read_b64_tr_b16 v[94:95], v2 offset:51072
v_mfma_f32_16x16x32_bf16 a[60:63], v[96:99], v[44:47], a[60:63]
s_barrier
s_waitcnt lgkmcnt(12)
ds_read_b64_tr_b16 v[96:97], v2 offset:50568
ds_read_b64_tr_b16 v[98:99], v2 offset:51080
v_mfma_f32_16x16x32_bf16 a[64:67], v[68:71], v[44:47], a[64:67]
s_waitcnt lgkmcnt(12)
ds_read_b64_tr_b16 v[68:69], v1 offset:57792
ds_read_b64_tr_b16 v[70:71], v1 offset:58304
s_add_u32 m0, s76, 33024
s_add_u32 s60, s60, 261376
v_mfma_f32_16x16x32_bf16 a[68:71], v[72:75], v[44:47], a[68:71]
s_waitcnt lgkmcnt(12)
ds_read_b64_tr_b16 v[72:73], v1 offset:57800
ds_read_b64_tr_b16 v[74:75], v1 offset:58312
s_add_u32 s68, s68, 261376
buffer_load_dwordx4 v54, s[40:43], s60 offen offset:0 lds
v_mfma_f32_16x16x32_bf16 a[72:75], v[76:79], v[44:47], a[72:75]
s_waitcnt lgkmcnt(12)
ds_read_b64_tr_b16 v[76:77], v2 offset:57792
ds_read_b64_tr_b16 v[78:79], v2 offset:58304
buffer_load_dwordx4 v54, s[40:43], s68 offen offset:1024 lds
s_add_u32 m0, s76, 41280
v_mfma_f32_16x16x32_bf16 a[76:79], v[80:83], v[44:47], a[76:79]
s_waitcnt lgkmcnt(12)
ds_read_b64_tr_b16 v[80:81], v2 offset:57800
ds_read_b64_tr_b16 v[82:83], v2 offset:58312
s_add_u32 s60, s60, 256
s_add_u32 s68, s68, 256
v_mfma_f32_16x16x32_bf16 a[80:83], v[84:87], v[44:47], a[80:83]
s_waitcnt lgkmcnt(12)
ds_read_b64_tr_b16 v[84:85], v1 offset:58816
ds_read_b64_tr_b16 v[86:87], v1 offset:59328
buffer_load_dwordx4 v54, s[40:43], s60 offen offset:0 lds
buffer_load_dwordx4 v54, s[40:43], s68 offen offset:1024 lds
v_mfma_f32_16x16x32_bf16 a[84:87], v[88:91], v[44:47], a[84:87]
s_waitcnt lgkmcnt(12)
ds_read_b64_tr_b16 v[88:89], v1 offset:58824
ds_read_b64_tr_b16 v[90:91], v1 offset:59336
v_mfma_f32_16x16x32_bf16 a[88:91], v[92:95], v[44:47], a[88:91]
s_waitcnt lgkmcnt(12)
ds_read_b64_tr_b16 v[92:93], v2 offset:58816
ds_read_b64_tr_b16 v[94:95], v2 offset:59328
v_mfma_f32_16x16x32_bf16 a[92:95], v[96:99], v[44:47], a[92:95]
s_waitcnt lgkmcnt(12)
ds_read_b64_tr_b16 v[96:97], v2 offset:58824
ds_read_b64_tr_b16 v[98:99], v2 offset:59336
v_mfma_f32_16x16x32_bf16 a[96:99], v[68:71], v[44:47], a[96:99]
s_waitcnt lgkmcnt(12)
v_mfma_f32_16x16x32_bf16 a[100:103], v[72:75], v[44:47], a[100:103]
s_waitcnt lgkmcnt(10)
v_mfma_f32_16x16x32_bf16 a[104:107], v[76:79], v[44:47], a[104:107]
s_waitcnt lgkmcnt(8)
v_mfma_f32_16x16x32_bf16 a[108:111], v[80:83], v[44:47], a[108:111]
s_waitcnt lgkmcnt(6)
v_mfma_f32_16x16x32_bf16 a[112:115], v[84:87], v[44:47], a[112:115]
s_waitcnt lgkmcnt(4)
v_mfma_f32_16x16x32_bf16 a[116:119], v[88:91], v[44:47], a[116:119]
s_waitcnt lgkmcnt(2)
v_mfma_f32_16x16x32_bf16 a[120:123], v[92:95], v[44:47], a[120:123]
s_waitcnt lgkmcnt(0)
v_mfma_f32_16x16x32_bf16 a[124:127], v[96:99], v[44:47], a[124:127]
s_waitcnt vmcnt(0) lgkmcnt(0)
s_barrier
s_add_u32 m0, s69, 33024
s_nop 0
buffer_load_dwordx4 v7, s[80:83], s64 offen offset:0 nt lds
buffer_load_dwordx4 v7, s[80:83], s66 offen offset:1024 nt lds
s_add_u32 m0, s69, 41280
s_add_u32 s64, s64, 8192
s_add_u32 s66, s66, 8192
buffer_load_dwordx4 v7, s[80:83], s64 offen offset:0 nt lds
buffer_load_dwordx4 v7, s[80:83], s66 offen offset:1024 nt lds
s_add_u32 m0, s76, 0
s_nop 0
buffer_load_dwordx4 v8, s[92:95], s65 offen offset:0 nt lds
buffer_load_dwordx4 v8, s[92:95], s67 offen offset:1024 nt lds
s_add_u32 m0, s69, 49536
s_add_u32 s64, s64, 8192
s_add_u32 s66, s66, 8192
buffer_load_dwordx4 v7, s[80:83], s64 offen offset:0 nt lds
buffer_load_dwordx4 v7, s[80:83], s66 offen offset:1024 nt lds
s_add_u32 m0, s76, 8256
s_add_u32 s65, s65, 8192
s_add_u32 s67, s67, 8192
buffer_load_dwordx4 v8, s[92:95], s65 offen offset:0 nt lds
buffer_load_dwordx4 v8, s[92:95], s67 offen offset:1024 nt lds
s_add_u32 m0, s69, 57792
s_add_u32 s64, s64, 8192
s_add_u32 s66, s66, 8192
buffer_load_dwordx4 v7, s[80:83], s64 offen offset:0 nt lds
buffer_load_dwordx4 v7, s[80:83], s66 offen offset:1024 nt lds
v_mov_b32 v4, v63
s_add_u32 m0, s78, 66048
s_nop 0
buffer_load_dwordx4 v4, s[48:51], s62 offen offset:0 nt lds
s_add_u32 m0, s78, 70400
s_add_u32 s62, s62, 128
buffer_load_dwordx4 v4, s[48:51], s62 offen offset:0 nt lds
s_add_u32 m0, s78, 83456
s_add_u32 s62, s62, 128
buffer_load_dwordx4 v4, s[48:51], s62 offen offset:0 nt lds
s_add_u32 m0, s78, 87808
s_add_u32 s62, s62, 128
buffer_load_dwordx4 v4, s[48:51], s62 offen offset:0 nt lds
s_add_u32 m0, s78, 118272
s_add_u32 s62, s62, 128
buffer_load_dwordx4 v4, s[48:51], s62 offen offset:0 nt lds
s_add_u32 m0, s78, 122624
s_add_u32 s62, s62, 128
buffer_load_dwordx4 v4, s[48:51], s62 offen offset:0 nt lds
s_nop 7
v_mbcnt_lo_u32_b32 v15, -1, 0
v_mbcnt_hi_u32_b32 v15, -1, v15
v_accvgpr_read_b32 v68, a0
v_accvgpr_read_b32 v69, a1
v_accvgpr_read_b32 v70, a2
v_accvgpr_read_b32 v71, a3
v_accvgpr_write_b32 a0, 0
v_accvgpr_write_b32 a1, 0
v_accvgpr_write_b32 a2, 0
v_accvgpr_write_b32 a3, 0
v_pk_mul_f32 v[68:69], v[68:69], s[26:27]
v_pk_mul_f32 v[70:71], v[70:71], s[26:27]
v_cvt_pk_bf16_f32 v164, v68, v69
v_cvt_pk_bf16_f32 v165, v70, v71
v_accvgpr_read_b32 v72, a4
v_accvgpr_read_b32 v73, a5
v_accvgpr_read_b32 v74, a6
v_accvgpr_read_b32 v75, a7
v_accvgpr_write_b32 a4, 0
v_accvgpr_write_b32 a5, 0
v_accvgpr_write_b32 a6, 0
v_accvgpr_write_b32 a7, 0
v_pk_mul_f32 v[72:73], v[72:73], s[26:27]
v_pk_mul_f32 v[74:75], v[74:75], s[26:27]
v_cvt_pk_bf16_f32 v166, v72, v73
v_cvt_pk_bf16_f32 v167, v74, v75
v_accvgpr_read_b32 v84, a8
v_accvgpr_read_b32 v85, a9
v_accvgpr_read_b32 v86, a10
v_accvgpr_read_b32 v87, a11
v_accvgpr_write_b32 a8, 0
v_accvgpr_write_b32 a9, 0
v_accvgpr_write_b32 a10, 0
v_accvgpr_write_b32 a11, 0
v_pk_mul_f32 v[84:85], v[84:85], s[26:27]
v_pk_mul_f32 v[86:87], v[86:87], s[26:27]
v_cvt_pk_bf16_f32 v172, v84, v85
v_cvt_pk_bf16_f32 v173, v86, v87
v_accvgpr_read_b32 v88, a12
v_accvgpr_read_b32 v89, a13
v_accvgpr_read_b32 v90, a14
v_accvgpr_read_b32 v91, a15
v_accvgpr_write_b32 a12, 0
v_accvgpr_write_b32 a13, 0
v_accvgpr_write_b32 a14, 0
v_accvgpr_write_b32 a15, 0
v_pk_mul_f32 v[88:89], v[88:89], s[26:27]
v_pk_mul_f32 v[90:91], v[90:91], s[26:27]
v_cvt_pk_bf16_f32 v174, v88, v89
v_cvt_pk_bf16_f32 v175, v90, v91
v_accvgpr_read_b32 v100, a16
v_accvgpr_read_b32 v101, a17
v_accvgpr_read_b32 v102, a18
v_accvgpr_read_b32 v103, a19
v_accvgpr_write_b32 a16, 0
v_accvgpr_write_b32 a17, 0
v_accvgpr_write_b32 a18, 0
v_accvgpr_write_b32 a19, 0
v_pk_mul_f32 v[100:101], v[100:101], s[26:27]
v_pk_mul_f32 v[102:103], v[102:103], s[26:27]
v_cvt_pk_bf16_f32 v180, v100, v101
v_cvt_pk_bf16_f32 v181, v102, v103
v_accvgpr_read_b32 v104, a20
v_accvgpr_read_b32 v105, a21
v_accvgpr_read_b32 v106, a22
v_accvgpr_read_b32 v107, a23
v_accvgpr_write_b32 a20, 0
v_accvgpr_write_b32 a21, 0
v_accvgpr_write_b32 a22, 0
v_accvgpr_write_b32 a23, 0
v_pk_mul_f32 v[104:105], v[104:105], s[26:27]
v_pk_mul_f32 v[106:107], v[106:107], s[26:27]
v_cvt_pk_bf16_f32 v182, v104, v105
v_cvt_pk_bf16_f32 v183, v106, v107
v_accvgpr_read_b32 v116, a24
v_accvgpr_read_b32 v117, a25
v_accvgpr_read_b32 v118, a26
v_accvgpr_read_b32 v119, a27
v_accvgpr_write_b32 a24, 0
v_accvgpr_write_b32 a25, 0
v_accvgpr_write_b32 a26, 0
v_accvgpr_write_b32 a27, 0
v_pk_mul_f32 v[116:117], v[116:117], s[26:27]
v_pk_mul_f32 v[118:119], v[118:119], s[26:27]
v_cvt_pk_bf16_f32 v188, v116, v117
v_cvt_pk_bf16_f32 v189, v118, v119
v_accvgpr_read_b32 v120, a28
v_accvgpr_read_b32 v121, a29
v_accvgpr_read_b32 v122, a30
v_accvgpr_read_b32 v123, a31
v_accvgpr_write_b32 a28, 0
v_accvgpr_write_b32 a29, 0
v_accvgpr_write_b32 a30, 0
v_accvgpr_write_b32 a31, 0
v_pk_mul_f32 v[120:121], v[120:121], s[26:27]
v_pk_mul_f32 v[122:123], v[122:123], s[26:27]
v_cvt_pk_bf16_f32 v190, v120, v121
v_cvt_pk_bf16_f32 v191, v122, v123
v_accvgpr_read_b32 v68, a32
v_accvgpr_read_b32 v69, a33
v_accvgpr_read_b32 v70, a34
v_accvgpr_read_b32 v71, a35
v_accvgpr_write_b32 a32, 0
v_accvgpr_write_b32 a33, 0
v_accvgpr_write_b32 a34, 0
v_accvgpr_write_b32 a35, 0
v_pk_mul_f32 v[68:69], v[68:69], s[26:27]
v_pk_mul_f32 v[70:71], v[70:71], s[26:27]
v_cvt_pk_bf16_f32 v196, v68, v69
v_cvt_pk_bf16_f32 v197, v70, v71
v_accvgpr_read_b32 v72, a36
v_accvgpr_read_b32 v73, a37
v_accvgpr_read_b32 v74, a38
v_accvgpr_read_b32 v75, a39
v_accvgpr_write_b32 a36, 0
v_accvgpr_write_b32 a37, 0
v_accvgpr_write_b32 a38, 0
v_accvgpr_write_b32 a39, 0
v_pk_mul_f32 v[72:73], v[72:73], s[26:27]
v_pk_mul_f32 v[74:75], v[74:75], s[26:27]
v_cvt_pk_bf16_f32 v198, v72, v73
v_cvt_pk_bf16_f32 v199, v74, v75
v_accvgpr_read_b32 v84, a40
v_accvgpr_read_b32 v85, a41
v_accvgpr_read_b32 v86, a42
v_accvgpr_read_b32 v87, a43
v_accvgpr_write_b32 a40, 0
v_accvgpr_write_b32 a41, 0
v_accvgpr_write_b32 a42, 0
v_accvgpr_write_b32 a43, 0
v_pk_mul_f32 v[84:85], v[84:85], s[26:27]
v_pk_mul_f32 v[86:87], v[86:87], s[26:27]
v_cvt_pk_bf16_f32 v204, v84, v85
v_cvt_pk_bf16_f32 v205, v86, v87
v_accvgpr_read_b32 v88, a44
v_accvgpr_read_b32 v89, a45
v_accvgpr_read_b32 v90, a46
v_accvgpr_read_b32 v91, a47
v_accvgpr_write_b32 a44, 0
v_accvgpr_write_b32 a45, 0
v_accvgpr_write_b32 a46, 0
v_accvgpr_write_b32 a47, 0
v_pk_mul_f32 v[88:89], v[88:89], s[26:27]
v_pk_mul_f32 v[90:91], v[90:91], s[26:27]
v_cvt_pk_bf16_f32 v206, v88, v89
v_cvt_pk_bf16_f32 v207, v90, v91
v_accvgpr_read_b32 v100, a48
v_accvgpr_read_b32 v101, a49
v_accvgpr_read_b32 v102, a50
v_accvgpr_read_b32 v103, a51
v_accvgpr_write_b32 a48, 0
v_accvgpr_write_b32 a49, 0
v_accvgpr_write_b32 a50, 0
v_accvgpr_write_b32 a51, 0
v_pk_mul_f32 v[100:101], v[100:101], s[26:27]
v_pk_mul_f32 v[102:103], v[102:103], s[26:27]
v_cvt_pk_bf16_f32 v212, v100, v101
v_cvt_pk_bf16_f32 v213, v102, v103
v_accvgpr_read_b32 v104, a52
v_accvgpr_read_b32 v105, a53
v_accvgpr_read_b32 v106, a54
v_accvgpr_read_b32 v107, a55
v_accvgpr_write_b32 a52, 0
v_accvgpr_write_b32 a53, 0
v_accvgpr_write_b32 a54, 0
v_accvgpr_write_b32 a55, 0
v_pk_mul_f32 v[104:105], v[104:105], s[26:27]
v_pk_mul_f32 v[106:107], v[106:107], s[26:27]
v_cvt_pk_bf16_f32 v214, v104, v105
v_cvt_pk_bf16_f32 v215, v106, v107
v_accvgpr_read_b32 v116, a56
v_accvgpr_read_b32 v117, a57
v_accvgpr_read_b32 v118, a58
v_accvgpr_read_b32 v119, a59
v_accvgpr_write_b32 a56, 0
v_accvgpr_write_b32 a57, 0
v_accvgpr_write_b32 a58, 0
v_accvgpr_write_b32 a59, 0
v_pk_mul_f32 v[116:117], v[116:117], s[26:27]
v_pk_mul_f32 v[118:119], v[118:119], s[26:27]
v_cvt_pk_bf16_f32 v220, v116, v117
v_cvt_pk_bf16_f32 v221, v118, v119
v_accvgpr_read_b32 v120, a60
v_accvgpr_read_b32 v121, a61
v_accvgpr_read_b32 v122, a62
v_accvgpr_read_b32 v123, a63
v_accvgpr_write_b32 a60, 0
v_accvgpr_write_b32 a61, 0
v_accvgpr_write_b32 a62, 0
v_accvgpr_write_b32 a63, 0
v_pk_mul_f32 v[120:121], v[120:121], s[26:27]
v_pk_mul_f32 v[122:123], v[122:123], s[26:27]
v_cvt_pk_bf16_f32 v222, v120, v121
v_cvt_pk_bf16_f32 v223, v122, v123
buffer_store_dwordx4 v[196:199], v10, s[28:31], s38 offen offset:0 nt
buffer_store_dwordx4 v[204:207], v10, s[28:31], s38 offen offset:2048 nt
buffer_store_dwordx4 v[212:215], v10, s[28:31], s74 offen offset:0 nt
buffer_store_dwordx4 v[220:223], v10, s[28:31], s74 offen offset:2048 nt
s_add_u32 s38, s38, 8192
s_add_u32 s74, s74, 8192
v_accvgpr_read_b32 v68, a64
v_accvgpr_read_b32 v69, a65
v_accvgpr_read_b32 v70, a66
v_accvgpr_read_b32 v71, a67
v_accvgpr_write_b32 a64, 0
v_accvgpr_write_b32 a65, 0
v_accvgpr_write_b32 a66, 0
v_accvgpr_write_b32 a67, 0
v_pk_mul_f32 v[68:69], v[68:69], s[26:27]
v_pk_mul_f32 v[70:71], v[70:71], s[26:27]
v_cvt_pk_bf16_f32 v196, v68, v69
v_cvt_pk_bf16_f32 v197, v70, v71
v_accvgpr_read_b32 v72, a68
v_accvgpr_read_b32 v73, a69
v_accvgpr_read_b32 v74, a70
v_accvgpr_read_b32 v75, a71
v_accvgpr_write_b32 a68, 0
v_accvgpr_write_b32 a69, 0
v_accvgpr_write_b32 a70, 0
v_accvgpr_write_b32 a71, 0
v_pk_mul_f32 v[72:73], v[72:73], s[26:27]
v_pk_mul_f32 v[74:75], v[74:75], s[26:27]
v_cvt_pk_bf16_f32 v198, v72, v73
v_cvt_pk_bf16_f32 v199, v74, v75
v_accvgpr_read_b32 v84, a72
v_accvgpr_read_b32 v85, a73
v_accvgpr_read_b32 v86, a74
v_accvgpr_read_b32 v87, a75
v_accvgpr_write_b32 a72, 0
v_accvgpr_write_b32 a73, 0
v_accvgpr_write_b32 a74, 0
v_accvgpr_write_b32 a75, 0
v_pk_mul_f32 v[84:85], v[84:85], s[26:27]
v_pk_mul_f32 v[86:87], v[86:87], s[26:27]
v_cvt_pk_bf16_f32 v204, v84, v85
v_cvt_pk_bf16_f32 v205, v86, v87
v_accvgpr_read_b32 v88, a76
v_accvgpr_read_b32 v89, a77
v_accvgpr_read_b32 v90, a78
v_accvgpr_read_b32 v91, a79
v_accvgpr_write_b32 a76, 0
v_accvgpr_write_b32 a77, 0
v_accvgpr_write_b32 a78, 0
v_accvgpr_write_b32 a79, 0
v_pk_mul_f32 v[88:89], v[88:89], s[26:27]
v_pk_mul_f32 v[90:91], v[90:91], s[26:27]
v_cvt_pk_bf16_f32 v206, v88, v89
v_cvt_pk_bf16_f32 v207, v90, v91
v_accvgpr_read_b32 v100, a80
v_accvgpr_read_b32 v101, a81
v_accvgpr_read_b32 v102, a82
v_accvgpr_read_b32 v103, a83
v_accvgpr_write_b32 a80, 0
v_accvgpr_write_b32 a81, 0
v_accvgpr_write_b32 a82, 0
v_accvgpr_write_b32 a83, 0
v_pk_mul_f32 v[100:101], v[100:101], s[26:27]
v_pk_mul_f32 v[102:103], v[102:103], s[26:27]
v_cvt_pk_bf16_f32 v212, v100, v101
v_cvt_pk_bf16_f32 v213, v102, v103
v_accvgpr_read_b32 v104, a84
v_accvgpr_read_b32 v105, a85
v_accvgpr_read_b32 v106, a86
v_accvgpr_read_b32 v107, a87
v_accvgpr_write_b32 a84, 0
v_accvgpr_write_b32 a85, 0
v_accvgpr_write_b32 a86, 0
v_accvgpr_write_b32 a87, 0
v_pk_mul_f32 v[104:105], v[104:105], s[26:27]
v_pk_mul_f32 v[106:107], v[106:107], s[26:27]
v_cvt_pk_bf16_f32 v214, v104, v105
v_cvt_pk_bf16_f32 v215, v106, v107
v_accvgpr_read_b32 v116, a88
v_accvgpr_read_b32 v117, a89
v_accvgpr_read_b32 v118, a90
v_accvgpr_read_b32 v119, a91
v_accvgpr_write_b32 a88, 0
v_accvgpr_write_b32 a89, 0
v_accvgpr_write_b32 a90, 0
v_accvgpr_write_b32 a91, 0
v_pk_mul_f32 v[116:117], v[116:117], s[26:27]
v_pk_mul_f32 v[118:119], v[118:119], s[26:27]
v_cvt_pk_bf16_f32 v220, v116, v117
v_cvt_pk_bf16_f32 v221, v118, v119
v_accvgpr_read_b32 v120, a92
v_accvgpr_read_b32 v121, a93
v_accvgpr_read_b32 v122, a94
v_accvgpr_read_b32 v123, a95
v_accvgpr_write_b32 a92, 0
v_accvgpr_write_b32 a93, 0
v_accvgpr_write_b32 a94, 0
v_accvgpr_write_b32 a95, 0
v_pk_mul_f32 v[120:121], v[120:121], s[26:27]
v_pk_mul_f32 v[122:123], v[122:123], s[26:27]
v_cvt_pk_bf16_f32 v222, v120, v121
v_cvt_pk_bf16_f32 v223, v122, v123
buffer_store_dwordx4 v[196:199], v10, s[28:31], s38 offen offset:0 nt
buffer_store_dwordx4 v[204:207], v10, s[28:31], s38 offen offset:2048 nt
buffer_store_dwordx4 v[212:215], v10, s[28:31], s74 offen offset:0 nt
buffer_store_dwordx4 v[220:223], v10, s[28:31], s74 offen offset:2048 nt
s_add_u32 s38, s38, 8192
s_add_u32 s74, s74, 8192
v_accvgpr_read_b32 v68, a96
v_accvgpr_read_b32 v69, a97
v_accvgpr_read_b32 v70, a98
v_accvgpr_read_b32 v71, a99
v_accvgpr_write_b32 a96, 0
v_accvgpr_write_b32 a97, 0
v_accvgpr_write_b32 a98, 0
v_accvgpr_write_b32 a99, 0
v_pk_mul_f32 v[68:69], v[68:69], s[26:27]
v_pk_mul_f32 v[70:71], v[70:71], s[26:27]
v_cvt_pk_bf16_f32 v196, v68, v69
v_cvt_pk_bf16_f32 v197, v70, v71
v_accvgpr_read_b32 v72, a100
v_accvgpr_read_b32 v73, a101
v_accvgpr_read_b32 v74, a102
v_accvgpr_read_b32 v75, a103
v_accvgpr_write_b32 a100, 0
v_accvgpr_write_b32 a101, 0
v_accvgpr_write_b32 a102, 0
v_accvgpr_write_b32 a103, 0
v_pk_mul_f32 v[72:73], v[72:73], s[26:27]
v_pk_mul_f32 v[74:75], v[74:75], s[26:27]
v_cvt_pk_bf16_f32 v198, v72, v73
v_cvt_pk_bf16_f32 v199, v74, v75
v_accvgpr_read_b32 v84, a104
v_accvgpr_read_b32 v85, a105
v_accvgpr_read_b32 v86, a106
v_accvgpr_read_b32 v87, a107
v_accvgpr_write_b32 a104, 0
v_accvgpr_write_b32 a105, 0
v_accvgpr_write_b32 a106, 0
v_accvgpr_write_b32 a107, 0
v_pk_mul_f32 v[84:85], v[84:85], s[26:27]
v_pk_mul_f32 v[86:87], v[86:87], s[26:27]
v_cvt_pk_bf16_f32 v204, v84, v85
v_cvt_pk_bf16_f32 v205, v86, v87
v_accvgpr_read_b32 v88, a108
v_accvgpr_read_b32 v89, a109
v_accvgpr_read_b32 v90, a110
v_accvgpr_read_b32 v91, a111
v_accvgpr_write_b32 a108, 0
v_accvgpr_write_b32 a109, 0
v_accvgpr_write_b32 a110, 0
v_accvgpr_write_b32 a111, 0
v_pk_mul_f32 v[88:89], v[88:89], s[26:27]
v_pk_mul_f32 v[90:91], v[90:91], s[26:27]
v_cvt_pk_bf16_f32 v206, v88, v89
v_cvt_pk_bf16_f32 v207, v90, v91
v_accvgpr_read_b32 v100, a112
v_accvgpr_read_b32 v101, a113
v_accvgpr_read_b32 v102, a114
v_accvgpr_read_b32 v103, a115
v_accvgpr_write_b32 a112, 0
v_accvgpr_write_b32 a113, 0
v_accvgpr_write_b32 a114, 0
v_accvgpr_write_b32 a115, 0
v_pk_mul_f32 v[100:101], v[100:101], s[26:27]
v_pk_mul_f32 v[102:103], v[102:103], s[26:27]
v_cvt_pk_bf16_f32 v212, v100, v101
v_cvt_pk_bf16_f32 v213, v102, v103
v_accvgpr_read_b32 v104, a116
v_accvgpr_read_b32 v105, a117
v_accvgpr_read_b32 v106, a118
v_accvgpr_read_b32 v107, a119
v_accvgpr_write_b32 a116, 0
v_accvgpr_write_b32 a117, 0
v_accvgpr_write_b32 a118, 0
v_accvgpr_write_b32 a119, 0
v_pk_mul_f32 v[104:105], v[104:105], s[26:27]
v_pk_mul_f32 v[106:107], v[106:107], s[26:27]
v_cvt_pk_bf16_f32 v214, v104, v105
v_cvt_pk_bf16_f32 v215, v106, v107
v_accvgpr_read_b32 v116, a120
v_accvgpr_read_b32 v117, a121
v_accvgpr_read_b32 v118, a122
v_accvgpr_read_b32 v119, a123
v_accvgpr_write_b32 a120, 0
v_accvgpr_write_b32 a121, 0
v_accvgpr_write_b32 a122, 0
v_accvgpr_write_b32 a123, 0
v_pk_mul_f32 v[116:117], v[116:117], s[26:27]
v_pk_mul_f32 v[118:119], v[118:119], s[26:27]
v_cvt_pk_bf16_f32 v220, v116, v117
v_cvt_pk_bf16_f32 v221, v118, v119
v_accvgpr_read_b32 v120, a124
v_accvgpr_read_b32 v121, a125
v_accvgpr_read_b32 v122, a126
v_accvgpr_read_b32 v123, a127
v_accvgpr_write_b32 a124, 0
v_accvgpr_write_b32 a125, 0
v_accvgpr_write_b32 a126, 0
v_accvgpr_write_b32 a127, 0
v_pk_mul_f32 v[120:121], v[120:121], s[26:27]
v_pk_mul_f32 v[122:123], v[122:123], s[26:27]
v_cvt_pk_bf16_f32 v222, v120, v121
v_cvt_pk_bf16_f32 v223, v122, v123
buffer_store_dwordx4 v[196:199], v10, s[28:31], s38 offen offset:0 nt
buffer_store_dwordx4 v[204:207], v10, s[28:31], s38 offen offset:2048 nt
buffer_store_dwordx4 v[212:215], v10, s[28:31], s74 offen offset:0 nt
buffer_store_dwordx4 v[220:223], v10, s[28:31], s74 offen offset:2048 nt
s_add_u32 s38, s38, 8192
s_add_u32 s74, s74, 8192
v_accvgpr_write_b32 a128, 0
v_accvgpr_write_b32 a129, 0
v_accvgpr_write_b32 a130, 0
v_accvgpr_write_b32 a131, 0
v_accvgpr_write_b32 a132, 0
v_accvgpr_write_b32 a133, 0
v_accvgpr_write_b32 a134, 0
v_accvgpr_write_b32 a135, 0
v_accvgpr_write_b32 a136, 0
v_accvgpr_write_b32 a137, 0
v_accvgpr_write_b32 a138, 0
v_accvgpr_write_b32 a139, 0
v_accvgpr_write_b32 a140, 0
v_accvgpr_write_b32 a141, 0
v_accvgpr_write_b32 a142, 0
v_accvgpr_write_b32 a143, 0
s_nop 3
v_mov_b32 v196, 0
v_mov_b32 v197, 0
v_mov_b32 v198, 0
v_mov_b32 v199, 0
v_mov_b32 v200, 0
v_mov_b32 v201, 0
v_mov_b32 v202, 0
v_mov_b32 v203, 0
v_mov_b32 v204, 0
v_mov_b32 v205, 0
v_mov_b32 v206, 0
v_mov_b32 v207, 0
v_mov_b32 v208, 0
v_mov_b32 v209, 0
v_mov_b32 v210, 0
v_mov_b32 v211, 0
v_mov_b32 v212, 0
v_mov_b32 v213, 0
v_mov_b32 v214, 0
v_mov_b32 v215, 0
v_mov_b32 v216, 0
v_mov_b32 v217, 0
v_mov_b32 v218, 0
v_mov_b32 v219, 0
v_mov_b32 v220, 0
v_mov_b32 v221, 0
v_mov_b32 v222, 0
v_mov_b32 v223, 0
v_mov_b32 v224, 0
v_mov_b32 v225, 0
v_mov_b32 v226, 0
v_mov_b32 v227, 0
s_mov_b32 s38, 0
s_movk_i32 s74, 4096
L_head_W:
s_waitcnt vmcnt(0) lgkmcnt(0)
s_barrier
ds_read_b128 v[228:231], v3 offset:0
ds_read_b128 v[232:235], v3 offset:64
ds_read_b128 v[236:239], v3 offset:1024
ds_read_b128 v[240:243], v3 offset:1088
ds_read_b128 v[244:247], v3 offset:512
ds_read_b128 v[248:251], v3 offset:576
ds_read_b128 v[252:255], v3 offset:1536
s_waitcnt lgkmcnt(6)
v_mfma_f32_16x16x32_bf16 v[36:39], v[228:231], v[164:167], 0
s_waitcnt lgkmcnt(5)
ds_read_b128 v[228:231], v3 offset:1600
v_mfma_f32_16x16x32_bf16 v[36:39], v[232:235], v[172:175], v[36:39]
s_waitcnt lgkmcnt(5)
v_mfma_f32_16x16x32_bf16 v[36:39], v[236:239], v[180:183], v[36:39]
s_waitcnt vmcnt(16) lgkmcnt(0)
s_barrier
v_mfma_f32_16x16x32_bf16 v[36:39], v[240:243], v[188:191], v[36:39]
ds_read_b64_tr_b16 v[240:241], v5 offset:0
ds_read_b64_tr_b16 v[242:243], v5 offset:512
v_mfma_f32_16x16x32_bf16 v[40:43], v[244:247], v[164:167], 0
ds_read_b64_tr_b16 v[244:245], v6 offset:0
ds_read_b64_tr_b16 v[246:247], v6 offset:512
v_mfma_f32_16x16x32_bf16 v[40:43], v[248:251], v[172:175], v[40:43]
ds_read_b64_tr_b16 v[248:249], v5 offset:64
ds_read_b64_tr_b16 v[250:251], v5 offset:576
v_mfma_f32_16x16x32_bf16 v[40:43], v[252:255], v[180:183], v[40:43]
ds_read_b64_tr_b16 v[252:253], v6 offset:64
ds_read_b64_tr_b16 v[254:255], v6 offset:576
v_mfma_f32_16x16x32_bf16 v[40:43], v[228:231], v[188:191], v[40:43]
s_waitcnt lgkmcnt(6)
ds_read_b64_tr_b16 v[228:229], v5 offset:4352
ds_read_b64_tr_b16 v[230:231], v5 offset:4864
ds_read_b64_tr_b16 v[232:233], v6 offset:4352
ds_read_b64_tr_b16 v[234:235], v6 offset:4864
s_add_u32 m0, s78, 100864
s_add_u32 s62, s62, 128
buffer_load_dwordx4 v4, s[48:51], s62 offen offset:0 nt lds
v_mfma_f32_16x16x32_bf16 a[0:3], v[240:243], v[196:199], a[0:3]
s_waitcnt lgkmcnt(8)
ds_read_b64_tr_b16 v[236:237], v5 offset:4416
ds_read_b64_tr_b16 v[238:239], v5 offset:4928
ds_read_b64_tr_b16 v[240:241], v6 offset:4416
ds_read_b64_tr_b16 v[242:243], v6 offset:4928
s_add_u32 m0, s78, 105216
s_add_u32 s62, s62, 128
v_mfma_f32_16x16x32_bf16 a[4:7], v[244:247], v[196:199], a[4:7]
s_waitcnt lgkmcnt(10)
ds_read_b128 v[244:247], v3 offset:8256
buffer_load_dwordx4 v4, s[48:51], s62 offen offset:0 nt lds
s_add_u32 m0, s78, 109568
v_max3_f32 v15, v36, v37, v38
v_max3_f32 v16, v39, v40, v41
v_max3_f32 v15, v15, v42, v43
v_max_f32 v15, v15, v16
v_mov_b32 v16, v15
s_nop 1
v_permlane32_swap_b32 v15, v16
v_max_f32 v15, v15, v16
v_mov_b32 v16, v15
s_nop 1
v_permlane16_swap_b32 v15, v16
v_max_f32 v15, v15, v16
v_sub_f32 v20, 0, v15
v_sub_f32 v21, 0, v15
v_sub_f32 v22, 0, v15
v_mfma_f32_16x16x32_bf16 a[8:11], v[248:251], v[196:199], a[8:11]
s_waitcnt lgkmcnt(9)
ds_read_b128 v[248:251], v3 offset:8320
s_add_u32 s62, s62, 128
buffer_load_dwordx4 v4, s[48:51], s62 offen offset:0 nt lds
v_sub_f32 v23, 0, v15
v_sub_f32 v36, v36, v15
v_mfma_f32_16x16x32_bf16 a[12:15], v[252:255], v[196:199], a[12:15]
s_waitcnt lgkmcnt(8)
ds_read_b128 v[252:255], v3 offset:9280
s_add_u32 m0, s69, 33024
s_add_u32 s64, s64, 8192
v_sub_f32 v37, v37, v15
v_sub_f32 v38, v38, v15
v_mfma_f32_16x16x32_bf16 a[16:19], v[228:231], v[196:199], a[16:19]
s_waitcnt lgkmcnt(7)
ds_read_b128 v[228:231], v3 offset:9344
s_add_u32 s66, s66, 8192
buffer_load_dwordx4 v7, s[80:83], s64 offen offset:0 nt lds
v_sub_f32 v39, v39, v15
v_sub_f32 v40, v40, v15
v_mfma_f32_16x16x32_bf16 a[20:23], v[232:235], v[196:199], a[20:23]
s_waitcnt lgkmcnt(6)
ds_read_b128 v[232:235], v3 offset:8768
buffer_load_dwordx4 v7, s[80:83], s66 offen offset:1024 nt lds
s_add_u32 m0, s76, 16512
v_sub_f32 v41, v41, v15
v_sub_f32 v42, v42, v15
v_mfma_f32_16x16x32_bf16 a[24:27], v[236:239], v[196:199], a[24:27]
s_waitcnt lgkmcnt(5)
ds_read_b128 v[236:239], v3 offset:8832
s_add_u32 s65, s65, 8192
s_add_u32 s67, s67, 8192
v_sub_f32 v43, v43, v15
v_mov_b32 v11, 0
v_mfma_f32_16x16x32_bf16 a[28:31], v[240:243], v[196:199], a[28:31]
s_waitcnt lgkmcnt(5)
ds_read_b128 v[240:243], v3 offset:9792
buffer_load_dwordx4 v8, s[92:95], s65 offen offset:0 nt lds
buffer_load_dwordx4 v8, s[92:95], s67 offen offset:1024 nt lds
v_exp_f32 v16, v36
v_exp_f32 v17, v37
v_mov_b32 v13, v16
v_add_f32 v13, v13, v17
v_cvt_pk_bf16_f32 v28, v16, v17
v_exp_f32 v18, v38
v_exp_f32 v19, v39
v_add_f32 v13, v13, v18
v_mfma_f32_16x16x32_bf16 v[52:55], v[244:247], v[164:167], v[20:23]
s_waitcnt lgkmcnt(5)
ds_read_b128 v[244:247], v3 offset:9856
v_add_f32 v13, v13, v19
v_cvt_pk_bf16_f32 v29, v18, v19
v_exp_f32 v16, v40
v_mfma_f32_16x16x32_bf16 v[52:55], v[248:251], v[172:175], v[52:55]
s_waitcnt lgkmcnt(5)
v_exp_f32 v17, v41
v_add_f32 v13, v13, v16
v_add_f32 v13, v13, v17
v_cvt_pk_bf16_f32 v30, v16, v17
v_mfma_f32_16x16x32_bf16 v[52:55], v[252:255], v[180:183], v[52:55]
s_waitcnt vmcnt(21) lgkmcnt(0)
s_barrier
ds_read_b64_tr_b16 v[248:249], v1 offset:0
ds_read_b64_tr_b16 v[250:251], v1 offset:512
ds_read_b64_tr_b16 v[252:253], v1 offset:8
ds_read_b64_tr_b16 v[254:255], v1 offset:520
v_mfma_f32_16x16x32_bf16 v[52:55], v[228:231], v[188:191], v[52:55]
ds_read_b64_tr_b16 v[228:229], v2 offset:0
ds_read_b64_tr_b16 v[230:231], v2 offset:512
v_exp_f32 v18, v42
v_exp_f32 v19, v43
v_mfma_f32_16x16x32_bf16 v[56:59], v[232:235], v[164:167], v[20:23]
ds_read_b64_tr_b16 v[232:233], v2 offset:8
ds_read_b64_tr_b16 v[234:235], v2 offset:520
v_add_f32 v13, v13, v18
v_add_f32 v13, v13, v19
v_cvt_pk_bf16_f32 v31, v18, v19
v_mfma_f32_16x16x32_bf16 v[56:59], v[236:239], v[172:175], v[56:59]
ds_read_b64_tr_b16 v[236:237], v1 offset:1024
ds_read_b64_tr_b16 v[238:239], v1 offset:1536
v_mfma_f32_16x16x32_bf16 v[56:59], v[240:243], v[180:183], v[56:59]
ds_read_b64_tr_b16 v[240:241], v1 offset:1032
ds_read_b64_tr_b16 v[242:243], v1 offset:1544
v_mfma_f32_16x16x32_bf16 v[56:59], v[244:247], v[188:191], v[56:59]
s_waitcnt lgkmcnt(10)
ds_read_b64_tr_b16 v[244:245], v2 offset:1024
ds_read_b64_tr_b16 v[246:247], v2 offset:1536
v_add_f32 v11, v11, v13
s_nop 0
v_mfma_f32_16x16x32_bf16 v[68:71], v[248:251], v[28:31], 0
s_waitcnt lgkmcnt(10)
ds_read_b64_tr_b16 v[248:249], v2 offset:1032
ds_read_b64_tr_b16 v[250:251], v2 offset:1544
v_mfma_f32_16x16x32_bf16 v[76:79], v[252:255], v[28:31], 0
s_waitcnt lgkmcnt(10)
ds_read_b64_tr_b16 v[252:253], v5 offset:17408
ds_read_b64_tr_b16 v[254:255], v5 offset:17920
v_exp_f32 v16, v52
v_mfma_f32_16x16x32_bf16 v[84:87], v[228:231], v[28:31], 0
s_waitcnt lgkmcnt(10)
ds_read_b64_tr_b16 v[228:229], v6 offset:17408
ds_read_b64_tr_b16 v[230:231], v6 offset:17920
v_exp_f32 v17, v53
v_mov_b32 v13, v16
v_mfma_f32_16x16x32_bf16 v[92:95], v[232:235], v[28:31], 0
s_waitcnt lgkmcnt(10)
ds_read_b64_tr_b16 v[232:233], v5 offset:17472
ds_read_b64_tr_b16 v[234:235], v5 offset:17984
v_add_f32 v13, v13, v17
v_mfma_f32_16x16x32_bf16 v[100:103], v[236:239], v[28:31], 0
s_waitcnt lgkmcnt(10)
ds_read_b64_tr_b16 v[236:237], v6 offset:17472
ds_read_b64_tr_b16 v[238:239], v6 offset:17984
v_mfma_f32_16x16x32_bf16 v[108:111], v[240:243], v[28:31], 0
s_waitcnt lgkmcnt(10)
ds_read_b64_tr_b16 v[240:241], v5 offset:21760
ds_read_b64_tr_b16 v[242:243], v5 offset:22272
v_mfma_f32_16x16x32_bf16 v[116:119], v[244:247], v[28:31], 0
s_waitcnt lgkmcnt(10)
ds_read_b64_tr_b16 v[244:245], v6 offset:21760
ds_read_b64_tr_b16 v[246:247], v6 offset:22272
v_mfma_f32_16x16x32_bf16 v[124:127], v[248:251], v[28:31], 0
s_waitcnt lgkmcnt(10)
ds_read_b64_tr_b16 v[248:249], v5 offset:21824
ds_read_b64_tr_b16 v[250:251], v5 offset:22336
s_add_u32 m0, s78, 66048
s_add_u32 s62, s62, 35840
v_cvt_pk_bf16_f32 v28, v16, v17
v_mfma_f32_16x16x32_bf16 a[32:35], v[252:255], v[196:199], a[32:35]
s_waitcnt lgkmcnt(10)
ds_read_b64_tr_b16 v[252:253], v6 offset:21824
ds_read_b64_tr_b16 v[254:255], v6 offset:22336
buffer_load_dwordx4 v4, s[48:51], s62 offen offset:0 nt lds
s_add_u32 m0, s78, 70400
v_mfma_f32_16x16x32_bf16 a[36:39], v[228:231], v[196:199], a[36:39]
s_waitcnt lgkmcnt(10)
ds_read_b128 v[228:231], v3 offset:16512
s_add_u32 s62, s62, 128
buffer_load_dwordx4 v4, s[48:51], s62 offen offset:0 nt lds
v_exp_f32 v18, v54
v_mfma_f32_16x16x32_bf16 a[40:43], v[232:235], v[196:199], a[40:43]
s_waitcnt lgkmcnt(9)
ds_read_b128 v[232:235], v3 offset:16576
s_add_u32 m0, s69, 41280
s_add_u32 s64, s64, 8192
v_exp_f32 v19, v55
v_mfma_f32_16x16x32_bf16 a[44:47], v[236:239], v[196:199], a[44:47]
s_waitcnt lgkmcnt(8)
ds_read_b128 v[236:239], v3 offset:17536
s_add_u32 s66, s66, 8192
buffer_load_dwordx4 v7, s[80:83], s64 offen offset:0 nt lds
v_add_f32 v13, v13, v18
v_add_f32 v13, v13, v19
v_mfma_f32_16x16x32_bf16 a[48:51], v[240:243], v[196:199], a[48:51]
s_waitcnt lgkmcnt(7)
ds_read_b128 v[240:243], v3 offset:17600
buffer_load_dwordx4 v7, s[80:83], s66 offen offset:1024 nt lds
s_add_u32 m0, s76, 24768
v_cvt_pk_bf16_f32 v29, v18, v19
v_mfma_f32_16x16x32_bf16 a[52:55], v[244:247], v[196:199], a[52:55]
s_waitcnt lgkmcnt(6)
ds_read_b128 v[244:247], v3 offset:17024
s_add_u32 s65, s65, 8192
s_add_u32 s67, s67, 8192
v_exp_f32 v16, v56
v_mfma_f32_16x16x32_bf16 a[56:59], v[248:251], v[196:199], a[56:59]
s_waitcnt lgkmcnt(5)
ds_read_b128 v[248:251], v3 offset:17088
buffer_load_dwordx4 v8, s[92:95], s65 offen offset:0 nt lds
buffer_load_dwordx4 v8, s[92:95], s67 offen offset:1024 nt lds
v_exp_f32 v17, v57
v_mfma_f32_16x16x32_bf16 a[60:63], v[252:255], v[196:199], a[60:63]
s_waitcnt lgkmcnt(5)
ds_read_b128 v[252:255], v3 offset:18048
buffer_load_dword v0, v9, s[48:51], s89 offen offset:0
s_add_u32 s89, s89, 147456
v_add_f32 v13, v13, v16
v_add_f32 v13, v13, v17
v_mfma_f32_16x16x32_bf16 v[36:39], v[228:231], v[164:167], v[20:23]
s_waitcnt lgkmcnt(5)
ds_read_b128 v[228:231], v3 offset:18112
v_cvt_pk_bf16_f32 v30, v16, v17
v_exp_f32 v18, v58
v_mfma_f32_16x16x32_bf16 v[36:39], v[232:235], v[172:175], v[36:39]
s_waitcnt lgkmcnt(5)
v_exp_f32 v19, v59
v_add_f32 v13, v13, v18
v_add_f32 v13, v13, v19
v_cvt_pk_bf16_f32 v31, v18, v19
v_mfma_f32_16x16x32_bf16 v[36:39], v[236:239], v[180:183], v[36:39]
s_waitcnt vmcnt(26) lgkmcnt(0)
s_barrier
ds_read_b64_tr_b16 v[236:237], v1 offset:8256
ds_read_b64_tr_b16 v[238:239], v1 offset:8768
v_mfma_f32_16x16x32_bf16 v[36:39], v[240:243], v[188:191], v[36:39]
ds_read_b64_tr_b16 v[240:241], v1 offset:8264
ds_read_b64_tr_b16 v[242:243], v1 offset:8776
v_mfma_f32_16x16x32_bf16 v[40:43], v[244:247], v[164:167], v[20:23]
ds_read_b64_tr_b16 v[244:245], v2 offset:8256
ds_read_b64_tr_b16 v[246:247], v2 offset:8768
v_mfma_f32_16x16x32_bf16 v[40:43], v[248:251], v[172:175], v[40:43]
ds_read_b64_tr_b16 v[248:249], v2 offset:8264
ds_read_b64_tr_b16 v[250:251], v2 offset:8776
v_mfma_f32_16x16x32_bf16 v[40:43], v[252:255], v[180:183], v[40:43]
ds_read_b64_tr_b16 v[252:253], v1 offset:9280
ds_read_b64_tr_b16 v[254:255], v1 offset:9792
v_mfma_f32_16x16x32_bf16 v[40:43], v[228:231], v[188:191], v[40:43]
s_waitcnt lgkmcnt(8)
ds_read_b64_tr_b16 v[228:229], v1 offset:9288
ds_read_b64_tr_b16 v[230:231], v1 offset:9800
ds_read_b64_tr_b16 v[232:233], v2 offset:9280
ds_read_b64_tr_b16 v[234:235], v2 offset:9792
v_cmp_nle_f32 s[70:71], v13, s73
s_cmp_lg_u64 s[70:71], 0
s_cbranch_scc1 L_tr_WB1
L_back_WB1:
v_add_f32 v11, v11, v13
v_mfma_f32_16x16x32_bf16 v[68:71], v[236:239], v[28:31], v[68:71]
s_waitcnt lgkmcnt(10)
ds_read_b64_tr_b16 v[236:237], v2 offset:9288
ds_read_b64_tr_b16 v[238:239], v2 offset:9800
v_mfma_f32_16x16x32_bf16 v[76:79], v[240:243], v[28:31], v[76:79]
s_waitcnt lgkmcnt(10)
ds_read_b64_tr_b16 v[240:241], v5 offset:52224
ds_read_b64_tr_b16 v[242:243], v5 offset:52736
v_exp_f32 v16, v36
v_mfma_f32_16x16x32_bf16 v[84:87], v[244:247], v[28:31], v[84:87]
s_waitcnt lgkmcnt(10)
ds_read_b64_tr_b16 v[244:245], v6 offset:52224
ds_read_b64_tr_b16 v[246:247], v6 offset:52736
v_exp_f32 v17, v37
v_mov_b32 v13, v16
v_mfma_f32_16x16x32_bf16 v[92:95], v[248:251], v[28:31], v[92:95]
s_waitcnt lgkmcnt(10)
ds_read_b64_tr_b16 v[248:249], v5 offset:52288
ds_read_b64_tr_b16 v[250:251], v5 offset:52800
v_add_f32 v13, v13, v17
v_mfma_f32_16x16x32_bf16 v[100:103], v[252:255], v[28:31], v[100:103]
s_waitcnt lgkmcnt(10)
ds_read_b64_tr_b16 v[252:253], v6 offset:52288
ds_read_b64_tr_b16 v[254:255], v6 offset:52800
v_mfma_f32_16x16x32_bf16 v[108:111], v[228:231], v[28:31], v[108:111]
s_waitcnt lgkmcnt(10)
ds_read_b64_tr_b16 v[228:229], v5 offset:56576
ds_read_b64_tr_b16 v[230:231], v5 offset:57088
v_mfma_f32_16x16x32_bf16 v[116:119], v[232:235], v[28:31], v[116:119]
s_waitcnt lgkmcnt(10)
ds_read_b64_tr_b16 v[232:233], v6 offset:56576
ds_read_b64_tr_b16 v[234:235], v6 offset:57088
v_mfma_f32_16x16x32_bf16 v[124:127], v[236:239], v[28:31], v[124:127]
s_waitcnt lgkmcnt(10)
ds_read_b64_tr_b16 v[236:237], v5 offset:56640
ds_read_b64_tr_b16 v[238:239], v5 offset:57152
s_add_u32 m0, s78, 83456
s_add_u32 s62, s62, 128
v_cvt_pk_bf16_f32 v28, v16, v17
v_mfma_f32_16x16x32_bf16 a[64:67], v[240:243], v[196:199], a[64:67]
s_waitcnt lgkmcnt(10)
ds_read_b64_tr_b16 v[240:241], v6 offset:56640
ds_read_b64_tr_b16 v[242:243], v6 offset:57152
buffer_load_dwordx4 v4, s[48:51], s62 offen offset:0 nt lds
s_add_u32 m0, s78, 87808
v_mfma_f32_16x16x32_bf16 a[68:71], v[244:247], v[196:199], a[68:71]
s_waitcnt lgkmcnt(10)
ds_read_b128 v[244:247], v3 offset:24768
s_add_u32 s62, s62, 128
buffer_load_dwordx4 v4, s[48:51], s62 offen offset:0 nt lds
v_exp_f32 v18, v38
v_mfma_f32_16x16x32_bf16 a[72:75], v[248:251], v[196:199], a[72:75]
s_waitcnt lgkmcnt(9)
ds_read_b128 v[248:251], v3 offset:24832
s_add_u32 m0, s69, 49536
s_add_u32 s64, s64, 8192
v_exp_f32 v19, v39
v_mfma_f32_16x16x32_bf16 a[76:79], v[252:255], v[196:199], a[76:79]
s_waitcnt lgkmcnt(8)
ds_read_b128 v[252:255], v3 offset:25792
s_add_u32 s66, s66, 8192
buffer_load_dwordx4 v7, s[80:83], s64 offen offset:0 nt lds
v_add_f32 v13, v13, v18
v_add_f32 v13, v13, v19
v_mfma_f32_16x16x32_bf16 a[80:83], v[228:231], v[196:199], a[80:83]
s_waitcnt lgkmcnt(7)
ds_read_b128 v[228:231], v3 offset:25856
buffer_load_dwordx4 v7, s[80:83], s66 offen offset:1024 nt lds
s_add_u32 m0, s76, 0
v_cvt_pk_bf16_f32 v29, v18, v19
v_mfma_f32_16x16x32_bf16 a[84:87], v[232:235], v[196:199], a[84:87]
s_waitcnt lgkmcnt(6)
ds_read_b128 v[232:235], v3 offset:25280
s_add_u32 s65, s65, 8192
s_add_u32 s67, s67, 8192
v_exp_f32 v16, v40
v_mfma_f32_16x16x32_bf16 a[88:91], v[236:239], v[196:199], a[88:91]
s_waitcnt lgkmcnt(5)
ds_read_b128 v[236:239], v3 offset:25344
buffer_load_dwordx4 v8, s[92:95], s65 offen offset:0 nt lds
buffer_load_dwordx4 v8, s[92:95], s67 offen offset:1024 nt lds
v_exp_f32 v17, v41
v_mfma_f32_16x16x32_bf16 a[92:95], v[240:243], v[196:199], a[92:95]
s_waitcnt lgkmcnt(5)
ds_read_b128 v[240:243], v3 offset:26304
v_add_f32 v13, v13, v16
v_add_f32 v13, v13, v17
v_cvt_pk_bf16_f32 v30, v16, v17
v_mfma_f32_16x16x32_bf16 v[52:55], v[244:247], v[164:167], v[20:23]
s_waitcnt lgkmcnt(5)
ds_read_b128 v[244:247], v3 offset:26368
v_exp_f32 v18, v42
v_exp_f32 v19, v43
v_mfma_f32_16x16x32_bf16 v[52:55], v[248:251], v[172:175], v[52:55]
s_waitcnt lgkmcnt(5)
v_add_f32 v13, v13, v18
v_add_f32 v13, v13, v19
v_cvt_pk_bf16_f32 v31, v18, v19
v_mfma_f32_16x16x32_bf16 v[52:55], v[252:255], v[180:183], v[52:55]
s_mov_b32 s39, 3
L_loop5:
s_waitcnt vmcnt(12) lgkmcnt(0)
s_barrier
ds_read_b64_tr_b16 v[252:253], v1 offset:16512
ds_read_b64_tr_b16 v[254:255], v1 offset:17024
v_mfma_f32_16x16x32_bf16 v[52:55], v[228:231], v[188:191], v[52:55]
ds_read_b64_tr_b16 v[228:229], v1 offset:16520
ds_read_b64_tr_b16 v[230:231], v1 offset:17032
v_mfma_f32_16x16x32_bf16 v[56:59], v[232:235], v[164:167], v[20:23]
ds_read_b64_tr_b16 v[232:233], v2 offset:16512
ds_read_b64_tr_b16 v[234:235], v2 offset:17024
v_mfma_f32_16x16x32_bf16 v[56:59], v[236:239], v[172:175], v[56:59]
ds_read_b64_tr_b16 v[236:237], v2 offset:16520
ds_read_b64_tr_b16 v[238:239], v2 offset:17032
v_mfma_f32_16x16x32_bf16 v[56:59], v[240:243], v[180:183], v[56:59]
ds_read_b64_tr_b16 v[240:241], v1 offset:17536
ds_read_b64_tr_b16 v[242:243], v1 offset:18048
v_mfma_f32_16x16x32_bf16 v[56:59], v[244:247], v[188:191], v[56:59]
s_waitcnt lgkmcnt(8)
ds_read_b64_tr_b16 v[244:245], v1 offset:17544
ds_read_b64_tr_b16 v[246:247], v1 offset:18056
ds_read_b64_tr_b16 v[248:249], v2 offset:17536
ds_read_b64_tr_b16 v[250:251], v2 offset:18048
v_cmp_nle_f32 s[70:71], v13, s73
s_cmp_lg_u64 s[70:71], 0
s_cbranch_scc1 L_tr_WB2
L_back_WB2:
v_add_f32 v11, v11, v13
v_mfma_f32_16x16x32_bf16 v[68:71], v[252:255], v[28:31], v[68:71]
s_waitcnt lgkmcnt(10)
ds_read_b64_tr_b16 v[252:253], v2 offset:17544
ds_read_b64_tr_b16 v[254:255], v2 offset:18056
v_mfma_f32_16x16x32_bf16 v[76:79], v[228:231], v[28:31], v[76:79]
s_waitcnt lgkmcnt(10)
ds_read_b64_tr_b16 v[228:229], v5 offset:34816
ds_read_b64_tr_b16 v[230:231], v5 offset:35328
v_exp_f32 v16, v52
v_mfma_f32_16x16x32_bf16 v[84:87], v[232:235], v[28:31], v[84:87]
s_waitcnt lgkmcnt(10)
ds_read_b64_tr_b16 v[232:233], v6 offset:34816
ds_read_b64_tr_b16 v[234:235], v6 offset:35328
v_exp_f32 v17, v53
v_mov_b32 v13, v16
v_mfma_f32_16x16x32_bf16 v[92:95], v[236:239], v[28:31], v[92:95]
s_waitcnt lgkmcnt(10)
ds_read_b64_tr_b16 v[236:237], v5 offset:34880
ds_read_b64_tr_b16 v[238:239], v5 offset:35392
v_add_f32 v13, v13, v17
v_mfma_f32_16x16x32_bf16 v[100:103], v[240:243], v[28:31], v[100:103]
s_waitcnt lgkmcnt(10)
ds_read_b64_tr_b16 v[240:241], v6 offset:34880
ds_read_b64_tr_b16 v[242:243], v6 offset:35392
v_mfma_f32_16x16x32_bf16 v[108:111], v[244:247], v[28:31], v[108:111]
s_waitcnt lgkmcnt(10)
ds_read_b64_tr_b16 v[244:245], v5 offset:39168
ds_read_b64_tr_b16 v[246:247], v5 offset:39680
v_mfma_f32_16x16x32_bf16 v[116:119], v[248:251], v[28:31], v[116:119]
s_waitcnt lgkmcnt(10)
ds_read_b64_tr_b16 v[248:249], v6 offset:39168
ds_read_b64_tr_b16 v[250:251], v6 offset:39680
v_mfma_f32_16x16x32_bf16 v[124:127], v[252:255], v[28:31], v[124:127]
s_waitcnt lgkmcnt(10)
ds_read_b64_tr_b16 v[252:253], v5 offset:39232
ds_read_b64_tr_b16 v[254:255], v5 offset:39744
v_cvt_pk_bf16_f32 v28, v16, v17
v_exp_f32 v18, v54
v_mfma_f32_16x16x32_bf16 a[96:99], v[228:231], v[196:199], a[96:99]
s_waitcnt lgkmcnt(10)
ds_read_b64_tr_b16 v[228:229], v6 offset:39232
ds_read_b64_tr_b16 v[230:231], v6 offset:39744
v_exp_f32 v19, v55
v_add_f32 v13, v13, v18
v_mfma_f32_16x16x32_bf16 a[100:103], v[232:235], v[196:199], a[100:103]
s_waitcnt lgkmcnt(10)
ds_read_b64_tr_b16 v[232:233], v5 offset:43520
ds_read_b64_tr_b16 v[234:235], v5 offset:44032
v_add_f32 v13, v13, v19
v_cvt_pk_bf16_f32 v29, v18, v19
v_mfma_f32_16x16x32_bf16 a[104:107], v[236:239], v[196:199], a[104:107]
s_waitcnt lgkmcnt(10)
ds_read_b64_tr_b16 v[236:237], v6 offset:43520
ds_read_b64_tr_b16 v[238:239], v6 offset:44032
v_exp_f32 v16, v56
v_mfma_f32_16x16x32_bf16 a[108:111], v[240:243], v[196:199], a[108:111]
s_waitcnt lgkmcnt(10)
ds_read_b64_tr_b16 v[240:241], v5 offset:43584
ds_read_b64_tr_b16 v[242:243], v5 offset:44096
s_add_u32 m0, s78, 118272
s_add_u32 s62, s62, 128
v_mfma_f32_16x16x32_bf16 a[112:115], v[244:247], v[196:199], a[112:115]
s_waitcnt lgkmcnt(10)
ds_read_b64_tr_b16 v[244:245], v6 offset:43584
ds_read_b64_tr_b16 v[246:247], v6 offset:44096
buffer_load_dwordx4 v4, s[48:51], s62 offen offset:0 nt lds
s_add_u32 m0, s78, 122624
v_mfma_f32_16x16x32_bf16 a[116:119], v[248:251], v[196:199], a[116:119]
s_waitcnt lgkmcnt(10)
ds_read_b128 v[248:251], v3 offset:0
s_add_u32 s62, s62, 128
buffer_load_dwordx4 v4, s[48:51], s62 offen offset:0 nt lds
v_exp_f32 v17, v57
v_mfma_f32_16x16x32_bf16 a[120:123], v[252:255], v[196:199], a[120:123]
s_waitcnt lgkmcnt(9)
ds_read_b128 v[252:255], v3 offset:64
s_add_u32 m0, s69, 57792
s_add_u32 s64, s64, 8192
v_add_f32 v13, v13, v16
v_add_f32 v13, v13, v17
v_mfma_f32_16x16x32_bf16 a[124:127], v[228:231], v[196:199], a[124:127]
s_waitcnt lgkmcnt(8)
ds_read_b128 v[228:231], v3 offset:1024
s_add_u32 s66, s66, 8192
buffer_load_dwordx4 v7, s[80:83], s64 offen offset:0 nt lds
v_cvt_pk_bf16_f32 v30, v16, v17
v_mfma_f32_16x16x32_bf16 a[128:131], v[232:235], v[196:199], a[128:131]
s_waitcnt lgkmcnt(7)
ds_read_b128 v[232:235], v3 offset:1088
buffer_load_dwordx4 v7, s[80:83], s66 offen offset:1024 nt lds
s_add_u32 m0, s76, 8256
v_exp_f32 v18, v58
v_mfma_f32_16x16x32_bf16 a[132:135], v[236:239], v[196:199], a[132:135]
s_waitcnt lgkmcnt(6)
ds_read_b128 v[236:239], v3 offset:512
s_add_u32 s65, s65, 8192
s_add_u32 s67, s67, 8192
v_exp_f32 v19, v59
v_mfma_f32_16x16x32_bf16 a[136:139], v[240:243], v[196:199], a[136:139]
s_waitcnt lgkmcnt(5)
ds_read_b128 v[240:243], v3 offset:576
buffer_load_dwordx4 v8, s[92:95], s65 offen offset:0 nt lds
buffer_load_dwordx4 v8, s[92:95], s67 offen offset:1024 nt lds
v_add_f32 v13, v13, v18
v_add_f32 v13, v13, v19
v_mfma_f32_16x16x32_bf16 a[140:143], v[244:247], v[196:199], a[140:143]
s_waitcnt lgkmcnt(5)
ds_read_b128 v[244:247], v3 offset:1536
v_cvt_pk_bf16_f32 v31, v18, v19
v_mfma_f32_16x16x32_bf16 v[36:39], v[248:251], v[164:167], v[20:23]
s_waitcnt lgkmcnt(5)
ds_read_b128 v[248:251], v3 offset:1600
v_mov_b32 v196, v204
v_mov_b32 v197, v205
v_mov_b32 v198, v206
v_mov_b32 v199, v207
v_mfma_f32_16x16x32_bf16 v[36:39], v[252:255], v[172:175], v[36:39]
s_waitcnt lgkmcnt(5)
v_mfma_f32_16x16x32_bf16 v[36:39], v[228:231], v[180:183], v[36:39]
s_waitcnt vmcnt(12) lgkmcnt(0)
s_barrier
v_mfma_f32_16x16x32_bf16 v[36:39], v[232:235], v[188:191], v[36:39]
ds_read_b64_tr_b16 v[232:233], v1 offset:24768
ds_read_b64_tr_b16 v[234:235], v1 offset:25280
v_mfma_f32_16x16x32_bf16 v[40:43], v[236:239], v[164:167], v[20:23]
ds_read_b64_tr_b16 v[236:237], v1 offset:24776
ds_read_b64_tr_b16 v[238:239], v1 offset:25288
v_mfma_f32_16x16x32_bf16 v[40:43], v[240:243], v[172:175], v[40:43]
ds_read_b64_tr_b16 v[240:241], v2 offset:24768
ds_read_b64_tr_b16 v[242:243], v2 offset:25280
v_mfma_f32_16x16x32_bf16 v[40:43], v[244:247], v[180:183], v[40:43]
ds_read_b64_tr_b16 v[244:245], v2 offset:24776
ds_read_b64_tr_b16 v[246:247], v2 offset:25288
v_mfma_f32_16x16x32_bf16 v[40:43], v[248:251], v[188:191], v[40:43]
s_waitcnt lgkmcnt(6)
ds_read_b64_tr_b16 v[248:249], v1 offset:25792
ds_read_b64_tr_b16 v[250:251], v1 offset:26304
ds_read_b64_tr_b16 v[252:253], v1 offset:25800
ds_read_b64_tr_b16 v[254:255], v1 offset:26312
v_cmp_nle_f32 s[70:71], v13, s73
s_cmp_lg_u64 s[70:71], 0
s_cbranch_scc1 L_tr_WB3
L_back_WB3:
v_add_f32 v11, v11, v13
v_mfma_f32_16x16x32_bf16 v[68:71], v[232:235], v[28:31], v[68:71]
s_waitcnt lgkmcnt(8)
ds_read_b64_tr_b16 v[228:229], v2 offset:25792
ds_read_b64_tr_b16 v[230:231], v2 offset:26304
ds_read_b64_tr_b16 v[232:233], v2 offset:25800
ds_read_b64_tr_b16 v[234:235], v2 offset:26312
v_mfma_f32_16x16x32_bf16 v[76:79], v[236:239], v[28:31], v[76:79]
s_waitcnt lgkmcnt(10)
ds_read_b64_tr_b16 v[236:237], v5 offset:0
ds_read_b64_tr_b16 v[238:239], v5 offset:512
v_exp_f32 v16, v36
v_mfma_f32_16x16x32_bf16 v[84:87], v[240:243], v[28:31], v[84:87]
s_waitcnt lgkmcnt(10)
ds_read_b64_tr_b16 v[240:241], v6 offset:0
ds_read_b64_tr_b16 v[242:243], v6 offset:512
v_exp_f32 v17, v37
v_mov_b32 v13, v16
v_mfma_f32_16x16x32_bf16 v[92:95], v[244:247], v[28:31], v[92:95]
s_waitcnt lgkmcnt(10)
ds_read_b64_tr_b16 v[244:245], v5 offset:64
ds_read_b64_tr_b16 v[246:247], v5 offset:576
v_add_f32 v13, v13, v17
v_mfma_f32_16x16x32_bf16 v[100:103], v[248:251], v[28:31], v[100:103]
s_waitcnt lgkmcnt(10)
ds_read_b64_tr_b16 v[248:249], v6 offset:64
ds_read_b64_tr_b16 v[250:251], v6 offset:576
v_mfma_f32_16x16x32_bf16 v[108:111], v[252:255], v[28:31], v[108:111]
s_waitcnt lgkmcnt(10)
ds_read_b64_tr_b16 v[252:253], v5 offset:4352
ds_read_b64_tr_b16 v[254:255], v5 offset:4864
v_mfma_f32_16x16x32_bf16 v[116:119], v[228:231], v[28:31], v[116:119]
s_waitcnt lgkmcnt(10)
ds_read_b64_tr_b16 v[228:229], v6 offset:4352
ds_read_b64_tr_b16 v[230:231], v6 offset:4864
v_mfma_f32_16x16x32_bf16 v[124:127], v[232:235], v[28:31], v[124:127]
s_waitcnt lgkmcnt(10)
ds_read_b64_tr_b16 v[232:233], v5 offset:4416
ds_read_b64_tr_b16 v[234:235], v5 offset:4928
s_add_u32 m0, s78, 100864
s_add_u32 s62, s62, 128
buffer_load_dwordx4 v4, s[48:51], s62 offen offset:0 nt lds
v_mfma_f32_16x16x32_bf16 a[0:3], v[236:239], v[204:207], a[0:3]
s_waitcnt lgkmcnt(10)
ds_read_b64_tr_b16 v[236:237], v6 offset:4416
ds_read_b64_tr_b16 v[238:239], v6 offset:4928
s_add_u32 m0, s78, 105216
s_add_u32 s62, s62, 128
v_cvt_pk_bf16_f32 v28, v16, v17
v_mfma_f32_16x16x32_bf16 a[4:7], v[240:243], v[204:207], a[4:7]
s_waitcnt lgkmcnt(10)
ds_read_b128 v[240:243], v3 offset:8256
buffer_load_dwordx4 v4, s[48:51], s62 offen offset:0 nt lds
s_add_u32 m0, s78, 109568
v_exp_f32 v18, v38
v_mfma_f32_16x16x32_bf16 a[8:11], v[244:247], v[204:207], a[8:11]
s_waitcnt lgkmcnt(9)
ds_read_b128 v[244:247], v3 offset:8320
s_add_u32 s62, s62, 128
buffer_load_dwordx4 v4, s[48:51], s62 offen offset:0 nt lds
v_exp_f32 v19, v39
v_mfma_f32_16x16x32_bf16 a[12:15], v[248:251], v[204:207], a[12:15]
s_waitcnt lgkmcnt(8)
ds_read_b128 v[248:251], v3 offset:9280
s_add_u32 m0, s69, 33024
s_add_u32 s64, s64, 8192
v_add_f32 v13, v13, v18
v_add_f32 v13, v13, v19
v_mfma_f32_16x16x32_bf16 a[16:19], v[252:255], v[204:207], a[16:19]
s_waitcnt lgkmcnt(7)
ds_read_b128 v[252:255], v3 offset:9344
s_add_u32 s66, s66, 8192
buffer_load_dwordx4 v7, s[80:83], s64 offen offset:0 nt lds
v_cvt_pk_bf16_f32 v29, v18, v19
v_mfma_f32_16x16x32_bf16 a[20:23], v[228:231], v[204:207], a[20:23]
s_waitcnt lgkmcnt(6)
ds_read_b128 v[228:231], v3 offset:8768
buffer_load_dwordx4 v7, s[80:83], s66 offen offset:1024 nt lds
s_add_u32 m0, s76, 16512
v_exp_f32 v16, v40
v_mfma_f32_16x16x32_bf16 a[24:27], v[232:235], v[204:207], a[24:27]
s_waitcnt lgkmcnt(5)
ds_read_b128 v[232:235], v3 offset:8832
s_add_u32 s65, s65, 8192
s_add_u32 s67, s67, 8192
v_exp_f32 v17, v41
v_mfma_f32_16x16x32_bf16 a[28:31], v[236:239], v[204:207], a[28:31]
s_waitcnt lgkmcnt(5)
ds_read_b128 v[236:239], v3 offset:9792
buffer_load_dwordx4 v8, s[92:95], s65 offen offset:0 nt lds
buffer_load_dwordx4 v8, s[92:95], s67 offen offset:1024 nt lds
v_add_f32 v13, v13, v16
v_add_f32 v13, v13, v17
v_mfma_f32_16x16x32_bf16 v[52:55], v[240:243], v[164:167], v[20:23]
s_waitcnt lgkmcnt(5)
ds_read_b128 v[240:243], v3 offset:9856
v_cvt_pk_bf16_f32 v30, v16, v17
v_exp_f32 v18, v42
v_mfma_f32_16x16x32_bf16 v[52:55], v[244:247], v[172:175], v[52:55]
s_waitcnt lgkmcnt(5)
v_exp_f32 v19, v43
v_add_f32 v13, v13, v18
v_add_f32 v13, v13, v19
v_cvt_pk_bf16_f32 v31, v18, v19
v_mfma_f32_16x16x32_bf16 v[52:55], v[248:251], v[180:183], v[52:55]
s_waitcnt vmcnt(13) lgkmcnt(0)
s_barrier
ds_read_b64_tr_b16 v[248:249], v1 offset:0
ds_read_b64_tr_b16 v[250:251], v1 offset:512
v_mfma_f32_16x16x32_bf16 v[52:55], v[252:255], v[188:191], v[52:55]
ds_read_b64_tr_b16 v[252:253], v1 offset:8
ds_read_b64_tr_b16 v[254:255], v1 offset:520
v_mfma_f32_16x16x32_bf16 v[56:59], v[228:231], v[164:167], v[20:23]
ds_read_b64_tr_b16 v[228:229], v2 offset:0
ds_read_b64_tr_b16 v[230:231], v2 offset:512
v_mfma_f32_16x16x32_bf16 v[56:59], v[232:235], v[172:175], v[56:59]
ds_read_b64_tr_b16 v[232:233], v2 offset:8
ds_read_b64_tr_b16 v[234:235], v2 offset:520
v_mfma_f32_16x16x32_bf16 v[56:59], v[236:239], v[180:183], v[56:59]
ds_read_b64_tr_b16 v[236:237], v1 offset:1024
ds_read_b64_tr_b16 v[238:239], v1 offset:1536
v_mfma_f32_16x16x32_bf16 v[56:59], v[240:243], v[188:191], v[56:59]
s_waitcnt lgkmcnt(8)
ds_read_b64_tr_b16 v[240:241], v1 offset:1032
ds_read_b64_tr_b16 v[242:243], v1 offset:1544
ds_read_b64_tr_b16 v[244:245], v2 offset:1024
ds_read_b64_tr_b16 v[246:247], v2 offset:1536
v_cmp_nle_f32 s[70:71], v13, s73
s_cmp_lg_u64 s[70:71], 0
s_cbranch_scc1 L_tr_WB4
L_back_WB4:
v_add_f32 v11, v11, v13
v_mfma_f32_16x16x32_bf16 v[68:71], v[248:251], v[28:31], v[68:71]
s_waitcnt lgkmcnt(10)
ds_read_b64_tr_b16 v[248:249], v2 offset:1032
ds_read_b64_tr_b16 v[250:251], v2 offset:1544
v_mfma_f32_16x16x32_bf16 v[76:79], v[252:255], v[28:31], v[76:79]
s_waitcnt lgkmcnt(10)
ds_read_b64_tr_b16 v[252:253], v5 offset:17408
ds_read_b64_tr_b16 v[254:255], v5 offset:17920
v_exp_f32 v16, v52
v_mfma_f32_16x16x32_bf16 v[84:87], v[228:231], v[28:31], v[84:87]
s_waitcnt lgkmcnt(10)
ds_read_b64_tr_b16 v[228:229], v6 offset:17408
ds_read_b64_tr_b16 v[230:231], v6 offset:17920
v_exp_f32 v17, v53
v_mov_b32 v13, v16
v_mfma_f32_16x16x32_bf16 v[92:95], v[232:235], v[28:31], v[92:95]
s_waitcnt lgkmcnt(10)
ds_read_b64_tr_b16 v[232:233], v5 offset:17472
ds_read_b64_tr_b16 v[234:235], v5 offset:17984
v_add_f32 v13, v13, v17
v_mfma_f32_16x16x32_bf16 v[100:103], v[236:239], v[28:31], v[100:103]
s_waitcnt lgkmcnt(10)
ds_read_b64_tr_b16 v[236:237], v6 offset:17472
ds_read_b64_tr_b16 v[238:239], v6 offset:17984
v_mfma_f32_16x16x32_bf16 v[108:111], v[240:243], v[28:31], v[108:111]
s_waitcnt lgkmcnt(10)
ds_read_b64_tr_b16 v[240:241], v5 offset:21760
ds_read_b64_tr_b16 v[242:243], v5 offset:22272
v_mfma_f32_16x16x32_bf16 v[116:119], v[244:247], v[28:31], v[116:119]
s_waitcnt lgkmcnt(10)
ds_read_b64_tr_b16 v[244:245], v6 offset:21760
ds_read_b64_tr_b16 v[246:247], v6 offset:22272
v_mfma_f32_16x16x32_bf16 v[124:127], v[248:251], v[28:31], v[124:127]
s_waitcnt lgkmcnt(10)
ds_read_b64_tr_b16 v[248:249], v5 offset:21824
ds_read_b64_tr_b16 v[250:251], v5 offset:22336
s_add_u32 m0, s78, 66048
s_add_u32 s62, s62, 35840
v_cvt_pk_bf16_f32 v28, v16, v17
v_mfma_f32_16x16x32_bf16 a[32:35], v[252:255], v[204:207], a[32:35]
s_waitcnt lgkmcnt(10)
ds_read_b64_tr_b16 v[252:253], v6 offset:21824
ds_read_b64_tr_b16 v[254:255], v6 offset:22336
buffer_load_dwordx4 v4, s[48:51], s62 offen offset:0 nt lds
s_add_u32 m0, s78, 70400
v_mfma_f32_16x16x32_bf16 a[36:39], v[228:231], v[204:207], a[36:39]
s_waitcnt lgkmcnt(10)
ds_read_b128 v[228:231], v3 offset:16512
s_add_u32 s62, s62, 128
buffer_load_dwordx4 v4, s[48:51], s62 offen offset:0 nt lds
v_exp_f32 v18, v54
v_mfma_f32_16x16x32_bf16 a[40:43], v[232:235], v[204:207], a[40:43]
s_waitcnt lgkmcnt(9)
ds_read_b128 v[232:235], v3 offset:16576
s_add_u32 m0, s69, 41280
s_add_u32 s64, s64, 8192
v_exp_f32 v19, v55
v_mfma_f32_16x16x32_bf16 a[44:47], v[236:239], v[204:207], a[44:47]
s_waitcnt lgkmcnt(8)
ds_read_b128 v[236:239], v3 offset:17536
s_add_u32 s66, s66, 8192
buffer_load_dwordx4 v7, s[80:83], s64 offen offset:0 nt lds
v_add_f32 v13, v13, v18
v_add_f32 v13, v13, v19
v_mfma_f32_16x16x32_bf16 a[48:51], v[240:243], v[204:207], a[48:51]
s_waitcnt lgkmcnt(7)
ds_read_b128 v[240:243], v3 offset:17600
buffer_load_dwordx4 v7, s[80:83], s66 offen offset:1024 nt lds
s_add_u32 m0, s76, 24768
v_cvt_pk_bf16_f32 v29, v18, v19
v_mfma_f32_16x16x32_bf16 a[52:55], v[244:247], v[204:207], a[52:55]
s_waitcnt lgkmcnt(6)
ds_read_b128 v[244:247], v3 offset:17024
s_add_u32 s65, s65, 8192
s_add_u32 s67, s67, 8192
v_exp_f32 v16, v56
v_mfma_f32_16x16x32_bf16 a[56:59], v[248:251], v[204:207], a[56:59]
s_waitcnt lgkmcnt(5)
ds_read_b128 v[248:251], v3 offset:17088
buffer_load_dwordx4 v8, s[92:95], s65 offen offset:0 nt lds
buffer_load_dwordx4 v8, s[92:95], s67 offen offset:1024 nt lds
v_exp_f32 v17, v57
v_mfma_f32_16x16x32_bf16 a[60:63], v[252:255], v[204:207], a[60:63]
s_waitcnt lgkmcnt(5)
ds_read_b128 v[252:255], v3 offset:18048
v_add_f32 v13, v13, v16
v_add_f32 v13, v13, v17
v_cvt_pk_bf16_f32 v30, v16, v17
v_mfma_f32_16x16x32_bf16 v[36:39], v[228:231], v[164:167], v[20:23]
s_waitcnt lgkmcnt(5)
ds_read_b128 v[228:231], v3 offset:18112
v_exp_f32 v18, v58
v_exp_f32 v19, v59
v_mfma_f32_16x16x32_bf16 v[36:39], v[232:235], v[172:175], v[36:39]
s_waitcnt lgkmcnt(5)
v_add_f32 v13, v13, v18
v_add_f32 v13, v13, v19
v_cvt_pk_bf16_f32 v31, v18, v19
v_mov_b32 v204, v212
v_mov_b32 v205, v213
v_mfma_f32_16x16x32_bf16 v[36:39], v[236:239], v[180:183], v[36:39]
s_waitcnt vmcnt(13) lgkmcnt(0)
s_barrier
ds_read_b64_tr_b16 v[236:237], v1 offset:8256
ds_read_b64_tr_b16 v[238:239], v1 offset:8768
v_mov_b32 v206, v214
v_mfma_f32_16x16x32_bf16 v[36:39], v[240:243], v[188:191], v[36:39]
ds_read_b64_tr_b16 v[240:241], v1 offset:8264
ds_read_b64_tr_b16 v[242:243], v1 offset:8776
v_mov_b32 v207, v215
v_mov_b32 v212, v220
v_mov_b32 v213, v221
v_mov_b32 v214, v222
v_mfma_f32_16x16x32_bf16 v[40:43], v[244:247], v[164:167], v[20:23]
ds_read_b64_tr_b16 v[244:245], v2 offset:8256
ds_read_b64_tr_b16 v[246:247], v2 offset:8768
v_mov_b32 v215, v223
v_mfma_f32_16x16x32_bf16 v[40:43], v[248:251], v[172:175], v[40:43]
ds_read_b64_tr_b16 v[248:249], v2 offset:8264
ds_read_b64_tr_b16 v[250:251], v2 offset:8776
v_mfma_f32_16x16x32_bf16 v[40:43], v[252:255], v[180:183], v[40:43]
ds_read_b64_tr_b16 v[252:253], v1 offset:9280
ds_read_b64_tr_b16 v[254:255], v1 offset:9792
v_mfma_f32_16x16x32_bf16 v[40:43], v[228:231], v[188:191], v[40:43]
s_waitcnt lgkmcnt(8)
ds_read_b64_tr_b16 v[228:229], v1 offset:9288
ds_read_b64_tr_b16 v[230:231], v1 offset:9800
ds_read_b64_tr_b16 v[232:233], v2 offset:9280
ds_read_b64_tr_b16 v[234:235], v2 offset:9792
v_cmp_nle_f32 s[70:71], v13, s73
s_cmp_lg_u64 s[70:71], 0
s_cbranch_scc1 L_tr_WB5
L_back_WB5:
v_add_f32 v11, v11, v13
v_mfma_f32_16x16x32_bf16 v[68:71], v[236:239], v[28:31], v[68:71]
s_waitcnt lgkmcnt(10)
ds_read_b64_tr_b16 v[236:237], v2 offset:9288
ds_read_b64_tr_b16 v[238:239], v2 offset:9800
v_mfma_f32_16x16x32_bf16 v[76:79], v[240:243], v[28:31], v[76:79]
s_waitcnt lgkmcnt(10)
ds_read_b64_tr_b16 v[240:241], v5 offset:52224
ds_read_b64_tr_b16 v[242:243], v5 offset:52736
v_exp_f32 v16, v36
v_mfma_f32_16x16x32_bf16 v[84:87], v[244:247], v[28:31], v[84:87]
s_waitcnt lgkmcnt(10)
ds_read_b64_tr_b16 v[244:245], v6 offset:52224
ds_read_b64_tr_b16 v[246:247], v6 offset:52736
v_exp_f32 v17, v37
v_mov_b32 v13, v16
v_mfma_f32_16x16x32_bf16 v[92:95], v[248:251], v[28:31], v[92:95]
s_waitcnt lgkmcnt(10)
ds_read_b64_tr_b16 v[248:249], v5 offset:52288
ds_read_b64_tr_b16 v[250:251], v5 offset:52800
v_add_f32 v13, v13, v17
v_mfma_f32_16x16x32_bf16 v[100:103], v[252:255], v[28:31], v[100:103]
s_waitcnt lgkmcnt(10)
ds_read_b64_tr_b16 v[252:253], v6 offset:52288
ds_read_b64_tr_b16 v[254:255], v6 offset:52800
v_mfma_f32_16x16x32_bf16 v[108:111], v[228:231], v[28:31], v[108:111]
s_waitcnt lgkmcnt(10)
ds_read_b64_tr_b16 v[228:229], v5 offset:56576
ds_read_b64_tr_b16 v[230:231], v5 offset:57088
v_mfma_f32_16x16x32_bf16 v[116:119], v[232:235], v[28:31], v[116:119]
s_waitcnt lgkmcnt(10)
ds_read_b64_tr_b16 v[232:233], v6 offset:56576
ds_read_b64_tr_b16 v[234:235], v6 offset:57088
v_mfma_f32_16x16x32_bf16 v[124:127], v[236:239], v[28:31], v[124:127]
s_waitcnt lgkmcnt(10)
ds_read_b64_tr_b16 v[236:237], v5 offset:56640
ds_read_b64_tr_b16 v[238:239], v5 offset:57152
s_add_u32 m0, s78, 83456
s_add_u32 s62, s62, 128
v_cvt_pk_bf16_f32 v28, v16, v17
v_mfma_f32_16x16x32_bf16 a[64:67], v[240:243], v[196:199], a[64:67]
s_waitcnt lgkmcnt(10)
ds_read_b64_tr_b16 v[240:241], v6 offset:56640
ds_read_b64_tr_b16 v[242:243], v6 offset:57152
buffer_load_dwordx4 v4, s[48:51], s62 offen offset:0 nt lds
s_add_u32 m0, s78, 87808
v_mfma_f32_16x16x32_bf16 a[68:71], v[244:247], v[196:199], a[68:71]
s_waitcnt lgkmcnt(10)
ds_read_b128 v[244:247], v3 offset:24768
s_add_u32 s62, s62, 128
buffer_load_dwordx4 v4, s[48:51], s62 offen offset:0 nt lds
v_exp_f32 v18, v38
v_mfma_f32_16x16x32_bf16 a[72:75], v[248:251], v[196:199], a[72:75]
s_waitcnt lgkmcnt(9)
ds_read_b128 v[248:251], v3 offset:24832
s_add_u32 m0, s69, 49536
s_add_u32 s64, s64, 8192
v_exp_f32 v19, v39
v_mfma_f32_16x16x32_bf16 a[76:79], v[252:255], v[196:199], a[76:79]
s_waitcnt lgkmcnt(8)
ds_read_b128 v[252:255], v3 offset:25792
s_add_u32 s66, s66, 8192
buffer_load_dwordx4 v7, s[80:83], s64 offen offset:0 nt lds
v_add_f32 v13, v13, v18
v_add_f32 v13, v13, v19
v_mfma_f32_16x16x32_bf16 a[80:83], v[228:231], v[196:199], a[80:83]
s_waitcnt lgkmcnt(7)
ds_read_b128 v[228:231], v3 offset:25856
buffer_load_dwordx4 v7, s[80:83], s66 offen offset:1024 nt lds
s_add_u32 m0, s76, 0
v_cvt_pk_bf16_f32 v29, v18, v19
v_mfma_f32_16x16x32_bf16 a[84:87], v[232:235], v[196:199], a[84:87]
s_waitcnt lgkmcnt(6)
ds_read_b128 v[232:235], v3 offset:25280
s_add_u32 s65, s65, 8192
s_add_u32 s67, s67, 8192
v_exp_f32 v16, v40
v_mfma_f32_16x16x32_bf16 a[88:91], v[236:239], v[196:199], a[88:91]
s_waitcnt lgkmcnt(5)
ds_read_b128 v[236:239], v3 offset:25344
buffer_load_dwordx4 v8, s[92:95], s65 offen offset:0 nt lds
buffer_load_dwordx4 v8, s[92:95], s67 offen offset:1024 nt lds
v_exp_f32 v17, v41
v_mfma_f32_16x16x32_bf16 a[92:95], v[240:243], v[196:199], a[92:95]
s_waitcnt lgkmcnt(5)
ds_read_b128 v[240:243], v3 offset:26304
v_add_f32 v13, v13, v16
v_add_f32 v13, v13, v17
v_cvt_pk_bf16_f32 v30, v16, v17
v_mfma_f32_16x16x32_bf16 v[52:55], v[244:247], v[164:167], v[20:23]
s_waitcnt lgkmcnt(5)
ds_read_b128 v[244:247], v3 offset:26368
v_exp_f32 v18, v42
v_exp_f32 v19, v43
v_mfma_f32_16x16x32_bf16 v[52:55], v[248:251], v[172:175], v[52:55]
s_waitcnt lgkmcnt(5)
v_add_f32 v13, v13, v18
v_add_f32 v13, v13, v19
v_cvt_pk_bf16_f32 v31, v18, v19
v_mfma_f32_16x16x32_bf16 v[52:55], v[252:255], v[180:183], v[52:55]
s_sub_u32 s39, s39, 1
s_cmp_lg_u32 s39, 0
s_cbranch_scc1 L_loop5
s_waitcnt vmcnt(12) lgkmcnt(0)
s_barrier
ds_read_b64_tr_b16 v[252:253], v1 offset:16512
ds_read_b64_tr_b16 v[254:255], v1 offset:17024
v_mfma_f32_16x16x32_bf16 v[52:55], v[228:231], v[188:191], v[52:55]
ds_read_b64_tr_b16 v[228:229], v1 offset:16520
ds_read_b64_tr_b16 v[230:231], v1 offset:17032
v_mfma_f32_16x16x32_bf16 v[56:59], v[232:235], v[164:167], v[20:23]
ds_read_b64_tr_b16 v[232:233], v2 offset:16512
ds_read_b64_tr_b16 v[234:235], v2 offset:17024
v_mfma_f32_16x16x32_bf16 v[56:59], v[236:239], v[172:175], v[56:59]
ds_read_b64_tr_b16 v[236:237], v2 offset:16520
ds_read_b64_tr_b16 v[238:239], v2 offset:17032
v_mfma_f32_16x16x32_bf16 v[56:59], v[240:243], v[180:183], v[56:59]
ds_read_b64_tr_b16 v[240:241], v1 offset:17536
ds_read_b64_tr_b16 v[242:243], v1 offset:18048
v_mfma_f32_16x16x32_bf16 v[56:59], v[244:247], v[188:191], v[56:59]
s_waitcnt lgkmcnt(8)
ds_read_b64_tr_b16 v[244:245], v1 offset:17544
ds_read_b64_tr_b16 v[246:247], v1 offset:18056
ds_read_b64_tr_b16 v[248:249], v2 offset:17536
ds_read_b64_tr_b16 v[250:251], v2 offset:18048
v_cmp_nle_f32 s[70:71], v13, s73
s_cmp_lg_u64 s[70:71], 0
s_cbranch_scc1 L_tr_WB14
L_back_WB14:
v_add_f32 v11, v11, v13
v_mfma_f32_16x16x32_bf16 v[68:71], v[252:255], v[28:31], v[68:71]
s_waitcnt lgkmcnt(10)
ds_read_b64_tr_b16 v[252:253], v2 offset:17544
ds_read_b64_tr_b16 v[254:255], v2 offset:18056
v_mfma_f32_16x16x32_bf16 v[76:79], v[228:231], v[28:31], v[76:79]
s_waitcnt lgkmcnt(10)
ds_read_b64_tr_b16 v[228:229], v5 offset:34816
ds_read_b64_tr_b16 v[230:231], v5 offset:35328
v_exp_f32 v16, v52
v_mfma_f32_16x16x32_bf16 v[84:87], v[232:235], v[28:31], v[84:87]
s_waitcnt lgkmcnt(10)
ds_read_b64_tr_b16 v[232:233], v6 offset:34816
ds_read_b64_tr_b16 v[234:235], v6 offset:35328
v_exp_f32 v17, v53
v_mov_b32 v13, v16
v_mfma_f32_16x16x32_bf16 v[92:95], v[236:239], v[28:31], v[92:95]
s_waitcnt lgkmcnt(10)
ds_read_b64_tr_b16 v[236:237], v5 offset:34880
ds_read_b64_tr_b16 v[238:239], v5 offset:35392
s_add_u32 m0, s78, 118272
s_add_u32 s62, s62, 128
buffer_load_dwordx4 v4, s[48:51], s62 offen offset:0 nt lds
s_add_u32 m0, s78, 122624
s_add_u32 s62, s62, 128
buffer_load_dwordx4 v4, s[48:51], s62 offen offset:0 nt lds
v_mfma_f32_16x16x32_bf16 v[100:103], v[240:243], v[28:31], v[100:103]
s_waitcnt lgkmcnt(10)
ds_read_b64_tr_b16 v[240:241], v6 offset:34880
ds_read_b64_tr_b16 v[242:243], v6 offset:35392
s_add_u32 m0, s69, 57792
s_add_u32 s64, s64, 8192
v_add_f32 v13, v13, v17
v_mfma_f32_16x16x32_bf16 v[108:111], v[244:247], v[28:31], v[108:111]
s_waitcnt lgkmcnt(10)
ds_read_b64_tr_b16 v[244:245], v5 offset:39168
ds_read_b64_tr_b16 v[246:247], v5 offset:39680
s_add_u32 s66, s66, 8192
buffer_load_dwordx4 v7, s[80:83], s64 offen offset:0 nt lds
v_mfma_f32_16x16x32_bf16 v[116:119], v[248:251], v[28:31], v[116:119]
s_waitcnt lgkmcnt(10)
ds_read_b64_tr_b16 v[248:249], v6 offset:39168
ds_read_b64_tr_b16 v[250:251], v6 offset:39680
buffer_load_dwordx4 v7, s[80:83], s66 offen offset:1024 nt lds
s_add_u32 m0, s76, 8256
v_mfma_f32_16x16x32_bf16 v[124:127], v[252:255], v[28:31], v[124:127]
s_waitcnt lgkmcnt(10)
ds_read_b64_tr_b16 v[252:253], v5 offset:39232
ds_read_b64_tr_b16 v[254:255], v5 offset:39744
s_add_u32 s65, s65, 8192
s_add_u32 s67, s67, 8192
v_cvt_pk_bf16_f32 v28, v16, v17
v_mfma_f32_16x16x32_bf16 a[96:99], v[228:231], v[196:199], a[96:99]
s_waitcnt lgkmcnt(10)
ds_read_b64_tr_b16 v[228:229], v6 offset:39232
ds_read_b64_tr_b16 v[230:231], v6 offset:39744
buffer_load_dwordx4 v8, s[92:95], s65 offen offset:0 nt lds
buffer_load_dwordx4 v8, s[92:95], s67 offen offset:1024 nt lds
v_mfma_f32_16x16x32_bf16 a[100:103], v[232:235], v[196:199], a[100:103]
s_waitcnt lgkmcnt(10)
ds_read_b64_tr_b16 v[232:233], v5 offset:43520
ds_read_b64_tr_b16 v[234:235], v5 offset:44032
buffer_load_dwordx4 v[164:167], v10, s[28:31], s38 offen offset:0
buffer_load_dwordx4 v[172:175], v10, s[28:31], s38 offen offset:2048
v_exp_f32 v18, v54
v_mfma_f32_16x16x32_bf16 a[104:107], v[236:239], v[196:199], a[104:107]
s_waitcnt lgkmcnt(10)
ds_read_b64_tr_b16 v[236:237], v6 offset:43520
ds_read_b64_tr_b16 v[238:239], v6 offset:44032
buffer_load_dwordx4 v[180:183], v10, s[28:31], s74 offen offset:0
buffer_load_dwordx4 v[188:191], v10, s[28:31], s74 offen offset:2048
v_exp_f32 v19, v55
v_mfma_f32_16x16x32_bf16 a[108:111], v[240:243], v[196:199], a[108:111]
s_waitcnt lgkmcnt(10)
ds_read_b64_tr_b16 v[240:241], v5 offset:43584
ds_read_b64_tr_b16 v[242:243], v5 offset:44096
s_add_u32 s38, s38, 8192
s_add_u32 s74, s74, 8192
v_add_f32 v13, v13, v18
v_mfma_f32_16x16x32_bf16 a[112:115], v[244:247], v[196:199], a[112:115]
s_waitcnt lgkmcnt(10)
ds_read_b64_tr_b16 v[244:245], v6 offset:43584
ds_read_b64_tr_b16 v[246:247], v6 offset:44096
v_add_f32 v13, v13, v19
v_cvt_pk_bf16_f32 v29, v18, v19
v_mfma_f32_16x16x32_bf16 a[116:119], v[248:251], v[196:199], a[116:119]
s_waitcnt lgkmcnt(10)
v_exp_f32 v16, v56
v_exp_f32 v17, v57
v_add_f32 v13, v13, v16
v_mfma_f32_16x16x32_bf16 a[120:123], v[252:255], v[196:199], a[120:123]
s_waitcnt vmcnt(16) lgkmcnt(0)
s_barrier
ds_read_b64_tr_b16 v[248:249], v1 offset:24768
ds_read_b64_tr_b16 v[250:251], v1 offset:25280
ds_read_b64_tr_b16 v[252:253], v1 offset:24776
ds_read_b64_tr_b16 v[254:255], v1 offset:25288
v_mfma_f32_16x16x32_bf16 a[124:127], v[228:231], v[196:199], a[124:127]
ds_read_b64_tr_b16 v[228:229], v2 offset:24768
ds_read_b64_tr_b16 v[230:231], v2 offset:25280
v_add_f32 v13, v13, v17
v_cvt_pk_bf16_f32 v30, v16, v17
v_exp_f32 v18, v58
v_mfma_f32_16x16x32_bf16 a[128:131], v[232:235], v[196:199], a[128:131]
ds_read_b64_tr_b16 v[232:233], v2 offset:24776
ds_read_b64_tr_b16 v[234:235], v2 offset:25288
v_exp_f32 v19, v59
v_add_f32 v13, v13, v18
v_add_f32 v13, v13, v19
v_mfma_f32_16x16x32_bf16 a[132:135], v[236:239], v[196:199], a[132:135]
ds_read_b64_tr_b16 v[236:237], v1 offset:25792
ds_read_b64_tr_b16 v[238:239], v1 offset:26304
v_cvt_pk_bf16_f32 v31, v18, v19
v_mfma_f32_16x16x32_bf16 a[136:139], v[240:243], v[196:199], a[136:139]
ds_read_b64_tr_b16 v[240:241], v1 offset:25800
ds_read_b64_tr_b16 v[242:243], v1 offset:26312
v_mfma_f32_16x16x32_bf16 a[140:143], v[244:247], v[196:199], a[140:143]
s_waitcnt lgkmcnt(10)
ds_read_b64_tr_b16 v[244:245], v2 offset:25792
ds_read_b64_tr_b16 v[246:247], v2 offset:26304
v_cmp_nle_f32 s[70:71], v13, s73
s_cmp_lg_u64 s[70:71], 0
s_cbranch_scc1 L_tr_WB15
L_back_WB15:
v_add_f32 v11, v11, v13
v_mfma_f32_16x16x32_bf16 v[68:71], v[248:251], v[28:31], v[68:71]
s_waitcnt lgkmcnt(10)
ds_read_b64_tr_b16 v[248:249], v2 offset:25800
ds_read_b64_tr_b16 v[250:251], v2 offset:26312
v_mfma_f32_16x16x32_bf16 v[76:79], v[252:255], v[28:31], v[76:79]
s_waitcnt lgkmcnt(10)
v_mfma_f32_16x16x32_bf16 v[84:87], v[228:231], v[28:31], v[84:87]
s_waitcnt lgkmcnt(8)
v_mfma_f32_16x16x32_bf16 v[92:95], v[232:235], v[28:31], v[92:95]
s_waitcnt lgkmcnt(6)
v_mfma_f32_16x16x32_bf16 v[100:103], v[236:239], v[28:31], v[100:103]
s_waitcnt lgkmcnt(4)
v_mfma_f32_16x16x32_bf16 v[108:111], v[240:243], v[28:31], v[108:111]
s_waitcnt lgkmcnt(2)
v_mfma_f32_16x16x32_bf16 v[116:119], v[244:247], v[28:31], v[116:119]
s_waitcnt lgkmcnt(0)
v_mfma_f32_16x16x32_bf16 v[124:127], v[248:251], v[28:31], v[124:127]
s_nop 3
v_mov_b32 v15, v11
s_nop 1
v_permlane32_swap_b32 v11, v15
v_add_f32 v11, v11, v15
v_mov_b32 v15, v11
s_nop 1
v_permlane16_swap_b32 v11, v15
v_add_f32 v11, v11, v15
v_rcp_f32 v16, v11
s_nop 3
v_mul_f32 v68, v68, v16
v_mul_f32 v69, v69, v16
v_mul_f32 v70, v70, v16
v_mul_f32 v71, v71, v16
v_cvt_pk_bf16_f32 v196, v68, v69
v_cvt_pk_bf16_f32 v197, v70, v71
v_mul_f32 v76, v76, v16
v_mul_f32 v77, v77, v16
v_mul_f32 v78, v78, v16
v_mul_f32 v79, v79, v16
v_cvt_pk_bf16_f32 v198, v76, v77
v_cvt_pk_bf16_f32 v199, v78, v79
v_mul_f32 v84, v84, v16
v_mul_f32 v85, v85, v16
v_mul_f32 v86, v86, v16
v_mul_f32 v87, v87, v16
v_cvt_pk_bf16_f32 v204, v84, v85
v_cvt_pk_bf16_f32 v205, v86, v87
v_mul_f32 v92, v92, v16
v_mul_f32 v93, v93, v16
v_mul_f32 v94, v94, v16
v_mul_f32 v95, v95, v16
v_cvt_pk_bf16_f32 v206, v92, v93
v_cvt_pk_bf16_f32 v207, v94, v95
v_mul_f32 v100, v100, v16
v_mul_f32 v101, v101, v16
v_mul_f32 v102, v102, v16
v_mul_f32 v103, v103, v16
v_cvt_pk_bf16_f32 v212, v100, v101
v_cvt_pk_bf16_f32 v213, v102, v103
v_mul_f32 v108, v108, v16
v_mul_f32 v109, v109, v16
v_mul_f32 v110, v110, v16
v_mul_f32 v111, v111, v16
v_cvt_pk_bf16_f32 v214, v108, v109
v_cvt_pk_bf16_f32 v215, v110, v111
v_mul_f32 v116, v116, v16
v_mul_f32 v117, v117, v16
v_mul_f32 v118, v118, v16
v_mul_f32 v119, v119, v16
v_cvt_pk_bf16_f32 v220, v116, v117
v_cvt_pk_bf16_f32 v221, v118, v119
v_mul_f32 v124, v124, v16
v_mul_f32 v125, v125, v16
v_mul_f32 v126, v126, v16
v_mul_f32 v127, v127, v16
v_cvt_pk_bf16_f32 v222, v124, v125
v_cvt_pk_bf16_f32 v223, v126, v127
s_nop 1
s_add_u32 s58, s58, 1
s_cmp_lt_u32 s58, 4
s_cbranch_scc1 L_head_W
s_waitcnt lgkmcnt(0)
s_barrier
ds_read_b64_tr_b16 v[228:229], v5 offset:0
ds_read_b64_tr_b16 v[230:231], v5 offset:512
ds_read_b64_tr_b16 v[232:233], v6 offset:0
ds_read_b64_tr_b16 v[234:235], v6 offset:512
ds_read_b64_tr_b16 v[236:237], v5 offset:64
ds_read_b64_tr_b16 v[238:239], v5 offset:576
ds_read_b64_tr_b16 v[240:241], v6 offset:64
ds_read_b64_tr_b16 v[242:243], v6 offset:576
ds_read_b64_tr_b16 v[244:245], v5 offset:4352
ds_read_b64_tr_b16 v[246:247], v5 offset:4864
ds_read_b64_tr_b16 v[248:249], v6 offset:4352
ds_read_b64_tr_b16 v[250:251], v6 offset:4864
ds_read_b64_tr_b16 v[252:253], v5 offset:4416
ds_read_b64_tr_b16 v[254:255], v5 offset:4928
s_add_u32 m0, s78, 100864
s_add_u32 s62, s62, 128
buffer_load_dwordx4 v4, s[48:51], s62 offen offset:0 nt lds
s_waitcnt lgkmcnt(12)
v_mfma_f32_16x16x32_bf16 a[0:3], v[228:231], v[196:199], a[0:3]
s_waitcnt lgkmcnt(10)
ds_read_b64_tr_b16 v[228:229], v6 offset:4416
ds_read_b64_tr_b16 v[230:231], v6 offset:4928
s_add_u32 m0, s78, 105216
s_add_u32 s62, s62, 128
v_mfma_f32_16x16x32_bf16 a[4:7], v[232:235], v[196:199], a[4:7]
s_waitcnt lgkmcnt(10)
buffer_load_dwordx4 v4, s[48:51], s62 offen offset:0 nt lds
s_add_u32 m0, s78, 109568
v_mfma_f32_16x16x32_bf16 a[8:11], v[236:239], v[196:199], a[8:11]
s_waitcnt vmcnt(16) lgkmcnt(0)
s_barrier
s_add_u32 s62, s62, 128
buffer_load_dwordx4 v4, s[48:51], s62 offen offset:0 nt lds
v_mfma_f32_16x16x32_bf16 a[12:15], v[240:243], v[196:199], a[12:15]
ds_read_b64_tr_b16 v[240:241], v5 offset:17408
ds_read_b64_tr_b16 v[242:243], v5 offset:17920
s_add_u32 m0, s78, 66048
s_add_u32 s62, s62, 35840
v_mfma_f32_16x16x32_bf16 a[16:19], v[244:247], v[196:199], a[16:19]
ds_read_b64_tr_b16 v[244:245], v6 offset:17408
ds_read_b64_tr_b16 v[246:247], v6 offset:17920
buffer_load_dwordx4 v4, s[48:51], s62 offen offset:0 nt lds
s_add_u32 m0, s78, 70400
v_mfma_f32_16x16x32_bf16 a[20:23], v[248:251], v[196:199], a[20:23]
ds_read_b64_tr_b16 v[248:249], v5 offset:17472
ds_read_b64_tr_b16 v[250:251], v5 offset:17984
s_add_u32 s62, s62, 128
buffer_load_dwordx4 v4, s[48:51], s62 offen offset:0 nt lds
v_mfma_f32_16x16x32_bf16 a[24:27], v[252:255], v[196:199], a[24:27]
ds_read_b64_tr_b16 v[252:253], v6 offset:17472
ds_read_b64_tr_b16 v[254:255], v6 offset:17984
v_mfma_f32_16x16x32_bf16 a[28:31], v[228:231], v[196:199], a[28:31]
s_waitcnt lgkmcnt(6)
ds_read_b64_tr_b16 v[228:229], v5 offset:21760
ds_read_b64_tr_b16 v[230:231], v5 offset:22272
ds_read_b64_tr_b16 v[232:233], v6 offset:21760
ds_read_b64_tr_b16 v[234:235], v6 offset:22272
v_mfma_f32_16x16x32_bf16 a[32:35], v[240:243], v[196:199], a[32:35]
s_waitcnt lgkmcnt(8)
ds_read_b64_tr_b16 v[236:237], v5 offset:21824
ds_read_b64_tr_b16 v[238:239], v5 offset:22336
ds_read_b64_tr_b16 v[240:241], v6 offset:21824
ds_read_b64_tr_b16 v[242:243], v6 offset:22336
v_mfma_f32_16x16x32_bf16 a[36:39], v[244:247], v[196:199], a[36:39]
s_waitcnt lgkmcnt(10)
v_mfma_f32_16x16x32_bf16 a[40:43], v[248:251], v[196:199], a[40:43]
s_mov_b32 s39, 3
L_loop6:
s_waitcnt vmcnt(5) lgkmcnt(0)
s_barrier
s_add_u32 m0, s78, 83456
s_add_u32 s62, s62, 128
v_mfma_f32_16x16x32_bf16 a[44:47], v[252:255], v[196:199], a[44:47]
ds_read_b64_tr_b16 v[252:253], v5 offset:52224
ds_read_b64_tr_b16 v[254:255], v5 offset:52736
buffer_load_dwordx4 v4, s[48:51], s62 offen offset:0 nt lds
s_add_u32 m0, s78, 87808
v_mfma_f32_16x16x32_bf16 a[48:51], v[228:231], v[196:199], a[48:51]
ds_read_b64_tr_b16 v[228:229], v6 offset:52224
ds_read_b64_tr_b16 v[230:231], v6 offset:52736
s_add_u32 s62, s62, 128
buffer_load_dwordx4 v4, s[48:51], s62 offen offset:0 nt lds
v_mfma_f32_16x16x32_bf16 a[52:55], v[232:235], v[196:199], a[52:55]
ds_read_b64_tr_b16 v[232:233], v5 offset:52288
ds_read_b64_tr_b16 v[234:235], v5 offset:52800
v_mfma_f32_16x16x32_bf16 a[56:59], v[236:239], v[196:199], a[56:59]
ds_read_b64_tr_b16 v[236:237], v6 offset:52288
ds_read_b64_tr_b16 v[238:239], v6 offset:52800
v_mfma_f32_16x16x32_bf16 a[60:63], v[240:243], v[196:199], a[60:63]
s_waitcnt lgkmcnt(6)
ds_read_b64_tr_b16 v[240:241], v5 offset:56576
ds_read_b64_tr_b16 v[242:243], v5 offset:57088
ds_read_b64_tr_b16 v[244:245], v6 offset:56576
ds_read_b64_tr_b16 v[246:247], v6 offset:57088
v_mfma_f32_16x16x32_bf16 a[64:67], v[252:255], v[196:199], a[64:67]
s_waitcnt lgkmcnt(8)
ds_read_b64_tr_b16 v[248:249], v5 offset:56640
ds_read_b64_tr_b16 v[250:251], v5 offset:57152
ds_read_b64_tr_b16 v[252:253], v6 offset:56640
ds_read_b64_tr_b16 v[254:255], v6 offset:57152
v_mfma_f32_16x16x32_bf16 a[68:71], v[228:231], v[196:199], a[68:71]
s_waitcnt lgkmcnt(10)
v_mfma_f32_16x16x32_bf16 a[72:75], v[232:235], v[196:199], a[72:75]
s_waitcnt vmcnt(4) lgkmcnt(0)
s_barrier
s_add_u32 m0, s78, 118272
s_add_u32 s62, s62, 128
v_mfma_f32_16x16x32_bf16 a[76:79], v[236:239], v[196:199], a[76:79]
ds_read_b64_tr_b16 v[236:237], v5 offset:34816
ds_read_b64_tr_b16 v[238:239], v5 offset:35328
buffer_load_dwordx4 v4, s[48:51], s62 offen offset:0 nt lds
s_add_u32 m0, s78, 122624
v_mfma_f32_16x16x32_bf16 a[80:83], v[240:243], v[196:199], a[80:83]
ds_read_b64_tr_b16 v[240:241], v6 offset:34816
ds_read_b64_tr_b16 v[242:243], v6 offset:35328
s_add_u32 s62, s62, 128
buffer_load_dwordx4 v4, s[48:51], s62 offen offset:0 nt lds
v_mfma_f32_16x16x32_bf16 a[84:87], v[244:247], v[196:199], a[84:87]
ds_read_b64_tr_b16 v[244:245], v5 offset:34880
ds_read_b64_tr_b16 v[246:247], v5 offset:35392
v_mfma_f32_16x16x32_bf16 a[88:91], v[248:251], v[196:199], a[88:91]
ds_read_b64_tr_b16 v[248:249], v6 offset:34880
ds_read_b64_tr_b16 v[250:251], v6 offset:35392
v_mfma_f32_16x16x32_bf16 a[92:95], v[252:255], v[196:199], a[92:95]
s_waitcnt lgkmcnt(6)
ds_read_b64_tr_b16 v[252:253], v5 offset:39168
ds_read_b64_tr_b16 v[254:255], v5 offset:39680
ds_read_b64_tr_b16 v[228:229], v6 offset:39168
ds_read_b64_tr_b16 v[230:231], v6 offset:39680
v_mfma_f32_16x16x32_bf16 a[96:99], v[236:239], v[196:199], a[96:99]
s_waitcnt lgkmcnt(8)
ds_read_b64_tr_b16 v[232:233], v5 offset:39232
ds_read_b64_tr_b16 v[234:235], v5 offset:39744
ds_read_b64_tr_b16 v[236:237], v6 offset:39232
ds_read_b64_tr_b16 v[238:239], v6 offset:39744
v_mfma_f32_16x16x32_bf16 a[100:103], v[240:243], v[196:199], a[100:103]
s_waitcnt lgkmcnt(10)
ds_read_b64_tr_b16 v[240:241], v5 offset:43520
ds_read_b64_tr_b16 v[242:243], v5 offset:44032
v_mfma_f32_16x16x32_bf16 a[104:107], v[244:247], v[196:199], a[104:107]
s_waitcnt lgkmcnt(10)
ds_read_b64_tr_b16 v[244:245], v6 offset:43520
ds_read_b64_tr_b16 v[246:247], v6 offset:44032
v_mfma_f32_16x16x32_bf16 a[108:111], v[248:251], v[196:199], a[108:111]
s_waitcnt lgkmcnt(10)
ds_read_b64_tr_b16 v[248:249], v5 offset:43584
ds_read_b64_tr_b16 v[250:251], v5 offset:44096
v_mfma_f32_16x16x32_bf16 a[112:115], v[252:255], v[196:199], a[112:115]
s_waitcnt lgkmcnt(10)
ds_read_b64_tr_b16 v[252:253], v6 offset:43584
ds_read_b64_tr_b16 v[254:255], v6 offset:44096
v_mfma_f32_16x16x32_bf16 a[116:119], v[228:231], v[196:199], a[116:119]
s_waitcnt lgkmcnt(10)
v_mfma_f32_16x16x32_bf16 a[120:123], v[232:235], v[196:199], a[120:123]
s_waitcnt vmcnt(4) lgkmcnt(0)
s_barrier
ds_read_b64_tr_b16 v[228:229], v5 offset:0
ds_read_b64_tr_b16 v[230:231], v5 offset:512
ds_read_b64_tr_b16 v[232:233], v6 offset:0
ds_read_b64_tr_b16 v[234:235], v6 offset:512
v_mfma_f32_16x16x32_bf16 a[124:127], v[236:239], v[196:199], a[124:127]
ds_read_b64_tr_b16 v[236:237], v5 offset:64
ds_read_b64_tr_b16 v[238:239], v5 offset:576
s_add_u32 m0, s78, 100864
s_add_u32 s62, s62, 128
v_mfma_f32_16x16x32_bf16 a[128:131], v[240:243], v[196:199], a[128:131]
ds_read_b64_tr_b16 v[240:241], v6 offset:64
ds_read_b64_tr_b16 v[242:243], v6 offset:576
buffer_load_dwordx4 v4, s[48:51], s62 offen offset:0 nt lds
s_add_u32 m0, s78, 105216
v_mfma_f32_16x16x32_bf16 a[132:135], v[244:247], v[196:199], a[132:135]
ds_read_b64_tr_b16 v[244:245], v5 offset:4352
ds_read_b64_tr_b16 v[246:247], v5 offset:4864
s_add_u32 s62, s62, 128
buffer_load_dwordx4 v4, s[48:51], s62 offen offset:0 nt lds
v_mfma_f32_16x16x32_bf16 a[136:139], v[248:251], v[196:199], a[136:139]
ds_read_b64_tr_b16 v[248:249], v6 offset:4352
ds_read_b64_tr_b16 v[250:251], v6 offset:4864
s_add_u32 m0, s78, 109568
s_add_u32 s62, s62, 128
v_mfma_f32_16x16x32_bf16 a[140:143], v[252:255], v[196:199], a[140:143]
s_waitcnt lgkmcnt(10)
ds_read_b64_tr_b16 v[252:253], v5 offset:4416
ds_read_b64_tr_b16 v[254:255], v5 offset:4928
buffer_load_dwordx4 v4, s[48:51], s62 offen offset:0 nt lds
v_mov_b32 v196, v204
v_mov_b32 v197, v205
v_mov_b32 v198, v206
v_mov_b32 v199, v207
v_mov_b32 v200, v208
v_mov_b32 v201, v209
v_mov_b32 v202, v210
v_mov_b32 v203, v211
v_mov_b32 v204, v212
v_mov_b32 v205, v213
v_mov_b32 v206, v214
v_mov_b32 v207, v215
v_mov_b32 v208, v216
v_mov_b32 v209, v217
v_mov_b32 v210, v218
v_mov_b32 v211, v219
v_mov_b32 v212, v220
v_mov_b32 v213, v221
v_mov_b32 v214, v222
v_mov_b32 v215, v223
v_mov_b32 v216, v224
v_mov_b32 v217, v225
v_mov_b32 v218, v226
v_mov_b32 v219, v227
s_nop 1
v_mfma_f32_16x16x32_bf16 a[0:3], v[228:231], v[196:199], a[0:3]
s_waitcnt lgkmcnt(10)
ds_read_b64_tr_b16 v[228:229], v6 offset:4416
ds_read_b64_tr_b16 v[230:231], v6 offset:4928
v_mfma_f32_16x16x32_bf16 a[4:7], v[232:235], v[196:199], a[4:7]
s_waitcnt lgkmcnt(10)
v_mfma_f32_16x16x32_bf16 a[8:11], v[236:239], v[196:199], a[8:11]
s_waitcnt vmcnt(5) lgkmcnt(0)
s_barrier
s_add_u32 m0, s78, 66048
s_add_u32 s62, s62, 35840
v_mfma_f32_16x16x32_bf16 a[12:15], v[240:243], v[196:199], a[12:15]
ds_read_b64_tr_b16 v[240:241], v5 offset:17408
ds_read_b64_tr_b16 v[242:243], v5 offset:17920
buffer_load_dwordx4 v4, s[48:51], s62 offen offset:0 nt lds
s_add_u32 m0, s78, 70400
v_mfma_f32_16x16x32_bf16 a[16:19], v[244:247], v[196:199], a[16:19]
ds_read_b64_tr_b16 v[244:245], v6 offset:17408
ds_read_b64_tr_b16 v[246:247], v6 offset:17920
s_add_u32 s62, s62, 128
buffer_load_dwordx4 v4, s[48:51], s62 offen offset:0 nt lds
v_mfma_f32_16x16x32_bf16 a[20:23], v[248:251], v[196:199], a[20:23]
ds_read_b64_tr_b16 v[248:249], v5 offset:17472
ds_read_b64_tr_b16 v[250:251], v5 offset:17984
v_mfma_f32_16x16x32_bf16 a[24:27], v[252:255], v[196:199], a[24:27]
ds_read_b64_tr_b16 v[252:253], v6 offset:17472
ds_read_b64_tr_b16 v[254:255], v6 offset:17984
v_mfma_f32_16x16x32_bf16 a[28:31], v[228:231], v[196:199], a[28:31]
s_waitcnt lgkmcnt(6)
ds_read_b64_tr_b16 v[228:229], v5 offset:21760
ds_read_b64_tr_b16 v[230:231], v5 offset:22272
ds_read_b64_tr_b16 v[232:233], v6 offset:21760
ds_read_b64_tr_b16 v[234:235], v6 offset:22272
v_mfma_f32_16x16x32_bf16 a[32:35], v[240:243], v[196:199], a[32:35]
s_waitcnt lgkmcnt(8)
ds_read_b64_tr_b16 v[236:237], v5 offset:21824
ds_read_b64_tr_b16 v[238:239], v5 offset:22336
ds_read_b64_tr_b16 v[240:241], v6 offset:21824
ds_read_b64_tr_b16 v[242:243], v6 offset:22336
v_mfma_f32_16x16x32_bf16 a[36:39], v[244:247], v[196:199], a[36:39]
s_waitcnt lgkmcnt(10)
v_mfma_f32_16x16x32_bf16 a[40:43], v[248:251], v[196:199], a[40:43]
s_sub_u32 s39, s39, 1
s_cmp_lg_u32 s39, 0
s_cbranch_scc1 L_loop6
s_waitcnt vmcnt(5) lgkmcnt(0)
s_barrier
s_add_u32 m0, s78, 83456
s_add_u32 s62, s62, 128
v_mfma_f32_16x16x32_bf16 a[44:47], v[252:255], v[196:199], a[44:47]
ds_read_b64_tr_b16 v[252:253], v5 offset:52224
ds_read_b64_tr_b16 v[254:255], v5 offset:52736
buffer_load_dwordx4 v4, s[48:51], s62 offen offset:0 nt lds
s_add_u32 m0, s78, 87808
v_mfma_f32_16x16x32_bf16 a[48:51], v[228:231], v[196:199], a[48:51]
ds_read_b64_tr_b16 v[228:229], v6 offset:52224
ds_read_b64_tr_b16 v[230:231], v6 offset:52736
s_add_u32 s62, s62, 128
buffer_load_dwordx4 v4, s[48:51], s62 offen offset:0 nt lds
v_mfma_f32_16x16x32_bf16 a[52:55], v[232:235], v[196:199], a[52:55]
ds_read_b64_tr_b16 v[232:233], v5 offset:52288
ds_read_b64_tr_b16 v[234:235], v5 offset:52800
v_mfma_f32_16x16x32_bf16 a[56:59], v[236:239], v[196:199], a[56:59]
ds_read_b64_tr_b16 v[236:237], v6 offset:52288
ds_read_b64_tr_b16 v[238:239], v6 offset:52800
v_mfma_f32_16x16x32_bf16 a[60:63], v[240:243], v[196:199], a[60:63]
s_waitcnt lgkmcnt(6)
ds_read_b64_tr_b16 v[240:241], v5 offset:56576
ds_read_b64_tr_b16 v[242:243], v5 offset:57088
ds_read_b64_tr_b16 v[244:245], v6 offset:56576
ds_read_b64_tr_b16 v[246:247], v6 offset:57088
v_mfma_f32_16x16x32_bf16 a[64:67], v[252:255], v[196:199], a[64:67]
s_waitcnt lgkmcnt(8)
ds_read_b64_tr_b16 v[248:249], v5 offset:56640
ds_read_b64_tr_b16 v[250:251], v5 offset:57152
ds_read_b64_tr_b16 v[252:253], v6 offset:56640
ds_read_b64_tr_b16 v[254:255], v6 offset:57152
v_mfma_f32_16x16x32_bf16 a[68:71], v[228:231], v[196:199], a[68:71]
s_waitcnt lgkmcnt(10)
v_mfma_f32_16x16x32_bf16 a[72:75], v[232:235], v[196:199], a[72:75]
s_waitcnt vmcnt(4) lgkmcnt(0)
s_barrier
s_add_u32 m0, s78, 118272
s_add_u32 s62, s62, 128
v_mfma_f32_16x16x32_bf16 a[76:79], v[236:239], v[196:199], a[76:79]
ds_read_b64_tr_b16 v[236:237], v5 offset:34816
ds_read_b64_tr_b16 v[238:239], v5 offset:35328
buffer_load_dwordx4 v4, s[48:51], s62 offen offset:0 nt lds
s_add_u32 m0, s78, 122624
v_mfma_f32_16x16x32_bf16 a[80:83], v[240:243], v[196:199], a[80:83]
ds_read_b64_tr_b16 v[240:241], v6 offset:34816
ds_read_b64_tr_b16 v[242:243], v6 offset:35328
s_add_u32 s62, s62, 128
buffer_load_dwordx4 v4, s[48:51], s62 offen offset:0 nt lds
v_mfma_f32_16x16x32_bf16 a[84:87], v[244:247], v[196:199], a[84:87]
ds_read_b64_tr_b16 v[244:245], v5 offset:34880
ds_read_b64_tr_b16 v[246:247], v5 offset:35392
v_mfma_f32_16x16x32_bf16 a[88:91], v[248:251], v[196:199], a[88:91]
ds_read_b64_tr_b16 v[248:249], v6 offset:34880
ds_read_b64_tr_b16 v[250:251], v6 offset:35392
v_mfma_f32_16x16x32_bf16 a[92:95], v[252:255], v[196:199], a[92:95]
s_waitcnt lgkmcnt(6)
ds_read_b64_tr_b16 v[252:253], v5 offset:39168
ds_read_b64_tr_b16 v[254:255], v5 offset:39680
ds_read_b64_tr_b16 v[228:229], v6 offset:39168
ds_read_b64_tr_b16 v[230:231], v6 offset:39680
v_mfma_f32_16x16x32_bf16 a[96:99], v[236:239], v[196:199], a[96:99]
s_waitcnt lgkmcnt(8)
ds_read_b64_tr_b16 v[232:233], v5 offset:39232
ds_read_b64_tr_b16 v[234:235], v5 offset:39744
ds_read_b64_tr_b16 v[236:237], v6 offset:39232
ds_read_b64_tr_b16 v[238:239], v6 offset:39744
v_mfma_f32_16x16x32_bf16 a[100:103], v[240:243], v[196:199], a[100:103]
s_waitcnt lgkmcnt(10)
ds_read_b64_tr_b16 v[240:241], v5 offset:43520
ds_read_b64_tr_b16 v[242:243], v5 offset:44032
v_mfma_f32_16x16x32_bf16 a[104:107], v[244:247], v[196:199], a[104:107]
s_waitcnt lgkmcnt(10)
ds_read_b64_tr_b16 v[244:245], v6 offset:43520
ds_read_b64_tr_b16 v[246:247], v6 offset:44032
v_mfma_f32_16x16x32_bf16 a[108:111], v[248:251], v[196:199], a[108:111]
s_waitcnt lgkmcnt(10)
ds_read_b64_tr_b16 v[248:249], v5 offset:43584
ds_read_b64_tr_b16 v[250:251], v5 offset:44096
v_mfma_f32_16x16x32_bf16 a[112:115], v[252:255], v[196:199], a[112:115]
s_waitcnt lgkmcnt(10)
ds_read_b64_tr_b16 v[252:253], v6 offset:43584
ds_read_b64_tr_b16 v[254:255], v6 offset:44096
v_mfma_f32_16x16x32_bf16 a[116:119], v[228:231], v[196:199], a[116:119]
s_waitcnt lgkmcnt(10)
v_mfma_f32_16x16x32_bf16 a[120:123], v[232:235], v[196:199], a[120:123]
s_waitcnt lgkmcnt(8)
v_mfma_f32_16x16x32_bf16 a[124:127], v[236:239], v[196:199], a[124:127]
s_waitcnt lgkmcnt(6)
v_mfma_f32_16x16x32_bf16 a[128:131], v[240:243], v[196:199], a[128:131]
s_waitcnt lgkmcnt(4)
v_mfma_f32_16x16x32_bf16 a[132:135], v[244:247], v[196:199], a[132:135]
s_waitcnt lgkmcnt(2)
v_mfma_f32_16x16x32_bf16 a[136:139], v[248:251], v[196:199], a[136:139]
s_waitcnt lgkmcnt(0)
v_mfma_f32_16x16x32_bf16 a[140:143], v[252:255], v[196:199], a[140:143]
s_nop 7
v_mbcnt_lo_u32_b32 v15, -1, 0
v_mbcnt_hi_u32_b32 v15, -1, v15
v_lshlrev_b32 v15, 4, v15
s_mul_i32 s74, s56, 36864
v_accvgpr_read_b32 v36, a0
v_accvgpr_read_b32 v37, a1
v_accvgpr_read_b32 v38, a2
v_accvgpr_read_b32 v39, a3
v_accvgpr_read_b32 v40, a4
v_accvgpr_read_b32 v41, a5
v_accvgpr_read_b32 v42, a6
v_accvgpr_read_b32 v43, a7
v_cvt_pk_bf16_f32 v44, v36, v37
v_cvt_pk_bf16_f32 v45, v38, v39
v_cvt_pk_bf16_f32 v46, v40, v41
v_cvt_pk_bf16_f32 v47, v42, v43
buffer_store_dwordx4 v[44:47], v15, s[52:55], s74 offen offset:0
v_accvgpr_read_b32 v52, a8
v_accvgpr_read_b32 v53, a9
v_accvgpr_read_b32 v54, a10
v_accvgpr_read_b32 v55, a11
v_accvgpr_read_b32 v56, a12
v_accvgpr_read_b32 v57, a13
v_accvgpr_read_b32 v58, a14
v_accvgpr_read_b32 v59, a15
v_cvt_pk_bf16_f32 v60, v52, v53
v_cvt_pk_bf16_f32 v61, v54, v55
v_cvt_pk_bf16_f32 v62, v56, v57
v_cvt_pk_bf16_f32 v63, v58, v59
buffer_store_dwordx4 v[60:63], v15, s[52:55], s74 offen offset:1024
v_accvgpr_read_b32 v36, a16
v_accvgpr_read_b32 v37, a17
v_accvgpr_read_b32 v38, a18
v_accvgpr_read_b32 v39, a19
v_accvgpr_read_b32 v40, a20
v_accvgpr_read_b32 v41, a21
v_accvgpr_read_b32 v42, a22
v_accvgpr_read_b32 v43, a23
v_cvt_pk_bf16_f32 v44, v36, v37
v_cvt_pk_bf16_f32 v45, v38, v39
v_cvt_pk_bf16_f32 v46, v40, v41
v_cvt_pk_bf16_f32 v47, v42, v43
buffer_store_dwordx4 v[44:47], v15, s[52:55], s74 offen offset:2048
v_accvgpr_read_b32 v52, a24
v_accvgpr_read_b32 v53, a25
v_accvgpr_read_b32 v54, a26
v_accvgpr_read_b32 v55, a27
v_accvgpr_read_b32 v56, a28
v_accvgpr_read_b32 v57, a29
v_accvgpr_read_b32 v58, a30
v_accvgpr_read_b32 v59, a31
v_cvt_pk_bf16_f32 v60, v52, v53
v_cvt_pk_bf16_f32 v61, v54, v55
v_cvt_pk_bf16_f32 v62, v56, v57
v_cvt_pk_bf16_f32 v63, v58, v59
buffer_store_dwordx4 v[60:63], v15, s[52:55], s74 offen offset:3072
v_accvgpr_read_b32 v36, a32
v_accvgpr_read_b32 v37, a33
v_accvgpr_read_b32 v38, a34
v_accvgpr_read_b32 v39, a35
v_accvgpr_read_b32 v40, a36
v_accvgpr_read_b32 v41, a37
v_accvgpr_read_b32 v42, a38
v_accvgpr_read_b32 v43, a39
v_cvt_pk_bf16_f32 v44, v36, v37
v_cvt_pk_bf16_f32 v45, v38, v39
v_cvt_pk_bf16_f32 v46, v40, v41
v_cvt_pk_bf16_f32 v47, v42, v43
s_add_u32 s74, s74, 4096
buffer_store_dwordx4 v[44:47], v15, s[52:55], s74 offen offset:0
v_accvgpr_read_b32 v52, a40
v_accvgpr_read_b32 v53, a41
v_accvgpr_read_b32 v54, a42
v_accvgpr_read_b32 v55, a43
v_accvgpr_read_b32 v56, a44
v_accvgpr_read_b32 v57, a45
v_accvgpr_read_b32 v58, a46
v_accvgpr_read_b32 v59, a47
v_cvt_pk_bf16_f32 v60, v52, v53
v_cvt_pk_bf16_f32 v61, v54, v55
v_cvt_pk_bf16_f32 v62, v56, v57
v_cvt_pk_bf16_f32 v63, v58, v59
buffer_store_dwordx4 v[60:63], v15, s[52:55], s74 offen offset:1024
v_accvgpr_read_b32 v36, a48
v_accvgpr_read_b32 v37, a49
v_accvgpr_read_b32 v38, a50
v_accvgpr_read_b32 v39, a51
v_accvgpr_read_b32 v40, a52
v_accvgpr_read_b32 v41, a53
v_accvgpr_read_b32 v42, a54
v_accvgpr_read_b32 v43, a55
v_cvt_pk_bf16_f32 v44, v36, v37
v_cvt_pk_bf16_f32 v45, v38, v39
v_cvt_pk_bf16_f32 v46, v40, v41
v_cvt_pk_bf16_f32 v47, v42, v43
buffer_store_dwordx4 v[44:47], v15, s[52:55], s74 offen offset:2048
v_accvgpr_read_b32 v52, a56
v_accvgpr_read_b32 v53, a57
v_accvgpr_read_b32 v54, a58
v_accvgpr_read_b32 v55, a59
v_accvgpr_read_b32 v56, a60
v_accvgpr_read_b32 v57, a61
v_accvgpr_read_b32 v58, a62
v_accvgpr_read_b32 v59, a63
v_cvt_pk_bf16_f32 v60, v52, v53
v_cvt_pk_bf16_f32 v61, v54, v55
v_cvt_pk_bf16_f32 v62, v56, v57
v_cvt_pk_bf16_f32 v63, v58, v59
buffer_store_dwordx4 v[60:63], v15, s[52:55], s74 offen offset:3072
v_accvgpr_read_b32 v36, a64
v_accvgpr_read_b32 v37, a65
v_accvgpr_read_b32 v38, a66
v_accvgpr_read_b32 v39, a67
v_accvgpr_read_b32 v40, a68
v_accvgpr_read_b32 v41, a69
v_accvgpr_read_b32 v42, a70
v_accvgpr_read_b32 v43, a71
v_cvt_pk_bf16_f32 v44, v36, v37
v_cvt_pk_bf16_f32 v45, v38, v39
v_cvt_pk_bf16_f32 v46, v40, v41
v_cvt_pk_bf16_f32 v47, v42, v43
s_add_u32 s74, s74, 4096
buffer_store_dwordx4 v[44:47], v15, s[52:55], s74 offen offset:0
v_accvgpr_read_b32 v52, a72
v_accvgpr_read_b32 v53, a73
v_accvgpr_read_b32 v54, a74
v_accvgpr_read_b32 v55, a75
v_accvgpr_read_b32 v56, a76
v_accvgpr_read_b32 v57, a77
v_accvgpr_read_b32 v58, a78
v_accvgpr_read_b32 v59, a79
v_cvt_pk_bf16_f32 v60, v52, v53
v_cvt_pk_bf16_f32 v61, v54, v55
v_cvt_pk_bf16_f32 v62, v56, v57
v_cvt_pk_bf16_f32 v63, v58, v59
buffer_store_dwordx4 v[60:63], v15, s[52:55], s74 offen offset:1024
v_accvgpr_read_b32 v36, a80
v_accvgpr_read_b32 v37, a81
v_accvgpr_read_b32 v38, a82
v_accvgpr_read_b32 v39, a83
v_accvgpr_read_b32 v40, a84
v_accvgpr_read_b32 v41, a85
v_accvgpr_read_b32 v42, a86
v_accvgpr_read_b32 v43, a87
v_cvt_pk_bf16_f32 v44, v36, v37
v_cvt_pk_bf16_f32 v45, v38, v39
v_cvt_pk_bf16_f32 v46, v40, v41
v_cvt_pk_bf16_f32 v47, v42, v43
buffer_store_dwordx4 v[44:47], v15, s[52:55], s74 offen offset:2048
v_accvgpr_read_b32 v52, a88
v_accvgpr_read_b32 v53, a89
v_accvgpr_read_b32 v54, a90
v_accvgpr_read_b32 v55, a91
v_accvgpr_read_b32 v56, a92
v_accvgpr_read_b32 v57, a93
v_accvgpr_read_b32 v58, a94
v_accvgpr_read_b32 v59, a95
v_cvt_pk_bf16_f32 v60, v52, v53
v_cvt_pk_bf16_f32 v61, v54, v55
v_cvt_pk_bf16_f32 v62, v56, v57
v_cvt_pk_bf16_f32 v63, v58, v59
buffer_store_dwordx4 v[60:63], v15, s[52:55], s74 offen offset:3072
v_accvgpr_read_b32 v36, a96
v_accvgpr_read_b32 v37, a97
v_accvgpr_read_b32 v38, a98
v_accvgpr_read_b32 v39, a99
v_accvgpr_read_b32 v40, a100
v_accvgpr_read_b32 v41, a101
v_accvgpr_read_b32 v42, a102
v_accvgpr_read_b32 v43, a103
v_cvt_pk_bf16_f32 v44, v36, v37
v_cvt_pk_bf16_f32 v45, v38, v39
v_cvt_pk_bf16_f32 v46, v40, v41
v_cvt_pk_bf16_f32 v47, v42, v43
s_add_u32 s74, s74, 4096
buffer_store_dwordx4 v[44:47], v15, s[52:55], s74 offen offset:0
v_accvgpr_read_b32 v52, a104
v_accvgpr_read_b32 v53, a105
v_accvgpr_read_b32 v54, a106
v_accvgpr_read_b32 v55, a107
v_accvgpr_read_b32 v56, a108
v_accvgpr_read_b32 v57, a109
v_accvgpr_read_b32 v58, a110
v_accvgpr_read_b32 v59, a111
v_cvt_pk_bf16_f32 v60, v52, v53
v_cvt_pk_bf16_f32 v61, v54, v55
v_cvt_pk_bf16_f32 v62, v56, v57
v_cvt_pk_bf16_f32 v63, v58, v59
buffer_store_dwordx4 v[60:63], v15, s[52:55], s74 offen offset:1024
v_accvgpr_read_b32 v36, a112
v_accvgpr_read_b32 v37, a113
v_accvgpr_read_b32 v38, a114
v_accvgpr_read_b32 v39, a115
v_accvgpr_read_b32 v40, a116
v_accvgpr_read_b32 v41, a117
v_accvgpr_read_b32 v42, a118
v_accvgpr_read_b32 v43, a119
v_cvt_pk_bf16_f32 v44, v36, v37
v_cvt_pk_bf16_f32 v45, v38, v39
v_cvt_pk_bf16_f32 v46, v40, v41
v_cvt_pk_bf16_f32 v47, v42, v43
buffer_store_dwordx4 v[44:47], v15, s[52:55], s74 offen offset:2048
v_accvgpr_read_b32 v52, a120
v_accvgpr_read_b32 v53, a121
v_accvgpr_read_b32 v54, a122
v_accvgpr_read_b32 v55, a123
v_accvgpr_read_b32 v56, a124
v_accvgpr_read_b32 v57, a125
v_accvgpr_read_b32 v58, a126
v_accvgpr_read_b32 v59, a127
v_cvt_pk_bf16_f32 v60, v52, v53
v_cvt_pk_bf16_f32 v61, v54, v55
v_cvt_pk_bf16_f32 v62, v56, v57
v_cvt_pk_bf16_f32 v63, v58, v59
buffer_store_dwordx4 v[60:63], v15, s[52:55], s74 offen offset:3072
v_accvgpr_read_b32 v36, a128
v_accvgpr_read_b32 v37, a129
v_accvgpr_read_b32 v38, a130
v_accvgpr_read_b32 v39, a131
v_accvgpr_read_b32 v40, a132
v_accvgpr_read_b32 v41, a133
v_accvgpr_read_b32 v42, a134
v_accvgpr_read_b32 v43, a135
v_cvt_pk_bf16_f32 v44, v36, v37
v_cvt_pk_bf16_f32 v45, v38, v39
v_cvt_pk_bf16_f32 v46, v40, v41
v_cvt_pk_bf16_f32 v47, v42, v43
s_add_u32 s74, s74, 4096
buffer_store_dwordx4 v[44:47], v15, s[52:55], s74 offen offset:0
v_accvgpr_read_b32 v52, a136
v_accvgpr_read_b32 v53, a137
v_accvgpr_read_b32 v54, a138
v_accvgpr_read_b32 v55, a139
v_accvgpr_read_b32 v56, a140
v_accvgpr_read_b32 v57, a141
v_accvgpr_read_b32 v58, a142
v_accvgpr_read_b32 v59, a143
v_cvt_pk_bf16_f32 v60, v52, v53
v_cvt_pk_bf16_f32 v61, v54, v55
v_cvt_pk_bf16_f32 v62, v56, v57
v_cvt_pk_bf16_f32 v63, v58, v59
buffer_store_dwordx4 v[60:63], v15, s[52:55], s74 offen offset:1024
s_waitcnt vmcnt(0)
s_endpgm
L_tr_WB1:
s_getpc_b64 s[90:91]
L_pc_WB1:
s_add_u32 s90, s90, L_back_WB1-L_pc_WB1
s_addc_u32 s91, s91, -1
s_branch L_slow_W1
L_tr_WB2:
s_getpc_b64 s[90:91]
L_pc_WB2:
s_add_u32 s90, s90, L_back_WB2-L_pc_WB2
s_addc_u32 s91, s91, -1
s_branch L_slow_W0
L_tr_WB3:
s_getpc_b64 s[90:91]
L_pc_WB3:
s_add_u32 s90, s90, L_back_WB3-L_pc_WB3
s_addc_u32 s91, s91, -1
s_branch L_slow_W1
L_tr_WB4:
s_getpc_b64 s[90:91]
L_pc_WB4:
s_add_u32 s90, s90, L_back_WB4-L_pc_WB4
s_addc_u32 s91, s91, -1
s_branch L_slow_W0
L_tr_WB5:
s_getpc_b64 s[90:91]
L_pc_WB5:
s_add_u32 s90, s90, L_back_WB5-L_pc_WB5
s_addc_u32 s91, s91, -1
s_branch L_slow_W1
L_tr_WB14:
s_getpc_b64 s[90:91]
L_pc_WB14:
s_add_u32 s90, s90, L_back_WB14-L_pc_WB14
s_addc_u32 s91, s91, -1
s_branch L_slow_W0
L_tr_WB15:
s_getpc_b64 s[90:91]
L_pc_WB15:
s_add_u32 s90, s90, L_back_WB15-L_pc_WB15
s_addc_u32 s91, s91, -1
s_branch L_slow_W1
L_slow_W0:
s_nop 7
s_nop 7
v_max3_f32 v15, v36, v37, v38
v_max3_f32 v16, v39, v40, v41
v_max3_f32 v15, v15, v42, v43
v_max_f32 v15, v15, v16
v_mov_b32 v16, v15
s_nop 1
v_permlane32_swap_b32 v15, v16
v_max_f32 v15, v15, v16
v_mov_b32 v16, v15
s_nop 1
v_permlane16_swap_b32 v15, v16
v_max_f32 v15, v15, v16
v_max_f32 v15, 0, v15
v_sub_f32 v16, 0, v15
v_exp_f32 v16, v16
v_sub_f32 v20, v20, v15
v_sub_f32 v21, v21, v15
v_sub_f32 v22, v22, v15
v_sub_f32 v23, v23, v15
v_mul_f32 v11, v11, v16
v_mul_f32 v68, v68, v16
v_mul_f32 v69, v69, v16
v_mul_f32 v70, v70, v16
v_mul_f32 v71, v71, v16
v_mul_f32 v76, v76, v16
v_mul_f32 v77, v77, v16
v_mul_f32 v78, v78, v16
v_mul_f32 v79, v79, v16
v_mul_f32 v84, v84, v16
v_mul_f32 v85, v85, v16
v_mul_f32 v86, v86, v16
v_mul_f32 v87, v87, v16
v_mul_f32 v92, v92, v16
v_mul_f32 v93, v93, v16
v_mul_f32 v94, v94, v16
v_mul_f32 v95, v95, v16
v_mul_f32 v100, v100, v16
v_mul_f32 v101, v101, v16
v_mul_f32 v102, v102, v16
v_mul_f32 v103, v103, v16
v_mul_f32 v108, v108, v16
v_mul_f32 v109, v109, v16
v_mul_f32 v110, v110, v16
v_mul_f32 v111, v111, v16
v_mul_f32 v116, v116, v16
v_mul_f32 v117, v117, v16
v_mul_f32 v118, v118, v16
v_mul_f32 v119, v119, v16
v_mul_f32 v124, v124, v16
v_mul_f32 v125, v125, v16
v_mul_f32 v126, v126, v16
v_mul_f32 v127, v127, v16
v_sub_f32 v36, v36, v15
v_sub_f32 v52, v52, v15
v_sub_f32 v37, v37, v15
v_sub_f32 v53, v53, v15
v_sub_f32 v38, v38, v15
v_sub_f32 v54, v54, v15
v_sub_f32 v39, v39, v15
v_sub_f32 v55, v55, v15
v_sub_f32 v40, v40, v15
v_sub_f32 v56, v56, v15
v_sub_f32 v41, v41, v15
v_sub_f32 v57, v57, v15
v_sub_f32 v42, v42, v15
v_sub_f32 v58, v58, v15
v_sub_f32 v43, v43, v15
v_sub_f32 v59, v59, v15
v_exp_f32 v16, v36
v_exp_f32 v17, v37
v_mov_b32 v13, v16
v_add_f32 v13, v13, v17
v_cvt_pk_bf16_f32 v28, v16, v17
v_exp_f32 v18, v38
v_exp_f32 v19, v39
v_add_f32 v13, v13, v18
v_add_f32 v13, v13, v19
v_cvt_pk_bf16_f32 v29, v18, v19
v_exp_f32 v16, v40
v_exp_f32 v17, v41
v_add_f32 v13, v13, v16
v_add_f32 v13, v13, v17
v_cvt_pk_bf16_f32 v30, v16, v17
v_exp_f32 v18, v42
v_exp_f32 v19, v43
v_add_f32 v13, v13, v18
v_add_f32 v13, v13, v19
v_cvt_pk_bf16_f32 v31, v18, v19
s_nop 1
s_setpc_b64 s[90:91]
L_slow_W1:
s_nop 7
s_nop 7
v_max3_f32 v15, v52, v53, v54
v_max3_f32 v16, v55, v56, v57
v_max3_f32 v15, v15, v58, v59
v_max_f32 v15, v15, v16
v_mov_b32 v16, v15
s_nop 1
v_permlane32_swap_b32 v15, v16
v_max_f32 v15, v15, v16
v_mov_b32 v16, v15
s_nop 1
v_permlane16_swap_b32 v15, v16
v_max_f32 v15, v15, v16
v_max_f32 v15, 0, v15
v_sub_f32 v16, 0, v15
v_exp_f32 v16, v16
v_sub_f32 v20, v20, v15
v_sub_f32 v21, v21, v15
v_sub_f32 v22, v22, v15
v_sub_f32 v23, v23, v15
v_mul_f32 v11, v11, v16
v_mul_f32 v68, v68, v16
v_mul_f32 v69, v69, v16
v_mul_f32 v70, v70, v16
v_mul_f32 v71, v71, v16
v_mul_f32 v76, v76, v16
v_mul_f32 v77, v77, v16
v_mul_f32 v78, v78, v16
v_mul_f32 v79, v79, v16
v_mul_f32 v84, v84, v16
v_mul_f32 v85, v85, v16
v_mul_f32 v86, v86, v16
v_mul_f32 v87, v87, v16
v_mul_f32 v92, v92, v16
v_mul_f32 v93, v93, v16
v_mul_f32 v94, v94, v16
v_mul_f32 v95, v95, v16
v_mul_f32 v100, v100, v16
v_mul_f32 v101, v101, v16
v_mul_f32 v102, v102, v16
v_mul_f32 v103, v103, v16
v_mul_f32 v108, v108, v16
v_mul_f32 v109, v109, v16
v_mul_f32 v110, v110, v16
v_mul_f32 v111, v111, v16
v_mul_f32 v116, v116, v16
v_mul_f32 v117, v117, v16
v_mul_f32 v118, v118, v16
v_mul_f32 v119, v119, v16
v_mul_f32 v124, v124, v16
v_mul_f32 v125, v125, v16
v_mul_f32 v126, v126, v16
v_mul_f32 v127, v127, v16
v_sub_f32 v52, v52, v15
v_sub_f32 v36, v36, v15
v_sub_f32 v53, v53, v15
v_sub_f32 v37, v37, v15
v_sub_f32 v54, v54, v15
v_sub_f32 v38, v38, v15
v_sub_f32 v55, v55, v15
v_sub_f32 v39, v39, v15
v_sub_f32 v56, v56, v15
v_sub_f32 v40, v40, v15
v_sub_f32 v57, v57, v15
v_sub_f32 v41, v41, v15
v_sub_f32 v58, v58, v15
v_sub_f32 v42, v42, v15
v_sub_f32 v59, v59, v15
v_sub_f32 v43, v43, v15
v_exp_f32 v16, v52
v_exp_f32 v17, v53
v_mov_b32 v13, v16
v_add_f32 v13, v13, v17
v_cvt_pk_bf16_f32 v28, v16, v17
v_exp_f32 v18, v54
v_exp_f32 v19, v55
v_add_f32 v13, v13, v18
v_add_f32 v13, v13, v19
v_cvt_pk_bf16_f32 v29, v18, v19
v_exp_f32 v16, v56
v_exp_f32 v17, v57
v_add_f32 v13, v13, v16
v_add_f32 v13, v13, v17
v_cvt_pk_bf16_f32 v30, v16, v17
v_exp_f32 v18, v58
v_exp_f32 v19, v59
v_add_f32 v13, v13, v18
v_add_f32 v13, v13, v19
v_cvt_pk_bf16_f32 v31, v18, v19
s_nop 1
s_setpc_b64 s[90:91]
L_code_end:
s_endpgm
.globl fa_reduce_kernel
.p2align 8
.type fa_reduce_kernel,@function
fa_reduce_kernel:
s_cmp_ge_u32 s2, 1008
s_cbranch_scc1 L_rend
s_load_dwordx2 s[4:5], s[0:1], 96
s_load_dwordx2 s[6:7], s[0:1], 80
v_lshrrev_b32 v1, 6, v0
v_and_b32 v3, 63, v0
v_readfirstlane_b32 s12, v1
s_mul_i32 s13, s2, 4
s_add_u32 s13, s13, s12
s_mul_hi_u32 s8, s13, 34087043
s_mul_i32 s9, s8, 126
s_sub_u32 s9, s13, s9
s_lshr_b32 s10, s8, 4
s_and_b32 s11, s8, 15
s_mul_hi_u32 s14, s9, 238609295
s_mul_i32 s15, s14, 18
s_sub_u32 s15, s9, s15
v_lshlrev_b32 v2, 4, v3
s_lshl_b32 s27, s9, 10
v_add_u32 v2, s27, v2
v_and_b32 v4, 15, v3
v_lshrrev_b32 v5, 4, v3
s_waitcnt lgkmcnt(0)
s_mov_b32 s16, s4
s_mov_b32 s17, s5
s_mov_b32 s18, 33030144
s_mov_b32 s19, 0x00020000
s_mov_b32 s20, s6
s_mov_b32 s21, s7
s_mov_b32 s22, 4128768
s_mov_b32 s23, 0x00020000
s_lshl_b32 s26, s11, 4
s_lshl_b32 s25, s10, 2
s_add_u32 s26, s26, s25
s_add_u32 s24, s26, 0
s_mul_i32 s24, s24, 129024
buffer_load_dwordx4 v[8:11], v2, s[16:19], s24 offen nt
s_add_u32 s24, s26, 8
s_mul_i32 s24, s24, 129024
buffer_load_dwordx4 v[12:15], v2, s[16:19], s24 offen nt
s_add_u32 s24, s26, 1
s_mul_i32 s24, s24, 129024
buffer_load_dwordx4 v[16:19], v2, s[16:19], s24 offen nt
s_add_u32 s24, s26, 9
s_mul_i32 s24, s24, 129024
buffer_load_dwordx4 v[20:23], v2, s[16:19], s24 offen nt
s_add_u32 s24, s26, 2
s_mul_i32 s24, s24, 129024
buffer_load_dwordx4 v[24:27], v2, s[16:19], s24 offen nt
s_add_u32 s24, s26, 10
s_mul_i32 s24, s24, 129024
buffer_load_dwordx4 v[28:31], v2, s[16:19], s24 offen nt
s_add_u32 s24, s26, 3
s_mul_i32 s24, s24, 129024
buffer_load_dwordx4 v[32:35], v2, s[16:19], s24 offen nt
s_add_u32 s24, s26, 11
s_mul_i32 s24, s24, 129024
buffer_load_dwordx4 v[36:39], v2, s[16:19], s24 offen nt
s_mul_i32 s24, s11, 112
s_lshl_b32 s25, s14, 4
s_add_u32 s24, s24, s25
v_add_u32 v4, s24, v4
s_movk_i32 s25, 2304
v_mul_lo_u32 v4, s25, v4
s_mul_i32 s24, s10, 1152
s_lshl_b32 s25, s15, 6
s_add_u32 s24, s24, s25
v_lshl_add_u32 v4, v5, 3, v4
v_add_u32 v4, s24, v4
s_waitcnt vmcnt(7)
v_lshlrev_b32 v48, 16, v8
v_and_b32 v49, 0xffff0000, v8
v_lshlrev_b32 v50, 16, v9
v_and_b32 v51, 0xffff0000, v9
v_lshlrev_b32 v52, 16, v10
v_and_b32 v53, 0xffff0000, v10
v_lshlrev_b32 v54, 16, v11
v_and_b32 v55, 0xffff0000, v11
s_waitcnt vmcnt(6)
v_lshlrev_b32 v40, 16, v12
v_and_b32 v41, 0xffff0000, v12
v_add_f32 v48, v48, v40
v_add_f32 v49, v49, v41
v_lshlrev_b32 v40, 16, v13
v_and_b32 v41, 0xffff0000, v13
v_add_f32 v50, v50, v40
v_add_f32 v51, v51, v41
v_lshlrev_b32 v40, 16, v14
v_and_b32 v41, 0xffff0000, v14
v_add_f32 v52, v52, v40
v_add_f32 v53, v53, v41
v_lshlrev_b32 v40, 16, v15
v_and_b32 v41, 0xffff0000, v15
v_add_f32 v54, v54, v40
v_add_f32 v55, v55, v41
s_waitcnt vmcnt(5)
v_lshlrev_b32 v40, 16, v16
v_and_b32 v41, 0xffff0000, v16
v_add_f32 v48, v48, v40
v_add_f32 v49, v49, v41
v_lshlrev_b32 v40, 16, v17
v_and_b32 v41, 0xffff0000, v17
v_add_f32 v50, v50, v40
v_add_f32 v51, v51, v41
v_lshlrev_b32 v40, 16, v18
v_and_b32 v41, 0xffff0000, v18
v_add_f32 v52, v52, v40
v_add_f32 v53, v53, v41
v_lshlrev_b32 v40, 16, v19
v_and_b32 v41, 0xffff0000, v19
v_add_f32 v54, v54, v40
v_add_f32 v55, v55, v41
s_waitcnt vmcnt(4)
v_lshlrev_b32 v40, 16, v20
v_and_b32 v41, 0xffff0000, v20
v_add_f32 v48, v48, v40
v_add_f32 v49, v49, v41
v_lshlrev_b32 v40, 16, v21
v_and_b32 v41, 0xffff0000, v21
v_add_f32 v50, v50, v40
v_add_f32 v51, v51, v41
v_lshlrev_b32 v40, 16, v22
v_and_b32 v41, 0xffff0000, v22
v_add_f32 v52, v52, v40
v_add_f32 v53, v53, v41
v_lshlrev_b32 v40, 16, v23
v_and_b32 v41, 0xffff0000, v23
v_add_f32 v54, v54, v40
v_add_f32 v55, v55, v41
s_waitcnt vmcnt(3)
v_lshlrev_b32 v40, 16, v24
v_and_b32 v41, 0xffff0000, v24
v_add_f32 v48, v48, v40
v_add_f32 v49, v49, v41
v_lshlrev_b32 v40, 16, v25
v_and_b32 v41, 0xffff0000, v25
v_add_f32 v50, v50, v40
v_add_f32 v51, v51, v41
v_lshlrev_b32 v40, 16, v26
v_and_b32 v41, 0xffff0000, v26
v_add_f32 v52, v52, v40
v_add_f32 v53, v53, v41
v_lshlrev_b32 v40, 16, v27
v_and_b32 v41, 0xffff0000, v27
v_add_f32 v54, v54, v40
v_add_f32 v55, v55, v41
s_waitcnt vmcnt(2)
v_lshlrev_b32 v40, 16, v28
v_and_b32 v41, 0xffff0000, v28
v_add_f32 v48, v48, v40
v_add_f32 v49, v49, v41
v_lshlrev_b32 v40, 16, v29
v_and_b32 v41, 0xffff0000, v29
v_add_f32 v50, v50, v40
v_add_f32 v51, v51, v41
v_lshlrev_b32 v40, 16, v30
v_and_b32 v41, 0xffff0000, v30
v_add_f32 v52, v52, v40
v_add_f32 v53, v53, v41
v_lshlrev_b32 v40, 16, v31
v_and_b32 v41, 0xffff0000, v31
v_add_f32 v54, v54, v40
v_add_f32 v55, v55, v41
s_waitcnt vmcnt(1)
v_lshlrev_b32 v40, 16, v32
v_and_b32 v41, 0xffff0000, v32
v_add_f32 v48, v48, v40
v_add_f32 v49, v49, v41
v_lshlrev_b32 v40, 16, v33
v_and_b32 v41, 0xffff0000, v33
v_add_f32 v50, v50, v40
v_add_f32 v51, v51, v41
v_lshlrev_b32 v40, 16, v34
v_and_b32 v41, 0xffff0000, v34
v_add_f32 v52, v52, v40
v_add_f32 v53, v53, v41
v_lshlrev_b32 v40, 16, v35
v_and_b32 v41, 0xffff0000, v35
v_add_f32 v54, v54, v40
v_add_f32 v55, v55, v41
s_waitcnt vmcnt(0)
v_lshlrev_b32 v40, 16, v36
v_and_b32 v41, 0xffff0000, v36
v_add_f32 v48, v48, v40
v_add_f32 v49, v49, v41
v_lshlrev_b32 v40, 16, v37
v_and_b32 v41, 0xffff0000, v37
v_add_f32 v50, v50, v40
v_add_f32 v51, v51, v41
v_lshlrev_b32 v40, 16, v38
v_and_b32 v41, 0xffff0000, v38
v_add_f32 v52, v52, v40
v_add_f32 v53, v53, v41
v_lshlrev_b32 v40, 16, v39
v_and_b32 v41, 0xffff0000, v39
v_add_f32 v54, v54, v40
v_add_f32 v55, v55, v41
v_cvt_pk_bf16_f32 v56, v48, v49
v_cvt_pk_bf16_f32 v57, v50, v51
v_cvt_pk_bf16_f32 v58, v52, v53
v_cvt_pk_bf16_f32 v59, v54, v55
buffer_store_dwordx2 v[56:57], v4, s[20:23], 0 offen nt
buffer_store_dwordx2 v[58:59], v4, s[20:23], 0 offen offset:32 nt
L_rend:
s_endpgm
.section .rodata,"a"
.p2align 6
.amdhsa_kernel fa_main_kernel
  .amdhsa_next_free_vgpr 512
  .amdhsa_next_free_sgpr 100
  .amdhsa_accum_offset 256
  .amdhsa_group_segment_fixed_size 0
  .amdhsa_kernarg_size 104
  .amdhsa_user_sgpr_count 2
  .amdhsa_user_sgpr_kernarg_segment_ptr 1
  .amdhsa_system_sgpr_workgroup_id_x 1
.end_amdhsa_kernel
.text
.section .rodata,"a"
.p2align 6
.amdhsa_kernel fa_reduce_kernel
  .amdhsa_next_free_vgpr 64
  .amdhsa_next_free_sgpr 40
  .amdhsa_accum_offset 64
  .amdhsa_group_segment_fixed_size 0
  .amdhsa_kernarg_size 104
  .amdhsa_user_sgpr_count 2
  .amdhsa_user_sgpr_kernarg_segment_ptr 1
  .amdhsa_system_sgpr_workgroup_id_x 1
.end_amdhsa_kernel
.text
```
